```python
import torch

def _softmax(x, axis=-1):
    return torch.softmax(x, dim=axis)
def _gelu(x):
    return torch.nn.functional.gelu(x, approximate="tanh")
def _silu(x):
    return torch.nn.functional.silu(x)
def _sigmoid(x):
    return torch.sigmoid(x)
def _layernorm(x, axis=-1, eps=1e-5):
    m = x.mean(dim=axis, keepdim=True)
    v = x.var(dim=axis, keepdim=True, unbiased=False)
    return (x - m) / torch.sqrt(v + eps)
def _scatter_add(tgt, idx, src, axis=0):
    return tgt.clone().index_add_(axis, idx, src)
def _segment_sum(src, seg, n):
    out = torch.zeros((n,) + src.shape[1:], dtype=src.dtype)
    return out.index_add_(0, seg, src)
def _pad(x, pw):
    flat = tuple(v for pair in reversed(pw) for v in pair)
    return torch.nn.functional.pad(x, flat)

kernel_name = 'recurrent_scan__sliding_block_cached__dense_activation_squared_relu__prompt'

def setup_inputs():

    _w = (lambda a: (lambda t: t.to(torch.bfloat16) if t.is_floating_point() else t)(torch.as_tensor(a)))
    def _A_setup():
        B, Sq, D = 1, 2048, 640
        Hq, Hkv, Sk, Dh = 32, 32, 2048, 192
        assert Hq % Hkv == 0, (Hq, Hkv)
        return {
            "x": _w((lambda *s: torch.randn(*s, dtype=torch.bfloat16) * 0.05)(B, Sq, D)),
            "k_cache": _w((lambda *s: torch.randn(*s, dtype=torch.bfloat16) * 0.8)(B, Hkv, Sk, Dh)),
            "v_cache": _w((lambda *s: torch.randn(*s, dtype=torch.bfloat16) * 0.2)(B, Hkv, Sk, Dh)),
            "wq": _w((lambda *s: torch.randn(*s, dtype=torch.bfloat16) * 0.8)(D, Hq * Dh) * (D ** -0.5)),
            "wo": _w((lambda *s: torch.randn(*s, dtype=torch.bfloat16) * 0.2)(Hq * Dh, D) * ((Hq * Dh) ** -0.5)),
        }
    _A_in = _A_setup()

    def _B_setup():
        B, S, D, F = 1, 2048, 640, 1536
        return {
            "x": _w((lambda *s: torch.randn(*s, dtype=torch.bfloat16) * 0.05)(B, S, D)),
            "w1": _w((lambda *s: torch.randn(*s, dtype=torch.bfloat16) * 0.1)(D, F)),
            "b1": _w((lambda *s: torch.randn(*s, dtype=torch.bfloat16) * 0.8)(F)),
            "w2": _w((lambda *s: torch.randn(*s, dtype=torch.bfloat16) * 0.1)(F, D)),
            "b2": _w((lambda *s: torch.randn(*s, dtype=torch.bfloat16) * 12.8)(D)),
        }
    _B_in = _B_setup()

    return {
        "A_x": _A_in["x"],
        "A_k_cache": _A_in["k_cache"],
        "A_v_cache": _A_in["v_cache"],
        "A_wq": _A_in["wq"],
        "A_wo": _A_in["wo"],
        "B_x": _B_in["x"],
        "B_w1": _B_in["w1"],
        "B_b1": _B_in["b1"],
        "B_w2": _B_in["w2"],
        "B_b2": _B_in["b2"],
    }

def reference(A_x, A_k_cache, A_v_cache, A_wq, A_wo, B_x, B_w1, B_b1, B_w2, B_b2):
    def _A_ref(x, k_cache, v_cache, wq, wo):
        B, Sq, D = x.shape
        Hq, Dh = 32, 192
        Hkv, Sk = k_cache.shape[1], k_cache.shape[2]
        W = min(4096, max(256, Sk // 4))
        rep = Hq // Hkv
        q = (lambda x, *d: x.permute(*d))((x @ wq).reshape(B, Sq, Hq, Dh), 0, 2, 1, 3)
        k = (lambda x, n, axis: torch.repeat_interleave(x, n, dim=axis))(k_cache[:, :, Sk - W:, :], rep, axis=1)
        v = (lambda x, n, axis: torch.repeat_interleave(x, n, dim=axis))(v_cache[:, :, Sk - W:, :], rep, axis=1)
        scores = torch.einsum("bhqd,bhkd->bhqk", q, k) * (Dh ** -0.5)
        p = _softmax(scores, axis=-1)
        o = torch.einsum("bhqk,bhkd->bhqd", p, v)
        return (lambda x, *d: x.permute(*d))(o, 0, 2, 1, 3).reshape(B, Sq, Hq * Dh) @ wo

    def _B_ref(x, w1, b1, w2, b2):
        h = torch.einsum("bsd,df->bsf", x, w1) + b1
        zero = torch.zeros_like(h)
        r = torch.where(h > zero, h, zero)
        h = r * r
        out = torch.einsum("bsf,fd->bsd", h, w2) + b2
        return out

    x = A_x
    xn = _layernorm(x, axis=-1)
    s = _A_ref(xn, A_k_cache, A_v_cache, A_wq, A_wo)
    g = _silu(_B_ref(xn, B_w1, B_b1, B_w2, B_b2))
    return x + s * g
```

```asm
; @launch grid=(256,1,1) block=(256,1,1) lds=163840
.amdgcn_target "amdgcn-amd-amdhsa--gfx950"
.text
.globl recurrent_scan__sliding_block_cached__dense_activation_squared_relu__prompt_kernel
.p2align 8
.type recurrent_scan__sliding_block_cached__dense_activation_squared_relu__prompt_kernel,@function
recurrent_scan__sliding_block_cached__dense_activation_squared_relu__prompt_kernel:
re_start:
  s_cmp_ge_u32 s2, 256
  s_cbranch_scc1 re_end
  s_load_dwordx2 s[62:63], s[0:1], 96
  s_load_dwordx8 s[44:51], s[0:1], 0
  s_load_dwordx2 s[74:75], s[0:1], 32
  s_load_dwordx4 s[52:55], s[0:1], 48
  s_load_dwordx2 s[82:83], s[0:1], 64
  s_cmp_ge_u32 s2, 24
  s_cbranch_scc1 re_npf0
  s_lshr_b32 s4, s2, 3
  s_lshl_b32 s4, s4, 2
  s_add_u32 s4, s4, 0
  s_lshl_b32 s4, s4, 12
  v_lshl_add_u32 v2, v0, 6, s4
  s_getpc_b64 s[4:5]
  re_pc0:
  v_min_u32 v2, re_zend-re_pc0-4, v2
  v_mov_b32 v3, s5
  v_add_co_u32 v2, vcc, s4, v2
  v_addc_co_u32 v3, vcc, 0, v3, vcc
   global_load_dword a149, v[2:3], off
  re_npf0:
  v_lshrrev_b32 v16, 6, v0
  v_and_b32 v17, 63, v0
  s_nop 0
  v_readfirstlane_b32 s32, v16
  s_lshr_b32 s3, s2, 3
  s_bfe_u32 s61, s2, 0x20001
  s_lshl_b32 s4, s61, 3
  s_and_b32 s5, s3, 7
  s_add_u32 s4, s4, s5
  s_and_b32 s5, s2, 1
  s_lshl_b32 s5, s5, 2
  s_lshr_b32 s3, s3, 3
  s_add_u32 s3, s5, s3
  s_lshl_b32 s5, s3, 2
  s_add_u32 s5, s5, s32
  s_lshl_b32 s6, s3, 5
  s_add_u32 s6, s6, s4
  s_mul_i32 s41, s6, 10240
  s_lshl_b32 s6, s3, 7
  s_add_u32 s6, s6, 3145728
  v_lshrrev_b32 v18, 5, v0
  v_mul_u32_u24 v18, 1280, v18
  v_and_b32 v19, 31, v0
  v_lshl_add_u32 v30, v19, 3, v18
  s_waitcnt lgkmcnt(0)
  s_load_dword s60, s[62:63], s6
  s_add_u32 s28, s44, 0
  s_addc_u32 s29, s45, 0
  s_mov_b32 s30, 2621440
  s_mov_b32 s31, 0x20000
  buffer_load_dwordx2 v[60:61], v30, s[28:31], s41 offen offset:0
  buffer_load_dwordx2 v[62:63], v30, s[28:31], s41 offen offset:256
  buffer_load_dwordx2 v[64:65], v30, s[28:31], s41 offen offset:512
  buffer_load_dwordx2 v[66:67], v30, s[28:31], s41 offen offset:768
  buffer_load_dwordx2 v[68:69], v30, s[28:31], s41 offen offset:1024
  s_add_u32 s76, s62, 0
  s_addc_u32 s77, s63, 0
  s_mov_b32 s78, 4194304
  s_mov_b32 s79, 0x20000
  s_lshl_b32 s73, s5, 7
  s_add_u32 s73, s73, 3149824
  buffer_load_dword v55, off, s[76:79], s73 sc1
  s_mul_i32 s33, s32, 3072
  s_lshl_b32 s34, s32, 10
  s_add_u32 s34, s34, 12288
  s_and_b32 s6, s4, 1
  s_lshr_b32 s7, s4, 1
  v_mul_u32_u24 v18, 192, v16
  v_add_u32 v18, v18, v17
  v_add_u32 v19, 0, v18
  v_mul_u32_u24 v20, 2731, v19
  v_lshrrev_b32 v20, 16, v20
  v_mul_u32_u24 v21, 24, v20
  v_sub_u32 v21, v19, v21
  v_and_b32 v22, 6, v20
  v_xor_b32 v21, v21, v22
  v_and_b32 v23, 3, v20
  v_bfe_u32 v24, v20, 2, 2
  v_lshl_add_u32 v23, v24, 3, v23
  v_lshrrev_b32 v24, 4, v20
  v_lshl_add_u32 v23, v24, 2, v23
  v_mul_u32_u24 v23, 12288, v23
  v_lshl_add_u32 v23, v21, 4, v23
  v_subrev_u32 v1, 0, v23
  v_xor_b32 v22, v18, v22
  v_lshlrev_b32 v11, 4, v22
  v_bfe_u32 v22, v20, 1, 3
  v_xor_b32 v22, v18, v22
  v_lshlrev_b32 v8, 4, v22
  v_add_u32 v19, 64, v18
  v_mul_u32_u24 v20, 2731, v19
  v_lshrrev_b32 v20, 16, v20
  v_mul_u32_u24 v21, 24, v20
  v_sub_u32 v21, v19, v21
  v_and_b32 v22, 6, v20
  v_xor_b32 v21, v21, v22
  v_and_b32 v23, 3, v20
  v_bfe_u32 v24, v20, 2, 2
  v_lshl_add_u32 v23, v24, 3, v23
  v_lshrrev_b32 v24, 4, v20
  v_lshl_add_u32 v23, v24, 2, v23
  v_mul_u32_u24 v23, 12288, v23
  v_lshl_add_u32 v23, v21, 4, v23
  v_subrev_u32 v2, 1024, v23
  v_xor_b32 v22, v18, v22
  v_lshlrev_b32 v12, 4, v22
  v_bfe_u32 v22, v20, 1, 3
  v_xor_b32 v22, v18, v22
  v_lshlrev_b32 v9, 4, v22
  v_add_u32 v19, 128, v18
  v_mul_u32_u24 v20, 2731, v19
  v_lshrrev_b32 v20, 16, v20
  v_mul_u32_u24 v21, 24, v20
  v_sub_u32 v21, v19, v21
  v_and_b32 v22, 6, v20
  v_xor_b32 v21, v21, v22
  v_and_b32 v23, 3, v20
  v_bfe_u32 v24, v20, 2, 2
  v_lshl_add_u32 v23, v24, 3, v23
  v_lshrrev_b32 v24, 4, v20
  v_lshl_add_u32 v23, v24, 2, v23
  v_mul_u32_u24 v23, 12288, v23
  v_lshl_add_u32 v23, v21, 4, v23
  v_subrev_u32 v3, 2048, v23
  v_xor_b32 v22, v18, v22
  v_lshlrev_b32 v13, 4, v22
  v_bfe_u32 v22, v20, 1, 3
  v_xor_b32 v22, v18, v22
  v_lshlrev_b32 v10, 4, v22
  v_bfe_u32 v20, v17, 2, 3
  v_lshrrev_b32 v21, 1, v20
  v_and_b32 v21, 2, v21
  v_and_b32 v22, 3, v17
  v_xor_b32 v21, v21, v22
  v_lshl_add_u32 v20, v16, 3, v20
  v_and_b32 v23, 3, v20
  v_bfe_u32 v24, v20, 2, 2
  v_lshl_add_u32 v23, v24, 3, v23
  v_lshrrev_b32 v24, 4, v20
  v_lshl_add_u32 v23, v24, 2, v23
  s_lshl_b32 s68, s6, 6
  s_movk_i32 s69, 128
  v_mov_b32 v19, s68
  v_mov_b32 v22, s69
  v_cmp_gt_u32 vcc, 32, v17
  v_cndmask_b32 v19, v22, v19, vcc
  v_lshl_add_u32 v19, v21, 4, v19
  v_mul_u32_u24 v23, 3072, v23
  v_add_u32 v4, v19, v23
  s_mul_i32 s70, s4, 384
  s_mul_i32 s71, s7, 192
  s_add_u32 s8, s50, s70
  s_addc_u32 s9, s51, 0
  s_mov_b32 s10, 0
  s_mov_b32 s11, 0x20000
  s_sub_u32 s10, 7864320, s70
  s_add_u32 s12, s52, s71
  s_addc_u32 s13, s53, 0
  s_mov_b32 s14, 0
  s_mov_b32 s15, 0x20000
  s_sub_u32 s14, 1966080, s71
  s_add_u32 s64, s54, s71
  s_addc_u32 s65, s55, 0
  s_mov_b32 s66, 192
  s_mov_b32 s67, 0x20000
  s_mov_b32 s35, 0
  s_mov_b32 s36, 0
  s_add_u32 m0, s33, 0
  s_nop 0
  buffer_load_dwordx4 v1, s[8:11], s35 offen offset:0 lds
  buffer_load_dwordx4 v2, s[8:11], s35 offen offset:1024 lds
  buffer_load_dwordx4 v3, s[8:11], s35 offen offset:2048 lds
  s_add_u32 m0, s34, 0
  s_add_u32 s35, s35, 393216
  buffer_load_dwordx4 v4, s[12:15], s36 offen lds
  s_add_u32 s36, s36, 98304
  s_add_u32 m0, s33, 16384
  s_nop 0
  buffer_load_dwordx4 v1, s[8:11], s35 offen offset:0 lds
  buffer_load_dwordx4 v2, s[8:11], s35 offen offset:1024 lds
  buffer_load_dwordx4 v3, s[8:11], s35 offen offset:2048 lds
  s_add_u32 m0, s34, 16384
  s_add_u32 s35, s35, 393216
  buffer_load_dwordx4 v4, s[12:15], s36 offen lds
  s_add_u32 s36, s36, 98304
  s_add_u32 m0, s33, 32768
  s_nop 0
  buffer_load_dwordx4 v1, s[8:11], s35 offen offset:0 lds
  buffer_load_dwordx4 v2, s[8:11], s35 offen offset:1024 lds
  buffer_load_dwordx4 v3, s[8:11], s35 offen offset:2048 lds
  s_add_u32 m0, s34, 32768
  s_add_u32 s35, s35, 393216
  buffer_load_dwordx4 v4, s[12:15], s36 offen lds
  s_add_u32 s36, s36, 98304
  s_add_u32 m0, s33, 49152
  s_nop 0
  buffer_load_dwordx4 v1, s[8:11], s35 offen offset:0 lds
  buffer_load_dwordx4 v2, s[8:11], s35 offen offset:1024 lds
  buffer_load_dwordx4 v3, s[8:11], s35 offen offset:2048 lds
  s_add_u32 m0, s34, 49152
  s_add_u32 s35, s35, 393216
  buffer_load_dwordx4 v4, s[12:15], s36 offen lds
  s_add_u32 s36, s36, 98304
  s_add_u32 m0, s33, 139264
  s_nop 0
  buffer_load_dwordx4 v1, s[8:11], s35 offen offset:0 lds
  buffer_load_dwordx4 v2, s[8:11], s35 offen offset:1024 lds
  buffer_load_dwordx4 v3, s[8:11], s35 offen offset:2048 lds
  s_add_u32 m0, s34, 139264
  s_add_u32 s35, s35, 393216
  buffer_load_dwordx4 v4, s[12:15], s36 offen lds
  s_add_u32 s36, s36, 98304
  v_lshrrev_b32 v19, 4, v17
  v_lshlrev_b32 v20, 3, v19
  buffer_load_dwordx2 v[208:209], v20, s[64:67], s68 offen offset:0
  buffer_load_dwordx2 v[224:225], v20, s[64:67], s68 offen offset:32
  buffer_load_dwordx2 v[240:241], v20, s[64:67], s69 offen offset:0
  buffer_load_dwordx2 v[244:245], v20, s[64:67], s69 offen offset:32
  v_bfe_u32 v20, v0, 1, 4
  v_lshrrev_b32 v21, 5, v0
  v_add_u32 v22, v20, v21
  v_and_b32 v22, 7, v22
  v_lshlrev_b32 v20, 7, v20
  v_lshl_add_u32 v20, v22, 4, v20
  v_and_b32 v22, 1, v0
  v_lshl_add_u32 v20, v22, 3, v20
  v_add_u32 v30, 65536, v20
  v_lshrrev_b32 v20, 3, v0
  v_sub_u32 v22, v0, v20
  v_and_b32 v22, 7, v22
  v_and_b32 v20, 3, v20
  v_lshlrev_b32 v20, 8, v20
  v_lshl_add_u32 v20, v22, 4, v20
  v_lshl_add_u32 v20, v21, 12, v20
  s_and_b32 s72, s7, 3
  s_lshl_b32 s72, s72, 10
  s_lshl_b32 s73, s6, 7
  s_add_u32 s72, s72, s73
  v_add_u32 v52, s72, v20
  v_add_u32 v53, 32768, v52
  v_add_u32 v54, 65536, v52
  v_lshlrev_b32 v31, 4, v0
  v_add_u32 v31, 65536, v31
  s_lshl_b32 s72, s3, 2
  s_add_u32 s72, s72, s61
  s_mul_i32 s72, s72, 81920
  s_add_u32 s56, s62, s72
  s_addc_u32 s57, s63, 0
  s_mov_b32 s58, 81920
  s_mov_b32 s59, 0x20000
  s_mul_i32 s73, s4, 786432
  s_add_u32 s73, s73, 589824
  s_add_u32 s20, s46, s73
  s_addc_u32 s21, s47, 0
  s_mov_b32 s22, 196608
  s_mov_b32 s23, 0x20000
  s_add_u32 s24, s48, s73
  s_addc_u32 s25, s49, 0
  s_mov_b32 s26, 196608
  s_mov_b32 s27, 0x20000
  v_mov_b64 v[56:57], 0
  v_mov_b64 v[58:59], 0
  s_waitcnt vmcnt(25)
  v_lshlrev_b32 v32, 16, v60
  v_and_b32 v33, 0xffff0000, v60
  v_lshlrev_b32 v34, 16, v61
  v_and_b32 v35, 0xffff0000, v61
  v_lshlrev_b32 v36, 16, v62
  v_and_b32 v37, 0xffff0000, v62
  v_lshlrev_b32 v38, 16, v63
  v_and_b32 v39, 0xffff0000, v63
  v_lshlrev_b32 v40, 16, v64
  v_and_b32 v41, 0xffff0000, v64
  v_lshlrev_b32 v42, 16, v65
  v_and_b32 v43, 0xffff0000, v65
  v_lshlrev_b32 v44, 16, v66
  v_and_b32 v45, 0xffff0000, v66
  v_lshlrev_b32 v46, 16, v67
  v_and_b32 v47, 0xffff0000, v67
  v_lshlrev_b32 v48, 16, v68
  v_and_b32 v49, 0xffff0000, v68
  v_lshlrev_b32 v50, 16, v69
  v_and_b32 v51, 0xffff0000, v69
  v_pk_add_f32 v[26:27], v[32:33], v[34:35]
  v_pk_add_f32 v[26:27], v[26:27], v[36:37]
  v_pk_add_f32 v[26:27], v[26:27], v[38:39]
  v_pk_add_f32 v[26:27], v[26:27], v[40:41]
  v_pk_add_f32 v[26:27], v[26:27], v[42:43]
  v_pk_add_f32 v[26:27], v[26:27], v[44:45]
  v_pk_add_f32 v[26:27], v[26:27], v[46:47]
  v_pk_add_f32 v[26:27], v[26:27], v[48:49]
  v_pk_add_f32 v[26:27], v[26:27], v[50:51]
  v_add_f32 v26, v26, v27
  s_nop 1
  v_add_f32_dpp v26, v26, v26 quad_perm:[1,0,3,2] row_mask:0xf bank_mask:0xf
  s_nop 1
  v_add_f32_dpp v26, v26, v26 quad_perm:[2,3,0,1] row_mask:0xf bank_mask:0xf
  s_nop 1
  v_add_f32_dpp v26, v26, v26 row_half_mirror row_mask:0xf bank_mask:0xf
  s_nop 1
  v_add_f32_dpp v26, v26, v26 row_mirror row_mask:0xf bank_mask:0xf
  v_mov_b32 v27, v26
  s_nop 1
  v_permlane16_swap_b32 v26, v27
  s_nop 1
  v_add_f32 v26, v26, v27
  v_mul_f32 v26, 0x3acccccd, v26
  v_pk_add_f32 v[60:61], v[32:33], v[26:27] op_sel_hi:[1,0] neg_lo:[0,1] neg_hi:[0,1]
  v_pk_add_f32 v[62:63], v[34:35], v[26:27] op_sel_hi:[1,0] neg_lo:[0,1] neg_hi:[0,1]
  v_pk_add_f32 v[64:65], v[36:37], v[26:27] op_sel_hi:[1,0] neg_lo:[0,1] neg_hi:[0,1]
  v_pk_add_f32 v[66:67], v[38:39], v[26:27] op_sel_hi:[1,0] neg_lo:[0,1] neg_hi:[0,1]
  v_pk_add_f32 v[68:69], v[40:41], v[26:27] op_sel_hi:[1,0] neg_lo:[0,1] neg_hi:[0,1]
  v_pk_add_f32 v[70:71], v[42:43], v[26:27] op_sel_hi:[1,0] neg_lo:[0,1] neg_hi:[0,1]
  v_pk_add_f32 v[72:73], v[44:45], v[26:27] op_sel_hi:[1,0] neg_lo:[0,1] neg_hi:[0,1]
  v_pk_add_f32 v[74:75], v[46:47], v[26:27] op_sel_hi:[1,0] neg_lo:[0,1] neg_hi:[0,1]
  v_pk_add_f32 v[76:77], v[48:49], v[26:27] op_sel_hi:[1,0] neg_lo:[0,1] neg_hi:[0,1]
  v_pk_add_f32 v[78:79], v[50:51], v[26:27] op_sel_hi:[1,0] neg_lo:[0,1] neg_hi:[0,1]
  v_pk_mul_f32 v[28:29], v[60:61], v[60:61]
  v_pk_fma_f32 v[28:29], v[62:63], v[62:63], v[28:29]
  v_pk_fma_f32 v[28:29], v[64:65], v[64:65], v[28:29]
  v_pk_fma_f32 v[28:29], v[66:67], v[66:67], v[28:29]
  v_pk_fma_f32 v[28:29], v[68:69], v[68:69], v[28:29]
  v_pk_fma_f32 v[28:29], v[70:71], v[70:71], v[28:29]
  v_pk_fma_f32 v[28:29], v[72:73], v[72:73], v[28:29]
  v_pk_fma_f32 v[28:29], v[74:75], v[74:75], v[28:29]
  v_pk_fma_f32 v[28:29], v[76:77], v[76:77], v[28:29]
  v_pk_fma_f32 v[28:29], v[78:79], v[78:79], v[28:29]
  v_add_f32 v28, v28, v29
  s_nop 1
  v_add_f32_dpp v28, v28, v28 quad_perm:[1,0,3,2] row_mask:0xf bank_mask:0xf
  s_nop 1
  v_add_f32_dpp v28, v28, v28 quad_perm:[2,3,0,1] row_mask:0xf bank_mask:0xf
  s_nop 1
  v_add_f32_dpp v28, v28, v28 row_half_mirror row_mask:0xf bank_mask:0xf
  s_nop 1
  v_add_f32_dpp v28, v28, v28 row_mirror row_mask:0xf bank_mask:0xf
  v_mov_b32 v27, v28
  s_nop 1
  v_permlane16_swap_b32 v28, v27
  s_nop 1
  v_add_f32 v28, v28, v27
  v_mul_f32 v28, 0x3acccccd, v28
  v_cvt_pk_bf16_f32 v26, v26, v26
  v_and_b32 v26, 0xffff0000, v26
  v_cvt_pk_bf16_f32 v28, v28, v28
  v_and_b32 v28, 0xffff0000, v28
  v_add_f32 v28, 0x3727c5ac, v28
  v_cvt_pk_bf16_f32 v28, v28, v28
  v_and_b32 v28, 0xffff0000, v28
  v_sqrt_f32 v28, v28
  s_nop 0
  v_cvt_pk_bf16_f32 v28, v28, v28
  v_and_b32 v28, 0xffff0000, v28
  v_rcp_f32 v28, v28
  s_nop 0
  v_mul_f32 v28, 0x3dd53b95, v28
  v_pk_add_f32 v[32:33], v[32:33], v[26:27] op_sel_hi:[1,0] neg_lo:[0,1] neg_hi:[0,1]
  v_cvt_pk_bf16_f32 v33, v32, v33
  v_lshlrev_b32 v32, 16, v33
  v_and_b32 v33, 0xffff0000, v33
  v_pk_mul_f32 v[32:33], v[32:33], v[28:29] op_sel_hi:[1,0]
  v_cvt_pk_bf16_f32 v60, v32, v33
  v_pk_add_f32 v[34:35], v[34:35], v[26:27] op_sel_hi:[1,0] neg_lo:[0,1] neg_hi:[0,1]
  v_cvt_pk_bf16_f32 v35, v34, v35
  v_lshlrev_b32 v34, 16, v35
  v_and_b32 v35, 0xffff0000, v35
  v_pk_mul_f32 v[34:35], v[34:35], v[28:29] op_sel_hi:[1,0]
  v_cvt_pk_bf16_f32 v61, v34, v35
  ds_write_b64 v30, v[60:61] offset:0
  v_pk_add_f32 v[36:37], v[36:37], v[26:27] op_sel_hi:[1,0] neg_lo:[0,1] neg_hi:[0,1]
  v_cvt_pk_bf16_f32 v37, v36, v37
  v_lshlrev_b32 v36, 16, v37
  v_and_b32 v37, 0xffff0000, v37
  v_pk_mul_f32 v[36:37], v[36:37], v[28:29] op_sel_hi:[1,0]
  v_cvt_pk_bf16_f32 v62, v36, v37
  v_pk_add_f32 v[38:39], v[38:39], v[26:27] op_sel_hi:[1,0] neg_lo:[0,1] neg_hi:[0,1]
  v_cvt_pk_bf16_f32 v39, v38, v39
  v_lshlrev_b32 v38, 16, v39
  v_and_b32 v39, 0xffff0000, v39
  v_pk_mul_f32 v[38:39], v[38:39], v[28:29] op_sel_hi:[1,0]
  v_cvt_pk_bf16_f32 v63, v38, v39
  ds_write_b64 v30, v[62:63] offset:2048
  v_pk_add_f32 v[40:41], v[40:41], v[26:27] op_sel_hi:[1,0] neg_lo:[0,1] neg_hi:[0,1]
  v_cvt_pk_bf16_f32 v41, v40, v41
  v_lshlrev_b32 v40, 16, v41
  v_and_b32 v41, 0xffff0000, v41
  v_pk_mul_f32 v[40:41], v[40:41], v[28:29] op_sel_hi:[1,0]
  v_cvt_pk_bf16_f32 v64, v40, v41
  v_pk_add_f32 v[42:43], v[42:43], v[26:27] op_sel_hi:[1,0] neg_lo:[0,1] neg_hi:[0,1]
  v_cvt_pk_bf16_f32 v43, v42, v43
  v_lshlrev_b32 v42, 16, v43
  v_and_b32 v43, 0xffff0000, v43
  v_pk_mul_f32 v[42:43], v[42:43], v[28:29] op_sel_hi:[1,0]
  v_cvt_pk_bf16_f32 v65, v42, v43
  ds_write_b64 v30, v[64:65] offset:4096
  v_pk_add_f32 v[44:45], v[44:45], v[26:27] op_sel_hi:[1,0] neg_lo:[0,1] neg_hi:[0,1]
  v_cvt_pk_bf16_f32 v45, v44, v45
  v_lshlrev_b32 v44, 16, v45
  v_and_b32 v45, 0xffff0000, v45
  v_pk_mul_f32 v[44:45], v[44:45], v[28:29] op_sel_hi:[1,0]
  v_cvt_pk_bf16_f32 v66, v44, v45
  v_pk_add_f32 v[46:47], v[46:47], v[26:27] op_sel_hi:[1,0] neg_lo:[0,1] neg_hi:[0,1]
  v_cvt_pk_bf16_f32 v47, v46, v47
  v_lshlrev_b32 v46, 16, v47
  v_and_b32 v47, 0xffff0000, v47
  v_pk_mul_f32 v[46:47], v[46:47], v[28:29] op_sel_hi:[1,0]
  v_cvt_pk_bf16_f32 v67, v46, v47
  ds_write_b64 v30, v[66:67] offset:6144
  v_pk_add_f32 v[48:49], v[48:49], v[26:27] op_sel_hi:[1,0] neg_lo:[0,1] neg_hi:[0,1]
  v_cvt_pk_bf16_f32 v49, v48, v49
  v_lshlrev_b32 v48, 16, v49
  v_and_b32 v49, 0xffff0000, v49
  v_pk_mul_f32 v[48:49], v[48:49], v[28:29] op_sel_hi:[1,0]
  v_cvt_pk_bf16_f32 v68, v48, v49
  v_pk_add_f32 v[50:51], v[50:51], v[26:27] op_sel_hi:[1,0] neg_lo:[0,1] neg_hi:[0,1]
  v_cvt_pk_bf16_f32 v51, v50, v51
  v_lshlrev_b32 v50, 16, v51
  v_and_b32 v51, 0xffff0000, v51
  v_pk_mul_f32 v[50:51], v[50:51], v[28:29] op_sel_hi:[1,0]
  v_cvt_pk_bf16_f32 v69, v50, v51
  ds_write_b64 v30, v[68:69] offset:8192
  s_waitcnt lgkmcnt(0)
  s_barrier
  ds_read_b128 v[60:63], v31 offset:0
  ds_read_b128 v[64:67], v31 offset:4096
  ds_read_b128 v[68:71], v31 offset:8192
  s_waitcnt lgkmcnt(2)
  buffer_store_dwordx4 v[60:63], v52, s[56:59], 0 offen sc1
  s_waitcnt lgkmcnt(1)
  buffer_store_dwordx4 v[64:67], v53, s[56:59], 0 offen sc1
  s_waitcnt lgkmcnt(0)
  buffer_store_dwordx4 v[68:71], v54, s[56:59], 0 offen sc1
  s_mul_i32 s60, s60, 0x41c64e6d
  s_add_u32 s60, s60, 0x3c6ef35f
  s_mul_i32 s72, s5, 81920
  s_add_u32 s16, s62, s72
  s_addc_u32 s17, s63, 0
  s_mov_b32 s18, 81920
  s_mov_b32 s19, 0x20000
  s_add_u32 s28, s62, 4194304
  s_addc_u32 s29, s63, 0
  s_mov_b32 s30, 31457280
  s_mov_b32 s31, 0x20000
  s_lshl_b32 s72, s3, 2
  s_add_u32 s72, s72, s61
  s_lshl_b32 s72, s72, 7
  s_and_b32 s73, s4, 7
  s_lshl_b32 s73, s73, 2
  s_add_u32 s72, s72, s73
  s_add_u32 s72, s72, 3149824
  v_mfma_f32_32x32x16_bf16 a[128:143], v[56:59], v[56:59], 0
  v_lshrrev_b32 v20, 2, v17
  v_and_b32 v21, 3, v17
  v_and_b32 v22, 6, v20
  v_xor_b32 v22, v21, v22
  v_mul_u32_u24 v23, 384, v20
  v_lshl_add_u32 v5, v22, 4, v23
  v_xor_b32 v6, 64, v5
  v_mfma_f32_32x32x16_bf16 a[112:127], v[56:59], v[56:59], 0
  v_bfe_u32 v22, v20, 2, 1
  v_and_b32 v20, 7, v20
  v_lshlrev_b32 v20, 6, v20
  v_lshl_add_u32 v20, v22, 5, v20
  v_lshl_add_u32 v20, v21, 3, v20
  v_lshrrev_b32 v22, 5, v17
  v_lshl_add_u32 v20, v22, 10, v20
  v_mfma_f32_32x32x16_bf16 a[96:111], v[56:59], v[56:59], 0
  v_add_u32 v7, 12288, v20
  v_xor_b32 v15, 32, v7
  v_and_b32 v20, 15, v17
  v_lshrrev_b32 v21, 1, v20
  v_xor_b32 v21, v21, v19
  v_mul_u32_u24 v22, 384, v20
  v_lshl_add_u32 v22, v21, 4, v22
  v_mfma_f32_32x32x16_bf16 a[80:95], v[56:59], v[56:59], 0
  v_add_u32 v14, 65536, v22
  s_and_b32 s70, s61, 1
  s_mul_i32 s70, s70, 10
  v_mul_u32_u24 v18, 320, v16
  v_add_u32 v18, v18, v17
  v_add_u32 v19, 0, v18
  v_mul_u32_u24 v20, 3277, v19
  v_mfma_f32_32x32x16_bf16 a[64:79], v[56:59], v[56:59], 0
  v_lshrrev_b32 v20, 16, v20
  v_mul_u32_u24 v21, 20, v20
  v_sub_u32 v21, v19, v21
  v_lshrrev_b32 v22, 1, v20
  v_and_b32 v22, 2, v22
  v_xor_b32 v21, v21, v22
  v_add_u32 v21, s70, v21
  v_mfma_f32_32x32x16_bf16 a[48:63], v[56:59], v[56:59], 0
  v_subrev_u32 v22, 20, v21
  v_min_u32 v21, v21, v22
  v_mul_u32_u24 v20, 1280, v20
  v_lshl_add_u32 v20, v21, 4, v20
  v_subrev_u32 v20, 0, v20
  v_accvgpr_write_b32 a139, v20
  v_add_u32 v19, 64, v18
  v_mfma_f32_32x32x16_bf16 a[32:47], v[56:59], v[56:59], 0
  v_mul_u32_u24 v20, 3277, v19
  v_lshrrev_b32 v20, 16, v20
  v_mul_u32_u24 v21, 20, v20
  v_sub_u32 v21, v19, v21
  v_lshrrev_b32 v22, 1, v20
  v_and_b32 v22, 2, v22
  v_xor_b32 v21, v21, v22
  v_mfma_f32_32x32x16_bf16 a[16:31], v[56:59], v[56:59], 0
  v_add_u32 v21, s70, v21
  v_subrev_u32 v22, 20, v21
  v_min_u32 v21, v21, v22
  v_mul_u32_u24 v20, 1280, v20
  v_lshl_add_u32 v20, v21, 4, v20
  v_subrev_u32 v20, 1024, v20
  v_accvgpr_write_b32 a140, v20
  v_mfma_f32_32x32x16_bf16 a[0:15], v[56:59], v[56:59], 0
  v_add_u32 v19, 128, v18
  v_mul_u32_u24 v20, 3277, v19
  v_lshrrev_b32 v20, 16, v20
  v_mul_u32_u24 v21, 20, v20
  v_sub_u32 v21, v19, v21
  v_lshrrev_b32 v22, 1, v20
  v_and_b32 v22, 2, v22
  v_mfma_f32_32x32x16_bf16 v[80:95], v[56:59], v[56:59], 0
  v_xor_b32 v21, v21, v22
  v_add_u32 v21, s70, v21
  v_subrev_u32 v22, 20, v21
  v_min_u32 v21, v21, v22
  v_mul_u32_u24 v20, 1280, v20
  v_lshl_add_u32 v20, v21, 4, v20
  v_subrev_u32 v20, 2048, v20
  v_mfma_f32_32x32x16_bf16 v[96:111], v[56:59], v[56:59], 0
  v_accvgpr_write_b32 a141, v20
  v_add_u32 v19, 192, v18
  v_mul_u32_u24 v20, 3277, v19
  v_lshrrev_b32 v20, 16, v20
  v_mul_u32_u24 v21, 20, v20
  v_sub_u32 v21, v19, v21
  v_lshrrev_b32 v22, 1, v20
  v_mfma_f32_32x32x16_bf16 v[112:127], v[56:59], v[56:59], 0
  v_and_b32 v22, 2, v22
  v_xor_b32 v21, v21, v22
  v_add_u32 v21, s70, v21
  v_subrev_u32 v22, 20, v21
  v_min_u32 v21, v21, v22
  v_mul_u32_u24 v20, 1280, v20
  v_lshl_add_u32 v20, v21, 4, v20
  v_mfma_f32_32x32x16_bf16 v[128:143], v[56:59], v[56:59], 0
  v_subrev_u32 v20, 3072, v20
  v_accvgpr_write_b32 a142, v20
  v_add_u32 v19, 256, v18
  v_mul_u32_u24 v20, 3277, v19
  v_lshrrev_b32 v20, 16, v20
  v_mul_u32_u24 v21, 20, v20
  v_sub_u32 v21, v19, v21
  v_mfma_f32_32x32x16_bf16 v[144:159], v[56:59], v[56:59], 0
  v_lshrrev_b32 v22, 1, v20
  v_and_b32 v22, 2, v22
  v_xor_b32 v21, v21, v22
  v_add_u32 v21, s70, v21
  v_subrev_u32 v22, 20, v21
  v_min_u32 v21, v21, v22
  v_mul_u32_u24 v20, 1280, v20
  v_mfma_f32_32x32x16_bf16 v[160:175], v[56:59], v[56:59], 0
  v_lshl_add_u32 v20, v21, 4, v20
  v_subrev_u32 v20, 0, v20
  v_accvgpr_write_b32 a143, v20
  v_and_b32 v16, 7, v17
  v_lshlrev_b32 v16, 2, v16
  s_lshl_b32 s55, s5, 7
  s_add_u32 s55, s55, 3149824
  v_mfma_f32_32x32x16_bf16 v[176:191], v[56:59], v[56:59], 0
  v_mfma_f32_32x32x16_bf16 v[192:207], v[56:59], v[56:59], 0
  v_bfrev_b32 v22, 1
  v_cmp_eq_u32 vcc, 0, v0
  v_cndmask_b32 v22, v22, v0, vcc
  v_mov_b32 v23, s60
  s_waitcnt vmcnt(3)
  v_and_b32 v211, 0xffff0000, v209
  v_lshlrev_b32 v210, 16, v209
  v_and_b32 v209, 0xffff0000, v208
  v_lshlrev_b32 v208, 16, v208
  v_mul_f32 v220, 0x3dd53b95, v208
  v_mul_f32 v221, 0x3dd53b95, v209
  v_mul_f32 v222, 0x3dd53b95, v210
  v_mul_f32 v223, 0x3dd53b95, v211
  v_mul_f32 v216, 0x3dd53b95, v208
  v_mul_f32 v217, 0x3dd53b95, v209
  v_mul_f32 v218, 0x3dd53b95, v210
  v_mul_f32 v219, 0x3dd53b95, v211
  v_mul_f32 v212, 0x3dd53b95, v208
  v_mul_f32 v213, 0x3dd53b95, v209
  v_mul_f32 v214, 0x3dd53b95, v210
  v_mul_f32 v215, 0x3dd53b95, v211
  v_mul_f32 v208, 0x3dd53b95, v208
  v_mul_f32 v209, 0x3dd53b95, v209
  v_mul_f32 v210, 0x3dd53b95, v210
  v_mul_f32 v211, 0x3dd53b95, v211
  v_and_b32 v227, 0xffff0000, v225
  v_lshlrev_b32 v226, 16, v225
  v_and_b32 v225, 0xffff0000, v224
  v_lshlrev_b32 v224, 16, v224
  v_mul_f32 v236, 0x3dd53b95, v224
  v_mul_f32 v237, 0x3dd53b95, v225
  v_mul_f32 v238, 0x3dd53b95, v226
  v_mul_f32 v239, 0x3dd53b95, v227
  v_mul_f32 v232, 0x3dd53b95, v224
  v_mul_f32 v233, 0x3dd53b95, v225
  v_mul_f32 v234, 0x3dd53b95, v226
  v_mul_f32 v235, 0x3dd53b95, v227
  v_mul_f32 v228, 0x3dd53b95, v224
  v_mul_f32 v229, 0x3dd53b95, v225
  v_mul_f32 v230, 0x3dd53b95, v226
  v_mul_f32 v231, 0x3dd53b95, v227
  v_mul_f32 v224, 0x3dd53b95, v224
  v_mul_f32 v225, 0x3dd53b95, v225
  v_mul_f32 v226, 0x3dd53b95, v226
  v_mul_f32 v227, 0x3dd53b95, v227
  v_and_b32 v243, 0xffff0000, v241
  v_lshlrev_b32 v242, 16, v241
  v_and_b32 v241, 0xffff0000, v240
  v_lshlrev_b32 v240, 16, v240
  v_mul_f32 v248, 0x3dd53b95, v240
  v_mul_f32 v249, 0x3dd53b95, v241
  v_mul_f32 v250, 0x3dd53b95, v242
  v_mul_f32 v251, 0x3dd53b95, v243
  v_mul_f32 v240, 0x3dd53b95, v240
  v_mul_f32 v241, 0x3dd53b95, v241
  v_mul_f32 v242, 0x3dd53b95, v242
  v_mul_f32 v243, 0x3dd53b95, v243
  v_and_b32 v247, 0xffff0000, v245
  v_lshlrev_b32 v246, 16, v245
  v_and_b32 v245, 0xffff0000, v244
  v_lshlrev_b32 v244, 16, v244
  v_mul_f32 v252, 0x3dd53b95, v244
  v_mul_f32 v253, 0x3dd53b95, v245
  v_mul_f32 v254, 0x3dd53b95, v246
  v_mul_f32 v255, 0x3dd53b95, v247
  v_mul_f32 v244, 0x3dd53b95, v244
  v_mul_f32 v245, 0x3dd53b95, v245
  v_mul_f32 v246, 0x3dd53b95, v246
  v_mul_f32 v247, 0x3dd53b95, v247
  s_waitcnt vmcnt(0)
  s_barrier
  buffer_store_dword v23, v22, s[76:79], s72 offen sc1
  v_mfma_f32_32x32x16_bf16 v[32:47], v[80:83], v[80:83], 0
  v_lshlrev_b32 v0, 4, v17
  s_lshl_b32 s52, s6, 11
  s_xor_b32 s53, s52, 2048
  s_lshl_b32 s72, s5, 1
  s_add_u32 s72, s72, s6
  s_lshl_b32 s72, s72, 2
  s_add_u32 s72, s72, s61
  s_mul_i32 s72, s72, 60
  s_and_b32 s71, s4, 7
  s_mul_i32 s71, s71, 6
  s_add_u32 s70, s72, s71
  s_add_u32 s70, s70, 12
  s_lshl_b32 s42, s70, 11
  s_mul_i32 s73, s6, -983040
  s_add_u32 s73, s73, 491520
  s_add_u32 s45, s42, s73
  s_add_u32 s43, s42, 4096
  s_add_u32 s44, s42, 8192
  s_add_u32 s46, s45, 4096
  s_add_u32 s47, s45, 8192
  s_and_b32 s70, s7, 3
  s_mul_i32 s70, s70, 3
  s_add_u32 s70, s70, s72
  s_add_u32 s71, s70, s6
  s_lshl_b32 s48, s71, 11
  s_add_u32 s49, s48, s73
  s_add_u32 s71, s70, 2
  s_lshl_b32 s50, s71, 11
  s_lshr_b32 s71, s2, 3
  s_lshl_b32 s71, s71, 2
  s_add_u32 s71, s71, s32
  s_lshl_b32 s70, s61, 7
  s_add_u32 s71, s71, s70
  s_mul_i32 s72, s71, 15360
  s_mul_i32 s70, s71, 3840
  s_bfe_u32 s71, s2, 0x20003
  s_mul_i32 s71, s71, 320
  s_mul_i32 s73, s61, 491520
  s_add_u32 s73, s73, s71
  s_add_u32 s64, s74, s72
  s_addc_u32 s65, s75, 0
  s_mov_b32 s66, 15360
  s_mov_b32 s67, 0x20000
  s_add_u32 s56, s82, s73
  s_addc_u32 s57, s83, 0
  s_mov_b32 s58, 0
  s_mov_b32 s59, 0x20000
  s_sub_u32 s58, 491520, s71
  s_add_u32 s80, s82, s70
  s_addc_u32 s81, s83, 0
  s_mov_b32 s82, 3840
  s_mov_b32 s83, 0x20000
  s_lshl_b32 s70, s3, 1
  s_bfe_u32 s71, s2, 0x10005
  s_add_u32 s70, s70, s71
  s_lshl_b32 s70, s70, 2
  s_add_u32 s51, s70, s32
  s_lshr_b32 s70, s51, 1
  s_lshl_b32 s70, s70, 2
  s_add_u32 s70, s70, s61
  s_lshl_b32 s70, s70, 7
  s_add_u32 s54, s70, 3162112
  s_lshl_b32 s70, s5, 2
  s_add_u32 s70, s70, s61
  s_lshl_b32 s70, s70, 7
  s_and_b32 s71, s4, 7
  s_lshl_b32 s71, s71, 2
  s_add_u32 s70, s70, s71
  s_add_u32 s71, s70, 3162112
  s_mov_b32 s39, 0
  s_mov_b32 s37, 0
  s_mov_b32 s38, 0
  s_mov_b32 s40, 0
  s_mov_b32 s70, 0
  s_mul_i32 s68, s32, 5120
  s_mov_b32 s69, 0
  s_mov_b32 s72, s68
  v_mfma_f32_32x32x16_bf16 v[48:63], v[80:83], v[80:83], 0
  v_mov_b64 v[18:19], 0
  v_mov_b64 v[20:21], 0
  v_mov_b64 v[22:23], 0
  v_mov_b64 v[24:25], 0
  v_mov_b64 v[26:27], 0
  v_mov_b64 v[28:29], 0
  v_mov_b64 v[30:31], 0
  v_mfma_f32_32x32x16_bf16 v[64:79], v[80:83], v[80:83], 0
  ds_read_b64_tr_b16 a[144:145], v5 offset:0
  ds_read_b64_tr_b16 a[146:147], v5 offset:6144
  ds_read_b64_tr_b16 a[148:149], v5 offset:8
  ds_read_b64_tr_b16 a[150:151], v5 offset:6152
  ds_read_b64_tr_b16 a[152:153], v6 offset:0
  ds_read_b64_tr_b16 a[154:155], v6 offset:6144
  ds_read_b64_tr_b16 a[156:157], v6 offset:8
  ds_read_b64_tr_b16 a[158:159], v6 offset:6152
  s_mov_b32 s73, 0
re_poll1:
  buffer_load_dword v17, v16, s[76:79], s55 offen sc1
  s_waitcnt vmcnt(0) lgkmcnt(0)
  v_cmp_ne_u32 vcc, s60, v17
  s_add_u32 s73, s73, 1
  s_bitcmp1_b32 s73, 20
  s_cbranch_scc1 re_poll1x
  s_cbranch_vccnz re_poll1
re_poll1x:
  buffer_load_dwordx4 a[176:179], v0, s[16:19], s52 offen offset:0 sc1
  buffer_load_dwordx4 a[180:183], v0, s[16:19], s52 offen offset:1024 sc1
  buffer_load_dwordx4 a[184:187], v0, s[16:19], s53 offen offset:0 sc1
  buffer_load_dwordx4 a[188:191], v0, s[16:19], s53 offen offset:1024 sc1
  s_add_u32 s52, s52, 4096
  s_add_u32 s53, s53, 4096
  buffer_load_dwordx4 a[192:195], v0, s[16:19], s52 offen offset:0 sc1
  buffer_load_dwordx4 a[196:199], v0, s[16:19], s52 offen offset:1024 sc1
  buffer_load_dwordx4 a[200:203], v0, s[16:19], s53 offen offset:0 sc1
  buffer_load_dwordx4 a[204:207], v0, s[16:19], s53 offen offset:1024 sc1
  s_add_u32 s52, s52, 4096
  s_add_u32 s53, s53, 4096
  buffer_load_dwordx4 a[208:211], v0, s[16:19], s52 offen offset:0 sc1
  buffer_load_dwordx4 a[212:215], v0, s[16:19], s52 offen offset:1024 sc1
  buffer_load_dwordx4 a[216:219], v0, s[16:19], s53 offen offset:0 sc1
  buffer_load_dwordx4 a[220:223], v0, s[16:19], s53 offen offset:1024 sc1
  s_add_u32 s52, s52, 4096
  s_add_u32 s53, s53, 4096
  buffer_load_dwordx4 a[224:227], v0, s[16:19], s52 offen offset:0 sc1
  buffer_load_dwordx4 a[228:231], v0, s[16:19], s52 offen offset:1024 sc1
  buffer_load_dwordx4 a[232:235], v0, s[16:19], s53 offen offset:0 sc1
  buffer_load_dwordx4 a[236:239], v0, s[16:19], s53 offen offset:1024 sc1
  s_add_u32 s52, s52, 4096
  s_add_u32 s53, s53, 4096
  v_mov_b64 v[16:17], 0
  s_mov_b64 vcc, -1
  s_waitcnt vmcnt(12)
.p2align 6
re_p1:
  v_mfma_f32_16x16x32_bf16 v[16:19], a[144:147], a[176:179], v[16:19]
  ds_read_b64_tr_b16 a[160:161], v5 offset:128
  v_mfma_f32_16x16x32_bf16 v[24:27], a[144:147], a[180:183], v[24:27]
  ds_read_b64_tr_b16 a[162:163], v5 offset:6272
  v_mfma_f32_16x16x32_bf16 v[32:35], a[144:147], a[184:187], v[32:35]
  v_mfma_f32_16x16x32_bf16 v[40:43], a[144:147], a[188:191], v[40:43]
  ds_read_b64_tr_b16 a[164:165], v5 offset:136
  s_waitcnt lgkmcnt(7)
  v_mfma_f32_16x16x32_bf16 v[20:23], a[148:151], a[176:179], v[20:23]
  ds_read_b64_tr_b16 a[166:167], v5 offset:6280
  v_mfma_f32_16x16x32_bf16 v[28:31], a[148:151], a[180:183], v[28:31]
  buffer_load_dwordx4 a[240:243], v0, s[16:19], s52 offen offset:0 sc1
  v_mfma_f32_16x16x32_bf16 v[36:39], a[148:151], a[184:187], v[36:39]
  ds_read_b64_tr_b16 a[168:169], v6 offset:128
  v_mfma_f32_16x16x32_bf16 v[44:47], a[148:151], a[188:191], v[44:47]
  ds_read_b64_tr_b16 a[170:171], v6 offset:6272
  s_waitcnt lgkmcnt(8)
  v_mfma_f32_16x16x32_bf16 v[48:51], a[152:155], a[176:179], v[48:51]
  v_mfma_f32_16x16x32_bf16 v[56:59], a[152:155], a[180:183], v[56:59]
  ds_read_b64_tr_b16 a[172:173], v6 offset:136
  v_mfma_f32_16x16x32_bf16 v[64:67], a[152:155], a[184:187], v[64:67]
  ds_read_b64_tr_b16 a[174:175], v6 offset:6280
  v_mfma_f32_16x16x32_bf16 v[72:75], a[152:155], a[188:191], v[72:75]
  buffer_load_dwordx4 a[244:247], v0, s[16:19], s52 offen offset:1024 sc1
  s_waitcnt lgkmcnt(8)
  v_mfma_f32_16x16x32_bf16 v[52:55], a[156:159], a[176:179], v[52:55]
  ds_read_b64_tr_b16 a[144:145], v5 offset:256
  v_mfma_f32_16x16x32_bf16 v[60:63], a[156:159], a[180:183], v[60:63]
  ds_read_b64_tr_b16 a[146:147], v5 offset:6400
  v_mfma_f32_16x16x32_bf16 v[68:71], a[156:159], a[184:187], v[68:71]
  v_mfma_f32_16x16x32_bf16 v[76:79], a[156:159], a[188:191], v[76:79]
  ds_read_b64_tr_b16 a[148:149], v5 offset:264
  s_waitcnt lgkmcnt(9)
  v_mfma_f32_16x16x32_bf16 v[80:83], a[160:163], a[176:179], v[80:83]
  ds_read_b64_tr_b16 a[150:151], v5 offset:6408
  v_mfma_f32_16x16x32_bf16 v[88:91], a[160:163], a[180:183], v[88:91]
  buffer_load_dwordx4 a[248:251], v0, s[16:19], s53 offen offset:0 sc1
  v_mfma_f32_16x16x32_bf16 v[96:99], a[160:163], a[184:187], v[96:99]
  ds_read_b64_tr_b16 a[152:153], v6 offset:256
  v_mfma_f32_16x16x32_bf16 v[104:107], a[160:163], a[188:191], v[104:107]
  ds_read_b64_tr_b16 a[154:155], v6 offset:6400
  s_waitcnt lgkmcnt(10)
  v_mfma_f32_16x16x32_bf16 v[84:87], a[164:167], a[176:179], v[84:87]
  s_add_u32 s52, s52, 4096
  v_mfma_f32_16x16x32_bf16 v[92:95], a[164:167], a[180:183], v[92:95]
  ds_read_b64_tr_b16 a[156:157], v6 offset:264
  v_mfma_f32_16x16x32_bf16 v[100:103], a[164:167], a[184:187], v[100:103]
  ds_read_b64_tr_b16 a[158:159], v6 offset:6408
  v_mfma_f32_16x16x32_bf16 v[108:111], a[164:167], a[188:191], v[108:111]
  buffer_load_dwordx4 a[252:255], v0, s[16:19], s53 offen offset:1024 sc1
  s_waitcnt lgkmcnt(10)
  v_mfma_f32_16x16x32_bf16 v[112:115], a[168:171], a[176:179], v[112:115]
  ds_read_b64_tr_b16 a[160:161], v7 offset:0
  v_mfma_f32_16x16x32_bf16 v[120:123], a[168:171], a[180:183], v[120:123]
  ds_read_b64_tr_b16 a[162:163], v7 offset:2048
  v_mfma_f32_16x16x32_bf16 v[128:131], a[168:171], a[184:187], v[128:131]
  s_add_u32 s53, s53, 4096
  v_mfma_f32_16x16x32_bf16 v[136:139], a[168:171], a[188:191], v[136:139]
  ds_read_b64_tr_b16 a[164:165], v15 offset:0
  s_waitcnt lgkmcnt(11)
  v_mfma_f32_16x16x32_bf16 v[116:119], a[172:175], a[176:179], v[116:119]
  ds_read_b64_tr_b16 a[166:167], v15 offset:2048
  v_mfma_f32_16x16x32_bf16 v[124:127], a[172:175], a[180:183], v[124:127]
  v_mfma_f32_16x16x32_bf16 v[132:135], a[172:175], a[184:187], v[132:135]
  ds_read_b64_tr_b16 a[168:169], v7 offset:512
  v_mfma_f32_16x16x32_bf16 v[140:143], a[172:175], a[188:191], v[140:143]
  ds_read_b64_tr_b16 a[170:171], v7 offset:2560
  s_waitcnt lgkmcnt(12)
  v_mfma_f32_16x16x32_bf16 v[144:147], a[144:147], a[176:179], v[144:147]
  v_mfma_f32_16x16x32_bf16 v[152:155], a[144:147], a[180:183], v[152:155]
  ds_read_b64_tr_b16 a[172:173], v15 offset:512
  v_mfma_f32_16x16x32_bf16 v[160:163], a[144:147], a[184:187], v[160:163]
  ds_read_b64_tr_b16 a[174:175], v15 offset:2560
  v_mfma_f32_16x16x32_bf16 v[168:171], a[144:147], a[188:191], v[168:171]
  s_add_u32 s41, s33, s37
  s_waitcnt lgkmcnt(12)
  v_mfma_f32_16x16x32_bf16 v[148:151], a[148:151], a[176:179], v[148:151]
  s_add_u32 m0, s41, 65536
  v_mfma_f32_16x16x32_bf16 v[156:159], a[148:151], a[180:183], v[156:159]
  buffer_load_dwordx4 v8, s[20:23], s37 offen offset:0 lds
  v_mfma_f32_16x16x32_bf16 v[164:167], a[148:151], a[184:187], v[164:167]
  v_mfma_f32_16x16x32_bf16 v[172:175], a[148:151], a[188:191], v[172:175]
  s_waitcnt lgkmcnt(10)
  v_mfma_f32_16x16x32_bf16 v[176:179], a[152:155], a[176:179], v[176:179]
  v_mfma_f32_16x16x32_bf16 v[184:187], a[152:155], a[180:183], v[184:187]
  buffer_load_dwordx4 v9, s[20:23], s37 offen offset:1024 lds
  v_mfma_f32_16x16x32_bf16 v[192:195], a[152:155], a[184:187], v[192:195]
  v_mfma_f32_16x16x32_bf16 v[200:203], a[152:155], a[188:191], v[200:203]
  s_waitcnt lgkmcnt(8)
  v_mfma_f32_16x16x32_bf16 v[180:183], a[156:159], a[176:179], v[180:183]
  v_mfma_f32_16x16x32_bf16 v[188:191], a[156:159], a[180:183], v[188:191]
  buffer_load_dwordx4 v10, s[20:23], s37 offen offset:2048 lds
  v_mfma_f32_16x16x32_bf16 v[196:199], a[156:159], a[184:187], v[196:199]
  s_add_u32 m0, s33, 0
  v_mfma_f32_16x16x32_bf16 v[204:207], a[156:159], a[188:191], v[204:207]
  s_waitcnt vmcnt(34) lgkmcnt(0)
  s_barrier
  v_mfma_f32_16x16x32_bf16 v[208:211], a[160:163], a[176:179], v[208:211]
  ds_read_b64_tr_b16 a[144:145], v5 offset:16384
  v_mfma_f32_16x16x32_bf16 v[212:215], a[160:163], a[180:183], v[212:215]
  ds_read_b64_tr_b16 a[146:147], v5 offset:22528
  v_mfma_f32_16x16x32_bf16 v[216:219], a[160:163], a[184:187], v[216:219]
  buffer_load_dwordx4 v1, s[8:11], s35 offen offset:0 lds
  v_mfma_f32_16x16x32_bf16 v[220:223], a[160:163], a[188:191], v[220:223]
  ds_read_b64_tr_b16 a[148:149], v5 offset:16392
  v_mfma_f32_16x16x32_bf16 v[224:227], a[164:167], a[176:179], v[224:227]
  ds_read_b64_tr_b16 a[150:151], v5 offset:22536
  v_mfma_f32_16x16x32_bf16 v[228:231], a[164:167], a[180:183], v[228:231]
  buffer_load_dwordx4 v2, s[8:11], s35 offen offset:1024 lds
  v_mfma_f32_16x16x32_bf16 v[232:235], a[164:167], a[184:187], v[232:235]
  ds_read_b64_tr_b16 a[152:153], v6 offset:16384
  v_mfma_f32_16x16x32_bf16 v[236:239], a[164:167], a[188:191], v[236:239]
  ds_read_b64_tr_b16 a[154:155], v6 offset:22528
  s_cbranch_vccnz re_p1w0x
re_p1w0b:
  v_mfma_f32_16x16x32_bf16 v[240:243], a[168:171], a[176:179], v[240:243]
  buffer_load_dwordx4 v3, s[8:11], s35 offen offset:2048 lds
  v_mfma_f32_16x16x32_bf16 v[248:251], a[168:171], a[180:183], v[248:251]
  ds_read_b64_tr_b16 a[156:157], v6 offset:16392
  s_add_u32 m0, s34, 0
  v_mfma_f32_16x16x32_bf16 v[244:247], a[172:175], a[176:179], v[244:247]
  ds_read_b64_tr_b16 a[158:159], v6 offset:22536
  s_add_u32 s35, s35, 393216
  v_mfma_f32_16x16x32_bf16 v[252:255], a[172:175], a[180:183], v[252:255]
  buffer_load_dwordx4 v4, s[12:15], s36 offen lds
  s_add_u32 s36, s36, 98304
  s_waitcnt vmcnt(34) lgkmcnt(6)
  v_mfma_f32_16x16x32_bf16 v[16:19], a[144:147], a[192:195], v[16:19]
  ds_read_b64_tr_b16 a[160:161], v5 offset:16512
  v_mfma_f32_16x16x32_bf16 v[24:27], a[144:147], a[196:199], v[24:27]
  ds_read_b64_tr_b16 a[162:163], v5 offset:22656
  v_mfma_f32_16x16x32_bf16 v[32:35], a[144:147], a[200:203], v[32:35]
  v_mfma_f32_16x16x32_bf16 v[40:43], a[144:147], a[204:207], v[40:43]
  ds_read_b64_tr_b16 a[164:165], v5 offset:16520
  s_waitcnt lgkmcnt(7)
  v_mfma_f32_16x16x32_bf16 v[20:23], a[148:151], a[192:195], v[20:23]
  ds_read_b64_tr_b16 a[166:167], v5 offset:22664
  v_mfma_f32_16x16x32_bf16 v[28:31], a[148:151], a[196:199], v[28:31]
  buffer_load_dwordx4 a[176:179], v0, s[16:19], s52 offen offset:0 sc1
  v_mfma_f32_16x16x32_bf16 v[36:39], a[148:151], a[200:203], v[36:39]
  ds_read_b64_tr_b16 a[168:169], v6 offset:16512
  v_mfma_f32_16x16x32_bf16 v[44:47], a[148:151], a[204:207], v[44:47]
  ds_read_b64_tr_b16 a[170:171], v6 offset:22656
  s_waitcnt lgkmcnt(8)
  v_mfma_f32_16x16x32_bf16 v[48:51], a[152:155], a[192:195], v[48:51]
  v_mfma_f32_16x16x32_bf16 v[56:59], a[152:155], a[196:199], v[56:59]
  ds_read_b64_tr_b16 a[172:173], v6 offset:16520
  v_mfma_f32_16x16x32_bf16 v[64:67], a[152:155], a[200:203], v[64:67]
  ds_read_b64_tr_b16 a[174:175], v6 offset:22664
  v_mfma_f32_16x16x32_bf16 v[72:75], a[152:155], a[204:207], v[72:75]
  buffer_load_dwordx4 a[180:183], v0, s[16:19], s52 offen offset:1024 sc1
  s_waitcnt lgkmcnt(8)
  v_mfma_f32_16x16x32_bf16 v[52:55], a[156:159], a[192:195], v[52:55]
  ds_read_b64_tr_b16 a[144:145], v5 offset:16640
  v_mfma_f32_16x16x32_bf16 v[60:63], a[156:159], a[196:199], v[60:63]
  ds_read_b64_tr_b16 a[146:147], v5 offset:22784
  v_mfma_f32_16x16x32_bf16 v[68:71], a[156:159], a[200:203], v[68:71]
  v_mfma_f32_16x16x32_bf16 v[76:79], a[156:159], a[204:207], v[76:79]
  ds_read_b64_tr_b16 a[148:149], v5 offset:16648
  s_waitcnt lgkmcnt(9)
  v_mfma_f32_16x16x32_bf16 v[80:83], a[160:163], a[192:195], v[80:83]
  ds_read_b64_tr_b16 a[150:151], v5 offset:22792
  v_mfma_f32_16x16x32_bf16 v[88:91], a[160:163], a[196:199], v[88:91]
  buffer_load_dwordx4 a[184:187], v0, s[16:19], s53 offen offset:0 sc1
  v_mfma_f32_16x16x32_bf16 v[96:99], a[160:163], a[200:203], v[96:99]
  ds_read_b64_tr_b16 a[152:153], v6 offset:16640
  v_mfma_f32_16x16x32_bf16 v[104:107], a[160:163], a[204:207], v[104:107]
  ds_read_b64_tr_b16 a[154:155], v6 offset:22784
  s_waitcnt lgkmcnt(10)
  v_mfma_f32_16x16x32_bf16 v[84:87], a[164:167], a[192:195], v[84:87]
  s_add_u32 s52, s52, 4096
  v_mfma_f32_16x16x32_bf16 v[92:95], a[164:167], a[196:199], v[92:95]
  ds_read_b64_tr_b16 a[156:157], v6 offset:16648
  v_mfma_f32_16x16x32_bf16 v[100:103], a[164:167], a[200:203], v[100:103]
  ds_read_b64_tr_b16 a[158:159], v6 offset:22792
  v_mfma_f32_16x16x32_bf16 v[108:111], a[164:167], a[204:207], v[108:111]
  buffer_load_dwordx4 a[188:191], v0, s[16:19], s53 offen offset:1024 sc1
  s_waitcnt lgkmcnt(10)
  v_mfma_f32_16x16x32_bf16 v[112:115], a[168:171], a[192:195], v[112:115]
  ds_read_b64_tr_b16 a[160:161], v7 offset:16384
  v_mfma_f32_16x16x32_bf16 v[120:123], a[168:171], a[196:199], v[120:123]
  ds_read_b64_tr_b16 a[162:163], v7 offset:18432
  v_mfma_f32_16x16x32_bf16 v[128:131], a[168:171], a[200:203], v[128:131]
  s_add_u32 s53, s53, 4096
  v_mfma_f32_16x16x32_bf16 v[136:139], a[168:171], a[204:207], v[136:139]
  ds_read_b64_tr_b16 a[164:165], v15 offset:16384
  s_waitcnt lgkmcnt(11)
  v_mfma_f32_16x16x32_bf16 v[116:119], a[172:175], a[192:195], v[116:119]
  ds_read_b64_tr_b16 a[166:167], v15 offset:18432
  v_mfma_f32_16x16x32_bf16 v[124:127], a[172:175], a[196:199], v[124:127]
  v_mfma_f32_16x16x32_bf16 v[132:135], a[172:175], a[200:203], v[132:135]
  ds_read_b64_tr_b16 a[168:169], v7 offset:16896
  v_mfma_f32_16x16x32_bf16 v[140:143], a[172:175], a[204:207], v[140:143]
  ds_read_b64_tr_b16 a[170:171], v7 offset:18944
  s_waitcnt lgkmcnt(12)
  v_mfma_f32_16x16x32_bf16 v[144:147], a[144:147], a[192:195], v[144:147]
  v_mfma_f32_16x16x32_bf16 v[152:155], a[144:147], a[196:199], v[152:155]
  ds_read_b64_tr_b16 a[172:173], v15 offset:16896
  v_mfma_f32_16x16x32_bf16 v[160:163], a[144:147], a[200:203], v[160:163]
  ds_read_b64_tr_b16 a[174:175], v15 offset:18944
  v_mfma_f32_16x16x32_bf16 v[168:171], a[144:147], a[204:207], v[168:171]
  s_waitcnt lgkmcnt(12)
  v_mfma_f32_16x16x32_bf16 v[148:151], a[148:151], a[192:195], v[148:151]
  v_mfma_f32_16x16x32_bf16 v[156:159], a[148:151], a[196:199], v[156:159]
  v_mfma_f32_16x16x32_bf16 v[164:167], a[148:151], a[200:203], v[164:167]
  v_mfma_f32_16x16x32_bf16 v[172:175], a[148:151], a[204:207], v[172:175]
  s_waitcnt lgkmcnt(10)
  v_mfma_f32_16x16x32_bf16 v[176:179], a[152:155], a[192:195], v[176:179]
  v_mfma_f32_16x16x32_bf16 v[184:187], a[152:155], a[196:199], v[184:187]
  v_mfma_f32_16x16x32_bf16 v[192:195], a[152:155], a[200:203], v[192:195]
  v_mfma_f32_16x16x32_bf16 v[200:203], a[152:155], a[204:207], v[200:203]
  s_waitcnt lgkmcnt(8)
  v_mfma_f32_16x16x32_bf16 v[180:183], a[156:159], a[192:195], v[180:183]
  v_mfma_f32_16x16x32_bf16 v[188:191], a[156:159], a[196:199], v[188:191]
  v_mfma_f32_16x16x32_bf16 v[196:199], a[156:159], a[200:203], v[196:199]
  s_add_u32 m0, s33, 16384
  v_mfma_f32_16x16x32_bf16 v[204:207], a[156:159], a[204:207], v[204:207]
  s_waitcnt vmcnt(31) lgkmcnt(0)
  s_barrier
  v_mfma_f32_16x16x32_bf16 v[208:211], a[160:163], a[192:195], v[208:211]
  ds_read_b64_tr_b16 a[144:145], v5 offset:32768
  v_mfma_f32_16x16x32_bf16 v[212:215], a[160:163], a[196:199], v[212:215]
  ds_read_b64_tr_b16 a[146:147], v5 offset:38912
  v_mfma_f32_16x16x32_bf16 v[216:219], a[160:163], a[200:203], v[216:219]
  buffer_load_dwordx4 v1, s[8:11], s35 offen offset:0 lds
  v_mfma_f32_16x16x32_bf16 v[220:223], a[160:163], a[204:207], v[220:223]
  ds_read_b64_tr_b16 a[148:149], v5 offset:32776
  v_mfma_f32_16x16x32_bf16 v[224:227], a[164:167], a[192:195], v[224:227]
  ds_read_b64_tr_b16 a[150:151], v5 offset:38920
  v_mfma_f32_16x16x32_bf16 v[228:231], a[164:167], a[196:199], v[228:231]
  buffer_load_dwordx4 v2, s[8:11], s35 offen offset:1024 lds
  v_mfma_f32_16x16x32_bf16 v[232:235], a[164:167], a[200:203], v[232:235]
  ds_read_b64_tr_b16 a[152:153], v6 offset:32768
  v_mfma_f32_16x16x32_bf16 v[236:239], a[164:167], a[204:207], v[236:239]
  ds_read_b64_tr_b16 a[154:155], v6 offset:38912
  s_cbranch_vccnz re_p1w1x
re_p1w1b:
  v_mfma_f32_16x16x32_bf16 v[240:243], a[168:171], a[192:195], v[240:243]
  buffer_load_dwordx4 v3, s[8:11], s35 offen offset:2048 lds
  v_mfma_f32_16x16x32_bf16 v[248:251], a[168:171], a[196:199], v[248:251]
  ds_read_b64_tr_b16 a[156:157], v6 offset:32776
  s_add_u32 m0, s34, 16384
  v_mfma_f32_16x16x32_bf16 v[244:247], a[172:175], a[192:195], v[244:247]
  ds_read_b64_tr_b16 a[158:159], v6 offset:38920
  s_add_u32 s35, s35, 393216
  v_mfma_f32_16x16x32_bf16 v[252:255], a[172:175], a[196:199], v[252:255]
  buffer_load_dwordx4 v4, s[12:15], s36 offen lds
  s_add_u32 s36, s36, 98304
  s_waitcnt vmcnt(31) lgkmcnt(6)
  v_mfma_f32_16x16x32_bf16 v[16:19], a[144:147], a[208:211], v[16:19]
  ds_read_b64_tr_b16 a[160:161], v5 offset:32896
  v_mfma_f32_16x16x32_bf16 v[24:27], a[144:147], a[212:215], v[24:27]
  ds_read_b64_tr_b16 a[162:163], v5 offset:39040
  v_mfma_f32_16x16x32_bf16 v[32:35], a[144:147], a[216:219], v[32:35]
  v_mfma_f32_16x16x32_bf16 v[40:43], a[144:147], a[220:223], v[40:43]
  ds_read_b64_tr_b16 a[164:165], v5 offset:32904
  s_waitcnt lgkmcnt(7)
  v_mfma_f32_16x16x32_bf16 v[20:23], a[148:151], a[208:211], v[20:23]
  ds_read_b64_tr_b16 a[166:167], v5 offset:39048
  v_mfma_f32_16x16x32_bf16 v[28:31], a[148:151], a[212:215], v[28:31]
  buffer_load_dwordx4 a[192:195], v0, s[16:19], s52 offen offset:0 sc1
  v_mfma_f32_16x16x32_bf16 v[36:39], a[148:151], a[216:219], v[36:39]
  ds_read_b64_tr_b16 a[168:169], v6 offset:32896
  v_mfma_f32_16x16x32_bf16 v[44:47], a[148:151], a[220:223], v[44:47]
  ds_read_b64_tr_b16 a[170:171], v6 offset:39040
  s_waitcnt lgkmcnt(8)
  v_mfma_f32_16x16x32_bf16 v[48:51], a[152:155], a[208:211], v[48:51]
  v_mfma_f32_16x16x32_bf16 v[56:59], a[152:155], a[212:215], v[56:59]
  ds_read_b64_tr_b16 a[172:173], v6 offset:32904
  v_mfma_f32_16x16x32_bf16 v[64:67], a[152:155], a[216:219], v[64:67]
  ds_read_b64_tr_b16 a[174:175], v6 offset:39048
  v_mfma_f32_16x16x32_bf16 v[72:75], a[152:155], a[220:223], v[72:75]
  buffer_load_dwordx4 a[196:199], v0, s[16:19], s52 offen offset:1024 sc1
  s_waitcnt lgkmcnt(8)
  v_mfma_f32_16x16x32_bf16 v[52:55], a[156:159], a[208:211], v[52:55]
  ds_read_b64_tr_b16 a[144:145], v5 offset:33024
  v_mfma_f32_16x16x32_bf16 v[60:63], a[156:159], a[212:215], v[60:63]
  ds_read_b64_tr_b16 a[146:147], v5 offset:39168
  v_mfma_f32_16x16x32_bf16 v[68:71], a[156:159], a[216:219], v[68:71]
  v_mfma_f32_16x16x32_bf16 v[76:79], a[156:159], a[220:223], v[76:79]
  ds_read_b64_tr_b16 a[148:149], v5 offset:33032
  s_waitcnt lgkmcnt(9)
  v_mfma_f32_16x16x32_bf16 v[80:83], a[160:163], a[208:211], v[80:83]
  ds_read_b64_tr_b16 a[150:151], v5 offset:39176
  v_mfma_f32_16x16x32_bf16 v[88:91], a[160:163], a[212:215], v[88:91]
  buffer_load_dwordx4 a[200:203], v0, s[16:19], s53 offen offset:0 sc1
  v_mfma_f32_16x16x32_bf16 v[96:99], a[160:163], a[216:219], v[96:99]
  ds_read_b64_tr_b16 a[152:153], v6 offset:33024
  v_mfma_f32_16x16x32_bf16 v[104:107], a[160:163], a[220:223], v[104:107]
  ds_read_b64_tr_b16 a[154:155], v6 offset:39168
  s_waitcnt lgkmcnt(10)
  v_mfma_f32_16x16x32_bf16 v[84:87], a[164:167], a[208:211], v[84:87]
  s_add_u32 s52, s52, 4096
  v_mfma_f32_16x16x32_bf16 v[92:95], a[164:167], a[212:215], v[92:95]
  ds_read_b64_tr_b16 a[156:157], v6 offset:33032
  v_mfma_f32_16x16x32_bf16 v[100:103], a[164:167], a[216:219], v[100:103]
  ds_read_b64_tr_b16 a[158:159], v6 offset:39176
  v_mfma_f32_16x16x32_bf16 v[108:111], a[164:167], a[220:223], v[108:111]
  buffer_load_dwordx4 a[204:207], v0, s[16:19], s53 offen offset:1024 sc1
  s_waitcnt lgkmcnt(10)
  v_mfma_f32_16x16x32_bf16 v[112:115], a[168:171], a[208:211], v[112:115]
  ds_read_b64_tr_b16 a[160:161], v7 offset:32768
  v_mfma_f32_16x16x32_bf16 v[120:123], a[168:171], a[212:215], v[120:123]
  ds_read_b64_tr_b16 a[162:163], v7 offset:34816
  v_mfma_f32_16x16x32_bf16 v[128:131], a[168:171], a[216:219], v[128:131]
  s_add_u32 s53, s53, 4096
  v_mfma_f32_16x16x32_bf16 v[136:139], a[168:171], a[220:223], v[136:139]
  ds_read_b64_tr_b16 a[164:165], v15 offset:32768
  s_waitcnt lgkmcnt(11)
  v_mfma_f32_16x16x32_bf16 v[116:119], a[172:175], a[208:211], v[116:119]
  ds_read_b64_tr_b16 a[166:167], v15 offset:34816
  v_mfma_f32_16x16x32_bf16 v[124:127], a[172:175], a[212:215], v[124:127]
  v_mfma_f32_16x16x32_bf16 v[132:135], a[172:175], a[216:219], v[132:135]
  ds_read_b64_tr_b16 a[168:169], v7 offset:33280
  v_mfma_f32_16x16x32_bf16 v[140:143], a[172:175], a[220:223], v[140:143]
  ds_read_b64_tr_b16 a[170:171], v7 offset:35328
  s_waitcnt lgkmcnt(12)
  v_mfma_f32_16x16x32_bf16 v[144:147], a[144:147], a[208:211], v[144:147]
  v_mfma_f32_16x16x32_bf16 v[152:155], a[144:147], a[212:215], v[152:155]
  ds_read_b64_tr_b16 a[172:173], v15 offset:33280
  v_mfma_f32_16x16x32_bf16 v[160:163], a[144:147], a[216:219], v[160:163]
  ds_read_b64_tr_b16 a[174:175], v15 offset:35328
  v_mfma_f32_16x16x32_bf16 v[168:171], a[144:147], a[220:223], v[168:171]
  s_add_u32 s41, s33, s38
  s_waitcnt lgkmcnt(12)
  v_mfma_f32_16x16x32_bf16 v[148:151], a[148:151], a[208:211], v[148:151]
  s_add_u32 m0, s41, 114688
  v_mfma_f32_16x16x32_bf16 v[156:159], a[148:151], a[212:215], v[156:159]
  buffer_load_dwordx4 v11, s[24:27], s38 offen offset:0 lds
  v_mfma_f32_16x16x32_bf16 v[164:167], a[148:151], a[216:219], v[164:167]
  v_mfma_f32_16x16x32_bf16 v[172:175], a[148:151], a[220:223], v[172:175]
  s_waitcnt lgkmcnt(10)
  v_mfma_f32_16x16x32_bf16 v[176:179], a[152:155], a[208:211], v[176:179]
  v_mfma_f32_16x16x32_bf16 v[184:187], a[152:155], a[212:215], v[184:187]
  buffer_load_dwordx4 v12, s[24:27], s38 offen offset:1024 lds
  v_mfma_f32_16x16x32_bf16 v[192:195], a[152:155], a[216:219], v[192:195]
  v_mfma_f32_16x16x32_bf16 v[200:203], a[152:155], a[220:223], v[200:203]
  s_waitcnt lgkmcnt(8)
  v_mfma_f32_16x16x32_bf16 v[180:183], a[156:159], a[208:211], v[180:183]
  v_mfma_f32_16x16x32_bf16 v[188:191], a[156:159], a[212:215], v[188:191]
  buffer_load_dwordx4 v13, s[24:27], s38 offen offset:2048 lds
  v_mfma_f32_16x16x32_bf16 v[196:199], a[156:159], a[216:219], v[196:199]
  s_add_u32 m0, s33, 32768
  v_mfma_f32_16x16x32_bf16 v[204:207], a[156:159], a[220:223], v[204:207]
  s_waitcnt vmcnt(34) lgkmcnt(0)
  s_barrier
  v_mfma_f32_16x16x32_bf16 v[208:211], a[160:163], a[208:211], v[208:211]
  ds_read_b64_tr_b16 a[144:145], v5 offset:49152
  v_mfma_f32_16x16x32_bf16 v[212:215], a[160:163], a[212:215], v[212:215]
  ds_read_b64_tr_b16 a[146:147], v5 offset:55296
  v_mfma_f32_16x16x32_bf16 v[216:219], a[160:163], a[216:219], v[216:219]
  buffer_load_dwordx4 v1, s[8:11], s35 offen offset:0 lds
  v_mfma_f32_16x16x32_bf16 v[220:223], a[160:163], a[220:223], v[220:223]
  ds_read_b64_tr_b16 a[148:149], v5 offset:49160
  v_mfma_f32_16x16x32_bf16 v[224:227], a[164:167], a[208:211], v[224:227]
  ds_read_b64_tr_b16 a[150:151], v5 offset:55304
  v_mfma_f32_16x16x32_bf16 v[228:231], a[164:167], a[212:215], v[228:231]
  buffer_load_dwordx4 v2, s[8:11], s35 offen offset:1024 lds
  v_mfma_f32_16x16x32_bf16 v[232:235], a[164:167], a[216:219], v[232:235]
  ds_read_b64_tr_b16 a[152:153], v6 offset:49152
  v_mfma_f32_16x16x32_bf16 v[236:239], a[164:167], a[220:223], v[236:239]
  ds_read_b64_tr_b16 a[154:155], v6 offset:55296
  s_cbranch_vccnz re_p1w2x
re_p1w2b:
  v_mfma_f32_16x16x32_bf16 v[240:243], a[168:171], a[208:211], v[240:243]
  buffer_load_dwordx4 v3, s[8:11], s35 offen offset:2048 lds
  v_mfma_f32_16x16x32_bf16 v[248:251], a[168:171], a[212:215], v[248:251]
  ds_read_b64_tr_b16 a[156:157], v6 offset:49160
  s_add_u32 m0, s34, 32768
  v_mfma_f32_16x16x32_bf16 v[244:247], a[172:175], a[208:211], v[244:247]
  ds_read_b64_tr_b16 a[158:159], v6 offset:55304
  s_add_u32 s35, s35, 393216
  v_mfma_f32_16x16x32_bf16 v[252:255], a[172:175], a[212:215], v[252:255]
  buffer_load_dwordx4 v4, s[12:15], s36 offen lds
  s_add_u32 s36, s36, 98304
  s_waitcnt vmcnt(34) lgkmcnt(6)
  v_mfma_f32_16x16x32_bf16 v[16:19], a[144:147], a[224:227], v[16:19]
  ds_read_b64_tr_b16 a[160:161], v5 offset:49280
  v_mfma_f32_16x16x32_bf16 v[24:27], a[144:147], a[228:231], v[24:27]
  ds_read_b64_tr_b16 a[162:163], v5 offset:55424
  v_mfma_f32_16x16x32_bf16 v[32:35], a[144:147], a[232:235], v[32:35]
  v_mfma_f32_16x16x32_bf16 v[40:43], a[144:147], a[236:239], v[40:43]
  ds_read_b64_tr_b16 a[164:165], v5 offset:49288
  s_waitcnt lgkmcnt(7)
  v_mfma_f32_16x16x32_bf16 v[20:23], a[148:151], a[224:227], v[20:23]
  ds_read_b64_tr_b16 a[166:167], v5 offset:55432
  v_mfma_f32_16x16x32_bf16 v[28:31], a[148:151], a[228:231], v[28:31]
  buffer_load_dwordx4 a[208:211], v0, s[16:19], s52 offen offset:0 sc1
  v_mfma_f32_16x16x32_bf16 v[36:39], a[148:151], a[232:235], v[36:39]
  ds_read_b64_tr_b16 a[168:169], v6 offset:49280
  v_mfma_f32_16x16x32_bf16 v[44:47], a[148:151], a[236:239], v[44:47]
  ds_read_b64_tr_b16 a[170:171], v6 offset:55424
  s_waitcnt lgkmcnt(8)
  v_mfma_f32_16x16x32_bf16 v[48:51], a[152:155], a[224:227], v[48:51]
  v_mfma_f32_16x16x32_bf16 v[56:59], a[152:155], a[228:231], v[56:59]
  ds_read_b64_tr_b16 a[172:173], v6 offset:49288
  v_mfma_f32_16x16x32_bf16 v[64:67], a[152:155], a[232:235], v[64:67]
  ds_read_b64_tr_b16 a[174:175], v6 offset:55432
  v_mfma_f32_16x16x32_bf16 v[72:75], a[152:155], a[236:239], v[72:75]
  buffer_load_dwordx4 a[212:215], v0, s[16:19], s52 offen offset:1024 sc1
  s_waitcnt lgkmcnt(8)
  v_mfma_f32_16x16x32_bf16 v[52:55], a[156:159], a[224:227], v[52:55]
  ds_read_b64_tr_b16 a[144:145], v5 offset:49408
  v_mfma_f32_16x16x32_bf16 v[60:63], a[156:159], a[228:231], v[60:63]
  ds_read_b64_tr_b16 a[146:147], v5 offset:55552
  v_mfma_f32_16x16x32_bf16 v[68:71], a[156:159], a[232:235], v[68:71]
  v_mfma_f32_16x16x32_bf16 v[76:79], a[156:159], a[236:239], v[76:79]
  ds_read_b64_tr_b16 a[148:149], v5 offset:49416
  s_waitcnt lgkmcnt(9)
  v_mfma_f32_16x16x32_bf16 v[80:83], a[160:163], a[224:227], v[80:83]
  ds_read_b64_tr_b16 a[150:151], v5 offset:55560
  v_mfma_f32_16x16x32_bf16 v[88:91], a[160:163], a[228:231], v[88:91]
  buffer_load_dwordx4 a[216:219], v0, s[16:19], s53 offen offset:0 sc1
  v_mfma_f32_16x16x32_bf16 v[96:99], a[160:163], a[232:235], v[96:99]
  ds_read_b64_tr_b16 a[152:153], v6 offset:49408
  v_mfma_f32_16x16x32_bf16 v[104:107], a[160:163], a[236:239], v[104:107]
  ds_read_b64_tr_b16 a[154:155], v6 offset:55552
  s_waitcnt lgkmcnt(10)
  v_mfma_f32_16x16x32_bf16 v[84:87], a[164:167], a[224:227], v[84:87]
  s_add_u32 s52, s52, 4096
  v_mfma_f32_16x16x32_bf16 v[92:95], a[164:167], a[228:231], v[92:95]
  ds_read_b64_tr_b16 a[156:157], v6 offset:49416
  v_mfma_f32_16x16x32_bf16 v[100:103], a[164:167], a[232:235], v[100:103]
  ds_read_b64_tr_b16 a[158:159], v6 offset:55560
  v_mfma_f32_16x16x32_bf16 v[108:111], a[164:167], a[236:239], v[108:111]
  buffer_load_dwordx4 a[220:223], v0, s[16:19], s53 offen offset:1024 sc1
  s_waitcnt lgkmcnt(10)
  v_mfma_f32_16x16x32_bf16 v[112:115], a[168:171], a[224:227], v[112:115]
  ds_read_b64_tr_b16 a[160:161], v7 offset:49152
  v_mfma_f32_16x16x32_bf16 v[120:123], a[168:171], a[228:231], v[120:123]
  ds_read_b64_tr_b16 a[162:163], v7 offset:51200
  v_mfma_f32_16x16x32_bf16 v[128:131], a[168:171], a[232:235], v[128:131]
  s_add_u32 s53, s53, 4096
  v_mfma_f32_16x16x32_bf16 v[136:139], a[168:171], a[236:239], v[136:139]
  ds_read_b64_tr_b16 a[164:165], v15 offset:49152
  s_waitcnt lgkmcnt(11)
  v_mfma_f32_16x16x32_bf16 v[116:119], a[172:175], a[224:227], v[116:119]
  ds_read_b64_tr_b16 a[166:167], v15 offset:51200
  v_mfma_f32_16x16x32_bf16 v[124:127], a[172:175], a[228:231], v[124:127]
  v_mfma_f32_16x16x32_bf16 v[132:135], a[172:175], a[232:235], v[132:135]
  ds_read_b64_tr_b16 a[168:169], v7 offset:49664
  v_mfma_f32_16x16x32_bf16 v[140:143], a[172:175], a[236:239], v[140:143]
  ds_read_b64_tr_b16 a[170:171], v7 offset:51712
  s_waitcnt lgkmcnt(12)
  v_mfma_f32_16x16x32_bf16 v[144:147], a[144:147], a[224:227], v[144:147]
  v_mfma_f32_16x16x32_bf16 v[152:155], a[144:147], a[228:231], v[152:155]
  ds_read_b64_tr_b16 a[172:173], v15 offset:49664
  v_mfma_f32_16x16x32_bf16 v[160:163], a[144:147], a[232:235], v[160:163]
  ds_read_b64_tr_b16 a[174:175], v15 offset:51712
  v_mfma_f32_16x16x32_bf16 v[168:171], a[144:147], a[236:239], v[168:171]
  s_waitcnt lgkmcnt(12)
  v_mfma_f32_16x16x32_bf16 v[148:151], a[148:151], a[224:227], v[148:151]
  v_mfma_f32_16x16x32_bf16 v[156:159], a[148:151], a[228:231], v[156:159]
  v_add_u32 v5, 139264, v5
  v_mfma_f32_16x16x32_bf16 v[164:167], a[148:151], a[232:235], v[164:167]
  v_mfma_f32_16x16x32_bf16 v[172:175], a[148:151], a[236:239], v[172:175]
  v_add_u32 v6, 139264, v6
  s_waitcnt lgkmcnt(10)
  v_mfma_f32_16x16x32_bf16 v[176:179], a[152:155], a[224:227], v[176:179]
  v_mfma_f32_16x16x32_bf16 v[184:187], a[152:155], a[228:231], v[184:187]
  v_add_u32 v7, 139264, v7
  v_mfma_f32_16x16x32_bf16 v[192:195], a[152:155], a[232:235], v[192:195]
  v_mfma_f32_16x16x32_bf16 v[200:203], a[152:155], a[236:239], v[200:203]
  v_add_u32 v15, 139264, v15
  s_waitcnt lgkmcnt(8)
  v_mfma_f32_16x16x32_bf16 v[180:183], a[156:159], a[224:227], v[180:183]
  v_mfma_f32_16x16x32_bf16 v[188:191], a[156:159], a[228:231], v[188:191]
  v_mfma_f32_16x16x32_bf16 v[196:199], a[156:159], a[232:235], v[196:199]
  s_add_u32 m0, s33, 49152
  v_mfma_f32_16x16x32_bf16 v[204:207], a[156:159], a[236:239], v[204:207]
  s_waitcnt vmcnt(34) lgkmcnt(0)
  s_barrier
  v_mfma_f32_16x16x32_bf16 v[208:211], a[160:163], a[224:227], v[208:211]
  ds_read_b64_tr_b16 a[144:145], v5 offset:0
  v_mfma_f32_16x16x32_bf16 v[212:215], a[160:163], a[228:231], v[212:215]
  ds_read_b64_tr_b16 a[146:147], v5 offset:6144
  v_mfma_f32_16x16x32_bf16 v[216:219], a[160:163], a[232:235], v[216:219]
  buffer_load_dwordx4 v1, s[8:11], s35 offen offset:0 lds
  v_mfma_f32_16x16x32_bf16 v[220:223], a[160:163], a[236:239], v[220:223]
  ds_read_b64_tr_b16 a[148:149], v5 offset:8
  v_mfma_f32_16x16x32_bf16 v[224:227], a[164:167], a[224:227], v[224:227]
  ds_read_b64_tr_b16 a[150:151], v5 offset:6152
  v_mfma_f32_16x16x32_bf16 v[228:231], a[164:167], a[228:231], v[228:231]
  buffer_load_dwordx4 v2, s[8:11], s35 offen offset:1024 lds
  v_mfma_f32_16x16x32_bf16 v[232:235], a[164:167], a[232:235], v[232:235]
  ds_read_b64_tr_b16 a[152:153], v6 offset:0
  v_mfma_f32_16x16x32_bf16 v[236:239], a[164:167], a[236:239], v[236:239]
  ds_read_b64_tr_b16 a[154:155], v6 offset:6144
  v_mfma_f32_16x16x32_bf16 v[240:243], a[168:171], a[224:227], v[240:243]
  buffer_load_dwordx4 v3, s[8:11], s35 offen offset:2048 lds
  v_mfma_f32_16x16x32_bf16 v[248:251], a[168:171], a[228:231], v[248:251]
  ds_read_b64_tr_b16 a[156:157], v6 offset:8
  s_add_u32 m0, s34, 49152
  v_mfma_f32_16x16x32_bf16 v[244:247], a[172:175], a[224:227], v[244:247]
  ds_read_b64_tr_b16 a[158:159], v6 offset:6152
  s_add_u32 s35, s35, 393216
  v_mfma_f32_16x16x32_bf16 v[252:255], a[172:175], a[228:231], v[252:255]
  buffer_load_dwordx4 v4, s[12:15], s36 offen lds
  s_add_u32 s36, s36, 98304
  s_waitcnt vmcnt(34) lgkmcnt(6)
  v_mfma_f32_16x16x32_bf16 v[16:19], a[144:147], a[240:243], v[16:19]
  ds_read_b64_tr_b16 a[160:161], v5 offset:128
  v_mfma_f32_16x16x32_bf16 v[24:27], a[144:147], a[244:247], v[24:27]
  ds_read_b64_tr_b16 a[162:163], v5 offset:6272
  v_mfma_f32_16x16x32_bf16 v[32:35], a[144:147], a[248:251], v[32:35]
  s_add_u32 s37, s37, 12288
  v_mfma_f32_16x16x32_bf16 v[40:43], a[144:147], a[252:255], v[40:43]
  ds_read_b64_tr_b16 a[164:165], v5 offset:136
  s_waitcnt lgkmcnt(7)
  v_mfma_f32_16x16x32_bf16 v[20:23], a[148:151], a[240:243], v[20:23]
  ds_read_b64_tr_b16 a[166:167], v5 offset:6280
  v_mfma_f32_16x16x32_bf16 v[28:31], a[148:151], a[244:247], v[28:31]
  buffer_load_dwordx4 a[224:227], v0, s[16:19], s52 offen offset:0 sc1
  v_mfma_f32_16x16x32_bf16 v[36:39], a[148:151], a[248:251], v[36:39]
  ds_read_b64_tr_b16 a[168:169], v6 offset:128
  v_mfma_f32_16x16x32_bf16 v[44:47], a[148:151], a[252:255], v[44:47]
  ds_read_b64_tr_b16 a[170:171], v6 offset:6272
  s_waitcnt lgkmcnt(8)
  v_mfma_f32_16x16x32_bf16 v[48:51], a[152:155], a[240:243], v[48:51]
  s_mov_b32 s38, 12288
  v_mfma_f32_16x16x32_bf16 v[56:59], a[152:155], a[244:247], v[56:59]
  ds_read_b64_tr_b16 a[172:173], v6 offset:136
  v_mfma_f32_16x16x32_bf16 v[64:67], a[152:155], a[248:251], v[64:67]
  ds_read_b64_tr_b16 a[174:175], v6 offset:6280
  v_mfma_f32_16x16x32_bf16 v[72:75], a[152:155], a[252:255], v[72:75]
  buffer_load_dwordx4 a[228:231], v0, s[16:19], s52 offen offset:1024 sc1
  s_waitcnt lgkmcnt(8)
  v_mfma_f32_16x16x32_bf16 v[52:55], a[156:159], a[240:243], v[52:55]
  ds_read_b64_tr_b16 a[144:145], v5 offset:256
  v_mfma_f32_16x16x32_bf16 v[60:63], a[156:159], a[244:247], v[60:63]
  ds_read_b64_tr_b16 a[146:147], v5 offset:6400
  v_mfma_f32_16x16x32_bf16 v[68:71], a[156:159], a[248:251], v[68:71]
  s_add_u32 s39, s39, 1
  v_mfma_f32_16x16x32_bf16 v[76:79], a[156:159], a[252:255], v[76:79]
  ds_read_b64_tr_b16 a[148:149], v5 offset:264
  s_waitcnt lgkmcnt(9)
  v_mfma_f32_16x16x32_bf16 v[80:83], a[160:163], a[240:243], v[80:83]
  ds_read_b64_tr_b16 a[150:151], v5 offset:6408
  v_mfma_f32_16x16x32_bf16 v[88:91], a[160:163], a[244:247], v[88:91]
  buffer_load_dwordx4 a[232:235], v0, s[16:19], s53 offen offset:0 sc1
  v_mfma_f32_16x16x32_bf16 v[96:99], a[160:163], a[248:251], v[96:99]
  ds_read_b64_tr_b16 a[152:153], v6 offset:256
  v_mfma_f32_16x16x32_bf16 v[104:107], a[160:163], a[252:255], v[104:107]
  ds_read_b64_tr_b16 a[154:155], v6 offset:6400
  s_waitcnt lgkmcnt(10)
  v_mfma_f32_16x16x32_bf16 v[84:87], a[164:167], a[240:243], v[84:87]
  s_add_u32 s52, s52, 4096
  v_mfma_f32_16x16x32_bf16 v[92:95], a[164:167], a[244:247], v[92:95]
  ds_read_b64_tr_b16 a[156:157], v6 offset:264
  v_mfma_f32_16x16x32_bf16 v[100:103], a[164:167], a[248:251], v[100:103]
  ds_read_b64_tr_b16 a[158:159], v6 offset:6408
  v_mfma_f32_16x16x32_bf16 v[108:111], a[164:167], a[252:255], v[108:111]
  buffer_load_dwordx4 a[236:239], v0, s[16:19], s53 offen offset:1024 sc1
  s_waitcnt lgkmcnt(10)
  v_mfma_f32_16x16x32_bf16 v[112:115], a[168:171], a[240:243], v[112:115]
  ds_read_b64_tr_b16 a[160:161], v7 offset:0
  v_mfma_f32_16x16x32_bf16 v[120:123], a[168:171], a[244:247], v[120:123]
  ds_read_b64_tr_b16 a[162:163], v7 offset:2048
  v_mfma_f32_16x16x32_bf16 v[128:131], a[168:171], a[248:251], v[128:131]
  s_add_u32 s53, s53, 4096
  v_mfma_f32_16x16x32_bf16 v[136:139], a[168:171], a[252:255], v[136:139]
  ds_read_b64_tr_b16 a[164:165], v15 offset:0
  s_waitcnt lgkmcnt(11)
  v_mfma_f32_16x16x32_bf16 v[116:119], a[172:175], a[240:243], v[116:119]
  ds_read_b64_tr_b16 a[166:167], v15 offset:2048
  v_mfma_f32_16x16x32_bf16 v[124:127], a[172:175], a[244:247], v[124:127]
  v_mfma_f32_16x16x32_bf16 v[132:135], a[172:175], a[248:251], v[132:135]
  ds_read_b64_tr_b16 a[168:169], v7 offset:512
  v_mfma_f32_16x16x32_bf16 v[140:143], a[172:175], a[252:255], v[140:143]
  ds_read_b64_tr_b16 a[170:171], v7 offset:2560
  s_waitcnt lgkmcnt(12)
  v_mfma_f32_16x16x32_bf16 v[144:147], a[144:147], a[240:243], v[144:147]
  v_mfma_f32_16x16x32_bf16 v[152:155], a[144:147], a[244:247], v[152:155]
  ds_read_b64_tr_b16 a[172:173], v15 offset:512
  v_mfma_f32_16x16x32_bf16 v[160:163], a[144:147], a[248:251], v[160:163]
  ds_read_b64_tr_b16 a[174:175], v15 offset:2560
  v_mfma_f32_16x16x32_bf16 v[168:171], a[144:147], a[252:255], v[168:171]
  s_waitcnt lgkmcnt(12)
  v_mfma_f32_16x16x32_bf16 v[148:151], a[148:151], a[240:243], v[148:151]
  v_mfma_f32_16x16x32_bf16 v[156:159], a[148:151], a[244:247], v[156:159]
  v_subrev_u32 v5, 139264, v5
  v_mfma_f32_16x16x32_bf16 v[164:167], a[148:151], a[248:251], v[164:167]
  v_mfma_f32_16x16x32_bf16 v[172:175], a[148:151], a[252:255], v[172:175]
  v_subrev_u32 v6, 139264, v6
  s_waitcnt lgkmcnt(10)
  v_mfma_f32_16x16x32_bf16 v[176:179], a[152:155], a[240:243], v[176:179]
  v_mfma_f32_16x16x32_bf16 v[184:187], a[152:155], a[244:247], v[184:187]
  v_subrev_u32 v7, 139264, v7
  v_mfma_f32_16x16x32_bf16 v[192:195], a[152:155], a[248:251], v[192:195]
  v_mfma_f32_16x16x32_bf16 v[200:203], a[152:155], a[252:255], v[200:203]
  v_subrev_u32 v15, 139264, v15
  s_waitcnt lgkmcnt(8)
  v_mfma_f32_16x16x32_bf16 v[180:183], a[156:159], a[240:243], v[180:183]
  v_mfma_f32_16x16x32_bf16 v[188:191], a[156:159], a[244:247], v[188:191]
  v_mfma_f32_16x16x32_bf16 v[196:199], a[156:159], a[248:251], v[196:199]
  s_add_u32 m0, s33, 139264
  v_mfma_f32_16x16x32_bf16 v[204:207], a[156:159], a[252:255], v[204:207]
  s_waitcnt vmcnt(31) lgkmcnt(0)
  s_barrier
  v_mfma_f32_16x16x32_bf16 v[208:211], a[160:163], a[240:243], v[208:211]
  ds_read_b64_tr_b16 a[144:145], v5 offset:0
  v_mfma_f32_16x16x32_bf16 v[212:215], a[160:163], a[244:247], v[212:215]
  ds_read_b64_tr_b16 a[146:147], v5 offset:6144
  v_mfma_f32_16x16x32_bf16 v[216:219], a[160:163], a[248:251], v[216:219]
  buffer_load_dwordx4 v1, s[8:11], s35 offen offset:0 lds
  v_mfma_f32_16x16x32_bf16 v[220:223], a[160:163], a[252:255], v[220:223]
  ds_read_b64_tr_b16 a[148:149], v5 offset:8
  v_mfma_f32_16x16x32_bf16 v[224:227], a[164:167], a[240:243], v[224:227]
  ds_read_b64_tr_b16 a[150:151], v5 offset:6152
  v_mfma_f32_16x16x32_bf16 v[228:231], a[164:167], a[244:247], v[228:231]
  buffer_load_dwordx4 v2, s[8:11], s35 offen offset:1024 lds
  v_mfma_f32_16x16x32_bf16 v[232:235], a[164:167], a[248:251], v[232:235]
  ds_read_b64_tr_b16 a[152:153], v6 offset:0
  v_mfma_f32_16x16x32_bf16 v[236:239], a[164:167], a[252:255], v[236:239]
  ds_read_b64_tr_b16 a[154:155], v6 offset:6144
  v_mfma_f32_16x16x32_bf16 v[240:243], a[168:171], a[240:243], v[240:243]
  buffer_load_dwordx4 v3, s[8:11], s35 offen offset:2048 lds
  v_mfma_f32_16x16x32_bf16 v[248:251], a[168:171], a[244:247], v[248:251]
  ds_read_b64_tr_b16 a[156:157], v6 offset:8
  s_add_u32 m0, s34, 139264
  v_mfma_f32_16x16x32_bf16 v[244:247], a[172:175], a[240:243], v[244:247]
  ds_read_b64_tr_b16 a[158:159], v6 offset:6152
  s_add_u32 s35, s35, 393216
  v_mfma_f32_16x16x32_bf16 v[252:255], a[172:175], a[244:247], v[252:255]
  buffer_load_dwordx4 v4, s[12:15], s36 offen lds
  s_add_u32 s36, s36, 98304
  s_waitcnt vmcnt(31) lgkmcnt(6)
  s_cmp_lt_u32 s39, 4
  s_cbranch_scc1 re_p1
re_t0:
  v_xor_b32 v15, 64, v14
  s_waitcnt vmcnt(4)
  ds_read_b128 a[224:227], v14 offset:0
  ds_read_b128 a[228:231], v15 offset:0
  ds_read_b128 a[232:235], v14 offset:128
  ds_read_b128 a[236:239], v15 offset:128
  ds_read_b128 a[240:243], v14 offset:256
  ds_read_b128 a[244:247], v15 offset:256
  ds_read_b128 a[248:251], v14 offset:6144
  ds_read_b128 a[252:255], v15 offset:6144
  v_cvt_pk_bf16_f32 v16, v16, v17
  v_cvt_pk_bf16_f32 v17, v18, v19
  v_cvt_pk_bf16_f32 v18, v20, v21
  v_cvt_pk_bf16_f32 v19, v22, v23
  v_cvt_pk_bf16_f32 v20, v24, v25
  v_cvt_pk_bf16_f32 v21, v26, v27
  v_cvt_pk_bf16_f32 v22, v28, v29
  v_cvt_pk_bf16_f32 v23, v30, v31
  v_cvt_pk_bf16_f32 v24, v32, v33
  v_cvt_pk_bf16_f32 v25, v34, v35
  v_cvt_pk_bf16_f32 v26, v36, v37
  v_cvt_pk_bf16_f32 v27, v38, v39
  v_cvt_pk_bf16_f32 v28, v40, v41
  v_cvt_pk_bf16_f32 v29, v42, v43
  v_cvt_pk_bf16_f32 v30, v44, v45
  v_cvt_pk_bf16_f32 v31, v46, v47
  s_waitcnt lgkmcnt(7)
  v_mfma_f32_16x16x32_bf16 v[32:35], a[224:227], v[16:19], 0
  v_cvt_pk_bf16_f32 v48, v48, v49
  v_cvt_pk_bf16_f32 v49, v50, v51
  v_cvt_pk_bf16_f32 v50, v52, v53
  v_cvt_pk_bf16_f32 v51, v54, v55
  v_mfma_f32_16x16x32_bf16 v[36:39], a[224:227], v[20:23], 0
  v_cvt_pk_bf16_f32 v52, v56, v57
  v_cvt_pk_bf16_f32 v53, v58, v59
  v_cvt_pk_bf16_f32 v54, v60, v61
  v_cvt_pk_bf16_f32 v55, v62, v63
  v_mfma_f32_16x16x32_bf16 v[40:43], a[224:227], v[24:27], 0
  v_cvt_pk_bf16_f32 v56, v64, v65
  v_cvt_pk_bf16_f32 v57, v66, v67
  v_cvt_pk_bf16_f32 v58, v68, v69
  v_cvt_pk_bf16_f32 v59, v70, v71
  v_mfma_f32_16x16x32_bf16 v[44:47], a[224:227], v[28:31], 0
  v_cvt_pk_bf16_f32 v60, v72, v73
  v_cvt_pk_bf16_f32 v61, v74, v75
  v_cvt_pk_bf16_f32 v62, v76, v77
  v_cvt_pk_bf16_f32 v63, v78, v79
  s_waitcnt lgkmcnt(6)
  v_mfma_f32_16x16x32_bf16 v[32:35], a[228:231], v[48:51], v[32:35]
  ds_read_b128 a[224:227], v14 offset:6272
  v_cvt_pk_bf16_f32 v80, v80, v81
  v_cvt_pk_bf16_f32 v81, v82, v83
  v_cvt_pk_bf16_f32 v82, v84, v85
  v_cvt_pk_bf16_f32 v83, v86, v87
  v_mfma_f32_16x16x32_bf16 v[36:39], a[228:231], v[52:55], v[36:39]
  v_cvt_pk_bf16_f32 v84, v88, v89
  v_cvt_pk_bf16_f32 v85, v90, v91
  v_cvt_pk_bf16_f32 v86, v92, v93
  v_cvt_pk_bf16_f32 v87, v94, v95
  v_mfma_f32_16x16x32_bf16 v[40:43], a[228:231], v[56:59], v[40:43]
  v_cvt_pk_bf16_f32 v88, v96, v97
  v_cvt_pk_bf16_f32 v89, v98, v99
  v_cvt_pk_bf16_f32 v90, v100, v101
  v_cvt_pk_bf16_f32 v91, v102, v103
  v_mfma_f32_16x16x32_bf16 v[44:47], a[228:231], v[60:63], v[44:47]
  v_cvt_pk_bf16_f32 v92, v104, v105
  v_cvt_pk_bf16_f32 v93, v106, v107
  v_cvt_pk_bf16_f32 v94, v108, v109
  v_cvt_pk_bf16_f32 v95, v110, v111
  s_waitcnt lgkmcnt(6)
  v_mfma_f32_16x16x32_bf16 v[32:35], a[232:235], v[80:83], v[32:35]
  ds_read_b128 a[228:231], v15 offset:6272
  v_cvt_pk_bf16_f32 v112, v112, v113
  v_cvt_pk_bf16_f32 v113, v114, v115
  v_cvt_pk_bf16_f32 v114, v116, v117
  v_cvt_pk_bf16_f32 v115, v118, v119
  v_mfma_f32_16x16x32_bf16 v[36:39], a[232:235], v[84:87], v[36:39]
  v_cvt_pk_bf16_f32 v116, v120, v121
  v_cvt_pk_bf16_f32 v117, v122, v123
  v_cvt_pk_bf16_f32 v118, v124, v125
  v_cvt_pk_bf16_f32 v119, v126, v127
  v_mfma_f32_16x16x32_bf16 v[40:43], a[232:235], v[88:91], v[40:43]
  v_cvt_pk_bf16_f32 v120, v128, v129
  v_cvt_pk_bf16_f32 v121, v130, v131
  v_cvt_pk_bf16_f32 v122, v132, v133
  v_cvt_pk_bf16_f32 v123, v134, v135
  v_mfma_f32_16x16x32_bf16 v[44:47], a[232:235], v[92:95], v[44:47]
  v_cvt_pk_bf16_f32 v124, v136, v137
  v_cvt_pk_bf16_f32 v125, v138, v139
  v_cvt_pk_bf16_f32 v126, v140, v141
  v_cvt_pk_bf16_f32 v127, v142, v143
  s_waitcnt lgkmcnt(6)
  v_mfma_f32_16x16x32_bf16 v[32:35], a[236:239], v[112:115], v[32:35]
  ds_read_b128 a[232:235], v14 offset:6400
  v_cvt_pk_bf16_f32 v144, v144, v145
  v_cvt_pk_bf16_f32 v145, v146, v147
  v_cvt_pk_bf16_f32 v146, v148, v149
  v_cvt_pk_bf16_f32 v147, v150, v151
  v_mfma_f32_16x16x32_bf16 v[36:39], a[236:239], v[116:119], v[36:39]
  v_cvt_pk_bf16_f32 v148, v152, v153
  v_cvt_pk_bf16_f32 v149, v154, v155
  v_cvt_pk_bf16_f32 v150, v156, v157
  v_cvt_pk_bf16_f32 v151, v158, v159
  v_mfma_f32_16x16x32_bf16 v[40:43], a[236:239], v[120:123], v[40:43]
  v_cvt_pk_bf16_f32 v152, v160, v161
  v_cvt_pk_bf16_f32 v153, v162, v163
  v_cvt_pk_bf16_f32 v154, v164, v165
  v_cvt_pk_bf16_f32 v155, v166, v167
  v_mfma_f32_16x16x32_bf16 v[44:47], a[236:239], v[124:127], v[44:47]
  v_cvt_pk_bf16_f32 v156, v168, v169
  v_cvt_pk_bf16_f32 v157, v170, v171
  v_cvt_pk_bf16_f32 v158, v172, v173
  v_cvt_pk_bf16_f32 v159, v174, v175
  s_waitcnt lgkmcnt(6)
  v_mfma_f32_16x16x32_bf16 v[32:35], a[240:243], v[144:147], v[32:35]
  ds_read_b128 a[236:239], v15 offset:6400
  v_cvt_pk_bf16_f32 v176, v176, v177
  v_cvt_pk_bf16_f32 v177, v178, v179
  v_cvt_pk_bf16_f32 v178, v180, v181
  v_cvt_pk_bf16_f32 v179, v182, v183
  v_mfma_f32_16x16x32_bf16 v[36:39], a[240:243], v[148:151], v[36:39]
  v_cvt_pk_bf16_f32 v180, v184, v185
  v_cvt_pk_bf16_f32 v181, v186, v187
  v_cvt_pk_bf16_f32 v182, v188, v189
  v_cvt_pk_bf16_f32 v183, v190, v191
  v_mfma_f32_16x16x32_bf16 v[40:43], a[240:243], v[152:155], v[40:43]
  v_cvt_pk_bf16_f32 v184, v192, v193
  v_cvt_pk_bf16_f32 v185, v194, v195
  v_cvt_pk_bf16_f32 v186, v196, v197
  v_cvt_pk_bf16_f32 v187, v198, v199
  v_mfma_f32_16x16x32_bf16 v[44:47], a[240:243], v[156:159], v[44:47]
  v_cvt_pk_bf16_f32 v188, v200, v201
  v_cvt_pk_bf16_f32 v189, v202, v203
  v_cvt_pk_bf16_f32 v190, v204, v205
  v_cvt_pk_bf16_f32 v191, v206, v207
  s_waitcnt lgkmcnt(6)
  v_mfma_f32_16x16x32_bf16 v[32:35], a[244:247], v[176:179], v[32:35]
  v_mfma_f32_16x16x32_bf16 v[36:39], a[244:247], v[180:183], v[36:39]
  v_mfma_f32_16x16x32_bf16 v[40:43], a[244:247], v[184:187], v[40:43]
  v_mfma_f32_16x16x32_bf16 v[44:47], a[244:247], v[188:191], v[44:47]
  s_waitcnt lgkmcnt(5)
  v_mbcnt_lo_u32_b32 v0, -1, 0
  v_mbcnt_hi_u32_b32 v0, -1, v0
  v_bfrev_b32 v207, 1
  v_cmp_eq_u32 vcc, 0, v0
  v_cndmask_b32 v207, v207, v0, vcc
  v_lshlrev_b32 v205, 6, v0
  v_lshlrev_b32 v0, 4, v0
  v_mov_b32 v5, s60
  v_lshrrev_b32 v1, 6, v0
  v_mul_u32_u24 v1, 384, v1
  v_bfe_u32 v2, v0, 7, 2
  v_lshl_add_u32 v1, v2, 5, v1
  v_bfe_u32 v2, v0, 4, 2
  v_lshl_add_u32 v1, v2, 3, v1
  v_add_u32 v1, 114688, v1
  v_xor_b32 v2, 32, v1
  v_xor_b32 v3, 64, v1
  v_xor_b32 v4, 96, v1
  v_max3_f32 v196, v32, v33, v34
  v_max_f32 v196, v196, v35
  v_max3_f32 v197, v36, v37, v38
  v_max_f32 v197, v197, v39
  v_max3_f32 v198, v40, v41, v42
  v_max_f32 v198, v198, v43
  v_max3_f32 v199, v44, v45, v46
  v_max_f32 v199, v199, v47
  s_nop 1
  v_permlane32_swap_b32 v196, v197
  v_permlane32_swap_b32 v198, v199
  s_nop 1
  v_max_f32 v196, v196, v197
  v_max_f32 v198, v198, v199
  s_nop 1
  v_permlane16_swap_b32 v196, v198
  s_nop 1
  v_max_f32 v196, v196, v198
  v_sub_f32 v196, 0, v196
  v_mov_b32 v198, v196
  s_nop 1
  v_permlane16_swap_b32 v196, v198
  s_nop 1
  v_mov_b32 v197, v196
  v_mov_b32 v199, v198
  s_nop 1
  v_permlane32_swap_b32 v196, v197
  v_permlane32_swap_b32 v198, v199
  s_nop 1
  v_mov_b32 v160, v196
  v_mov_b32 v161, v196
  v_mov_b32 v162, v196
  v_mov_b32 v163, v196
  v_mov_b32 v164, v197
  v_mov_b32 v165, v197
  v_mov_b32 v166, v197
  v_mov_b32 v167, v197
  v_mov_b32 v168, v198
  v_mov_b32 v169, v198
  v_mov_b32 v170, v198
  v_mov_b32 v171, v198
  v_mov_b32 v172, v199
  v_mov_b32 v173, v199
  v_mov_b32 v174, v199
  v_mov_b32 v175, v199
  v_mov_b32 v192, 0
  v_mov_b32 v193, 0
  v_mov_b32 v194, 0
  v_mov_b32 v195, 0
  s_mov_b32 s37, 49152
  s_mov_b32 s38, 24576
  v_mfma_f32_16x16x32_bf16 v[64:67], a[248:251], v[16:19], v[160:163]
  ds_read_b128 a[192:195], v14 offset:12288
  v_add_f32 v32, v32, v160
  v_add_f32 v33, v33, v160
  v_add_f32 v34, v34, v160
  v_mfma_f32_16x16x32_bf16 v[68:71], a[248:251], v[20:23], v[164:167]
  v_add_f32 v35, v35, v160
  v_exp_f32 v32, v32
  v_mfma_f32_16x16x32_bf16 v[72:75], a[248:251], v[24:27], v[168:171]
  v_exp_f32 v33, v33
  v_add_f32 v192, v192, v32
  v_mfma_f32_16x16x32_bf16 v[76:79], a[248:251], v[28:31], v[172:175]
  v_exp_f32 v34, v34
  v_add_f32 v192, v192, v33
  v_exp_f32 v35, v35
  s_waitcnt lgkmcnt(5)
  v_mfma_f32_16x16x32_bf16 v[64:67], a[252:255], v[48:51], v[64:67]
  ds_read_b128 a[196:199], v15 offset:12288
  v_cvt_pk_bf16_f32 v96, v32, v33
  v_add_f32 v192, v192, v34
  v_mfma_f32_16x16x32_bf16 v[68:71], a[252:255], v[52:55], v[68:71]
  v_add_f32 v192, v192, v35
  v_cvt_pk_bf16_f32 v97, v34, v35
  v_mfma_f32_16x16x32_bf16 v[72:75], a[252:255], v[56:59], v[72:75]
  v_add_f32 v36, v36, v164
  v_add_f32 v37, v37, v164
  v_add_f32 v38, v38, v164
  v_mfma_f32_16x16x32_bf16 v[76:79], a[252:255], v[60:63], v[76:79]
  v_add_f32 v39, v39, v164
  v_exp_f32 v36, v36
  s_waitcnt lgkmcnt(5)
  v_mfma_f32_16x16x32_bf16 v[64:67], a[224:227], v[80:83], v[64:67]
  ds_read_b128 a[200:203], v14 offset:12416
  v_exp_f32 v37, v37
  v_add_f32 v193, v193, v36
  v_mfma_f32_16x16x32_bf16 v[68:71], a[224:227], v[84:87], v[68:71]
  v_exp_f32 v38, v38
  v_add_f32 v193, v193, v37
  v_exp_f32 v39, v39
  v_mfma_f32_16x16x32_bf16 v[72:75], a[224:227], v[88:91], v[72:75]
  v_cvt_pk_bf16_f32 v100, v36, v37
  v_add_f32 v193, v193, v38
  v_mfma_f32_16x16x32_bf16 v[76:79], a[224:227], v[92:95], v[76:79]
  v_add_f32 v193, v193, v39
  v_cvt_pk_bf16_f32 v101, v38, v39
  s_waitcnt lgkmcnt(5)
  v_mfma_f32_16x16x32_bf16 v[64:67], a[228:231], v[112:115], v[64:67]
  ds_read_b128 a[204:207], v15 offset:12416
  v_add_f32 v40, v40, v168
  v_add_f32 v41, v41, v168
  v_add_f32 v42, v42, v168
  v_mfma_f32_16x16x32_bf16 v[68:71], a[228:231], v[116:119], v[68:71]
  v_add_f32 v43, v43, v168
  v_exp_f32 v40, v40
  v_mfma_f32_16x16x32_bf16 v[72:75], a[228:231], v[120:123], v[72:75]
  v_exp_f32 v41, v41
  v_add_f32 v194, v194, v40
  v_mfma_f32_16x16x32_bf16 v[76:79], a[228:231], v[124:127], v[76:79]
  v_exp_f32 v42, v42
  v_add_f32 v194, v194, v41
  v_exp_f32 v43, v43
  s_waitcnt lgkmcnt(5)
  v_mfma_f32_16x16x32_bf16 v[64:67], a[232:235], v[144:147], v[64:67]
  ds_read_b128 a[208:211], v14 offset:12544
  v_cvt_pk_bf16_f32 v104, v40, v41
  v_add_f32 v194, v194, v42
  v_mfma_f32_16x16x32_bf16 v[68:71], a[232:235], v[148:151], v[68:71]
  v_add_f32 v194, v194, v43
  v_cvt_pk_bf16_f32 v105, v42, v43
  v_mfma_f32_16x16x32_bf16 v[72:75], a[232:235], v[152:155], v[72:75]
  v_add_f32 v44, v44, v172
  v_add_f32 v45, v45, v172
  v_add_f32 v46, v46, v172
  v_mfma_f32_16x16x32_bf16 v[76:79], a[232:235], v[156:159], v[76:79]
  v_add_f32 v47, v47, v172
  v_exp_f32 v44, v44
  s_waitcnt lgkmcnt(5)
  s_waitcnt vmcnt(0)
  s_barrier
  v_mfma_f32_16x16x32_bf16 v[64:67], a[236:239], v[176:179], v[64:67]
  v_exp_f32 v45, v45
  v_add_f32 v195, v195, v44
  v_mfma_f32_16x16x32_bf16 v[68:71], a[236:239], v[180:183], v[68:71]
  v_exp_f32 v46, v46
  v_add_f32 v195, v195, v45
  v_exp_f32 v47, v47
  v_mfma_f32_16x16x32_bf16 v[72:75], a[236:239], v[184:187], v[72:75]
  v_cvt_pk_bf16_f32 v108, v44, v45
  v_add_f32 v195, v195, v46
  v_mfma_f32_16x16x32_bf16 v[76:79], a[236:239], v[188:191], v[76:79]
  v_add_f32 v195, v195, v47
  v_cvt_pk_bf16_f32 v109, v46, v47
  s_add_u32 m0, s33, 139264
  s_nop 0
  buffer_load_dwordx4 v11, s[24:27], s38 offen offset:0 lds
  buffer_load_dwordx4 v12, s[24:27], s38 offen offset:1024 lds
  buffer_load_dwordx4 v13, s[24:27], s38 offen offset:2048 lds
  s_add_u32 s38, s38, 12288
  v_accvgpr_read_b32 v200, a139
  v_accvgpr_read_b32 v201, a140
  v_accvgpr_read_b32 v202, a141
  v_accvgpr_read_b32 v203, a142
  v_accvgpr_read_b32 v204, a143
  v_accvgpr_write_b32 a139, 0
  v_accvgpr_write_b32 a140, 0
  v_accvgpr_write_b32 a141, 0
  v_accvgpr_write_b32 a142, 0
  v_accvgpr_write_b32 a143, 0
  v_mfma_f32_32x32x16_bf16 a[144:159], a[0:3], a[0:3], 0
  v_max_f32 v208, 0, v208
  v_max_f32 v209, 0, v209
  v_max_f32 v210, 0, v210
  v_max_f32 v211, 0, v211
  v_pk_mul_f32 v[208:209], v[208:209], v[208:209]
  v_pk_mul_f32 v[210:211], v[210:211], v[210:211]
  v_cvt_pk_bf16_f32 v208, v208, v209
  v_cvt_pk_bf16_f32 v209, v210, v211
  v_max_f32 v224, 0, v224
  v_max_f32 v225, 0, v225
  v_max_f32 v226, 0, v226
  v_max_f32 v227, 0, v227
  v_pk_mul_f32 v[224:225], v[224:225], v[224:225]
  v_pk_mul_f32 v[226:227], v[226:227], v[226:227]
  v_cvt_pk_bf16_f32 v210, v224, v225
  v_cvt_pk_bf16_f32 v211, v226, v227
  v_max_f32 v240, 0, v240
  v_max_f32 v241, 0, v241
  v_max_f32 v242, 0, v242
  v_max_f32 v243, 0, v243
  v_pk_mul_f32 v[240:241], v[240:241], v[240:241]
  v_pk_mul_f32 v[242:243], v[242:243], v[242:243]
  v_cvt_pk_bf16_f32 v240, v240, v241
  v_cvt_pk_bf16_f32 v241, v242, v243
  buffer_store_dwordx4 v[208:211], v0, s[28:31], s48 offen offset:0 sc1
  v_mfma_f32_32x32x16_bf16 a[160:175], a[0:3], a[0:3], 0
  v_max_f32 v212, 0, v212
  v_max_f32 v213, 0, v213
  v_max_f32 v214, 0, v214
  v_max_f32 v215, 0, v215
  v_pk_mul_f32 v[212:213], v[212:213], v[212:213]
  v_pk_mul_f32 v[214:215], v[214:215], v[214:215]
  v_cvt_pk_bf16_f32 v212, v212, v213
  v_cvt_pk_bf16_f32 v213, v214, v215
  v_max_f32 v228, 0, v228
  v_max_f32 v229, 0, v229
  v_max_f32 v230, 0, v230
  v_max_f32 v231, 0, v231
  v_pk_mul_f32 v[228:229], v[228:229], v[228:229]
  v_pk_mul_f32 v[230:231], v[230:231], v[230:231]
  v_cvt_pk_bf16_f32 v214, v228, v229
  v_cvt_pk_bf16_f32 v215, v230, v231
  v_max_f32 v244, 0, v244
  v_max_f32 v245, 0, v245
  v_max_f32 v246, 0, v246
  v_max_f32 v247, 0, v247
  v_pk_mul_f32 v[244:245], v[244:245], v[244:245]
  v_pk_mul_f32 v[246:247], v[246:247], v[246:247]
  v_cvt_pk_bf16_f32 v242, v244, v245
  v_cvt_pk_bf16_f32 v243, v246, v247
  buffer_store_dwordx4 v[212:215], v0, s[28:31], s48 offen offset:1024 sc1
  buffer_store_dwordx4 v[240:243], v0, s[28:31], s50 offen offset:0 sc1
  v_mfma_f32_32x32x16_bf16 a[176:191], a[0:3], a[0:3], 0
  v_max_f32 v216, 0, v216
  v_max_f32 v217, 0, v217
  v_max_f32 v218, 0, v218
  v_max_f32 v219, 0, v219
  v_pk_mul_f32 v[216:217], v[216:217], v[216:217]
  v_pk_mul_f32 v[218:219], v[218:219], v[218:219]
  v_cvt_pk_bf16_f32 v216, v216, v217
  v_cvt_pk_bf16_f32 v217, v218, v219
  v_max_f32 v232, 0, v232
  v_max_f32 v233, 0, v233
  v_max_f32 v234, 0, v234
  v_max_f32 v235, 0, v235
  v_pk_mul_f32 v[232:233], v[232:233], v[232:233]
  v_pk_mul_f32 v[234:235], v[234:235], v[234:235]
  v_cvt_pk_bf16_f32 v218, v232, v233
  v_cvt_pk_bf16_f32 v219, v234, v235
  v_max_f32 v248, 0, v248
  v_max_f32 v249, 0, v249
  v_max_f32 v250, 0, v250
  v_max_f32 v251, 0, v251
  v_pk_mul_f32 v[248:249], v[248:249], v[248:249]
  v_pk_mul_f32 v[250:251], v[250:251], v[250:251]
  v_cvt_pk_bf16_f32 v248, v248, v249
  v_cvt_pk_bf16_f32 v249, v250, v251
  buffer_store_dwordx4 v[216:219], v0, s[28:31], s49 offen offset:0 sc1
  v_max_f32 v220, 0, v220
  v_max_f32 v221, 0, v221
  v_max_f32 v222, 0, v222
  v_max_f32 v223, 0, v223
  v_pk_mul_f32 v[220:221], v[220:221], v[220:221]
  v_pk_mul_f32 v[222:223], v[222:223], v[222:223]
  v_cvt_pk_bf16_f32 v220, v220, v221
  v_cvt_pk_bf16_f32 v221, v222, v223
  v_max_f32 v236, 0, v236
  v_max_f32 v237, 0, v237
  v_max_f32 v238, 0, v238
  v_max_f32 v239, 0, v239
  v_pk_mul_f32 v[236:237], v[236:237], v[236:237]
  v_pk_mul_f32 v[238:239], v[238:239], v[238:239]
  v_cvt_pk_bf16_f32 v222, v236, v237
  v_cvt_pk_bf16_f32 v223, v238, v239
  v_max_f32 v252, 0, v252
  v_max_f32 v253, 0, v253
  v_max_f32 v254, 0, v254
  v_max_f32 v255, 0, v255
  v_pk_mul_f32 v[252:253], v[252:253], v[252:253]
  v_pk_mul_f32 v[254:255], v[254:255], v[254:255]
  v_cvt_pk_bf16_f32 v250, v252, v253
  v_cvt_pk_bf16_f32 v251, v254, v255
  buffer_store_dwordx4 v[220:223], v0, s[28:31], s49 offen offset:1024 sc1
  buffer_store_dwordx4 v[248:251], v0, s[28:31], s50 offen offset:1024 sc1
  buffer_load_dword v206, v205, s[80:83], 0 offen
  s_cmp_ge_u32 s2, 24
  s_cbranch_scc1 re_npf1
  s_lshr_b32 s52, s2, 3
  s_lshl_b32 s52, s52, 2
  s_add_u32 s52, s52, s32
  s_lshl_b32 s52, s52, 12
  v_lshl_add_u32 v6, v0, 2, s52
  s_getpc_b64 s[52:53]
  re_pc1:
  v_min_u32 v6, re_zend-re_pc1-4, v6
  v_mov_b32 v7, s53
  v_add_co_u32 v6, vcc, s52, v6
  v_addc_co_u32 v7, vcc, 0, v7, vcc
   global_load_dword v206, v[6:7], off
  re_npf1:
  s_lshl_b32 s73, s51, 2
  s_add_u32 s73, s73, s61
  s_mul_i32 s73, s73, 122880
  s_add_u32 s73, s73, 4194304
  s_add_u32 s8, s62, s73
  s_addc_u32 s9, s63, 0
  s_mov_b32 s10, 122880
  s_mov_b32 s11, 0x20000
  v_bfe_u32 v196, v0, 4, 3
  v_lshlrev_b32 v196, 2, v196
  s_lshr_b32 s73, s61, 1
  s_lshl_b32 s73, s73, 10
  v_add_u32 v198, s73, v0
  v_xor_b32 v199, 1024, v198
  v_exp_f32 v64, v64
  v_exp_f32 v68, v68
  v_exp_f32 v65, v65
  v_exp_f32 v69, v69
  v_add_f32 v192, v192, v64
  v_add_f32 v193, v193, v68
  v_exp_f32 v66, v66
  v_exp_f32 v70, v70
  v_add_f32 v192, v192, v65
  v_add_f32 v193, v193, v69
  v_exp_f32 v67, v67
  v_exp_f32 v71, v71
  v_cvt_pk_bf16_f32 v98, v64, v65
  v_cvt_pk_bf16_f32 v102, v68, v69
  v_add_f32 v192, v192, v66
  v_add_f32 v193, v193, v70
  v_add_f32 v192, v192, v67
  v_add_f32 v193, v193, v71
  v_cvt_pk_bf16_f32 v99, v66, v67
  v_cvt_pk_bf16_f32 v103, v70, v71
  s_waitcnt lgkmcnt(4)
.p2align 6
re_p21:
  v_mfma_f32_16x16x32_bf16 v[32:35], a[192:195], v[16:19], v[160:163]
  ds_read_b128 a[212:215], v15 offset:12544
  v_exp_f32 v72, v72
  v_mfma_f32_16x16x32_bf16 v[36:39], a[192:195], v[20:23], v[164:167]
  s_add_u32 m0, s33, 65536
  v_exp_f32 v73, v73
  v_mfma_f32_16x16x32_bf16 v[40:43], a[192:195], v[24:27], v[168:171]
  buffer_load_dwordx4 v8, s[20:23], s37 offen offset:0 lds
  v_add_f32 v194, v194, v72
  v_mfma_f32_16x16x32_bf16 v[44:47], a[192:195], v[28:31], v[172:175]
  v_exp_f32 v74, v74
  s_waitcnt lgkmcnt(4)
  v_mfma_f32_16x16x32_bf16 v[32:35], a[196:199], v[48:51], v[32:35]
  ds_read_b128 a[216:219], v14 offset:18432
  v_add_f32 v194, v194, v73
  v_mfma_f32_16x16x32_bf16 v[36:39], a[196:199], v[52:55], v[36:39]
  v_exp_f32 v75, v75
  v_mfma_f32_16x16x32_bf16 v[40:43], a[196:199], v[56:59], v[40:43]
  v_cvt_pk_bf16_f32 v106, v72, v73
  v_mfma_f32_16x16x32_bf16 v[44:47], a[196:199], v[60:63], v[44:47]
  v_add_f32 v194, v194, v74
  s_waitcnt lgkmcnt(4)
  v_mfma_f32_16x16x32_bf16 v[32:35], a[200:203], v[80:83], v[32:35]
  ds_read_b128 a[220:223], v15 offset:18432
  v_add_f32 v194, v194, v75
  v_mfma_f32_16x16x32_bf16 v[36:39], a[200:203], v[84:87], v[36:39]
  v_cvt_pk_bf16_f32 v107, v74, v75
  v_mfma_f32_16x16x32_bf16 v[40:43], a[200:203], v[88:91], v[40:43]
  buffer_load_dwordx4 v9, s[20:23], s37 offen offset:1024 lds
  v_mfma_f32_16x16x32_bf16 v[44:47], a[200:203], v[92:95], v[44:47]
  s_waitcnt lgkmcnt(4)
  v_mfma_f32_16x16x32_bf16 v[32:35], a[204:207], v[112:115], v[32:35]
  ds_read_b128 a[192:195], v14 offset:18560
  v_exp_f32 v76, v76
  v_mfma_f32_16x16x32_bf16 v[36:39], a[204:207], v[116:119], v[36:39]
  v_exp_f32 v77, v77
  v_mfma_f32_16x16x32_bf16 v[40:43], a[204:207], v[120:123], v[40:43]
  v_add_f32 v195, v195, v76
  v_mfma_f32_16x16x32_bf16 v[44:47], a[204:207], v[124:127], v[44:47]
  v_exp_f32 v78, v78
  s_waitcnt lgkmcnt(4)
  v_mfma_f32_16x16x32_bf16 v[32:35], a[208:211], v[144:147], v[32:35]
  ds_read_b128 a[196:199], v15 offset:18560
  v_add_f32 v195, v195, v77
  v_mfma_f32_16x16x32_bf16 v[36:39], a[208:211], v[148:151], v[36:39]
  v_exp_f32 v79, v79
  v_mfma_f32_16x16x32_bf16 v[40:43], a[208:211], v[152:155], v[40:43]
  buffer_load_dwordx4 v10, s[20:23], s37 offen offset:2048 lds
  v_cvt_pk_bf16_f32 v110, v76, v77
  v_mfma_f32_16x16x32_bf16 v[44:47], a[208:211], v[156:159], v[44:47]
  v_add_f32 v195, v195, v78
  s_waitcnt lgkmcnt(4)
  v_mfma_f32_16x16x32_bf16 v[32:35], a[212:215], v[176:179], v[32:35]
  ds_read_b128 a[200:203], v14 offset:18688
  v_add_f32 v195, v195, v79
  v_mfma_f32_16x16x32_bf16 v[36:39], a[212:215], v[180:183], v[36:39]
  s_add_u32 s37, s37, 12288
  v_cvt_pk_bf16_f32 v111, v78, v79
  v_mfma_f32_16x16x32_bf16 v[40:43], a[212:215], v[184:187], v[40:43]
  buffer_load_dword v197, v196, s[76:79], s54 offen sc1
  v_mfma_f32_16x16x32_bf16 v[44:47], a[212:215], v[188:191], v[44:47]
  s_waitcnt lgkmcnt(4)
  v_mfma_f32_16x16x32_bf16 v[64:67], a[216:219], v[16:19], v[160:163]
  ds_read_b128 a[204:207], v15 offset:18688
  v_exp_f32 v32, v32
  v_mfma_f32_16x16x32_bf16 v[68:71], a[216:219], v[20:23], v[164:167]
  v_exp_f32 v33, v33
  v_mfma_f32_16x16x32_bf16 v[72:75], a[216:219], v[24:27], v[168:171]
  v_add_f32 v192, v192, v32
  v_mfma_f32_16x16x32_bf16 v[76:79], a[216:219], v[28:31], v[172:175]
  v_exp_f32 v34, v34
  s_waitcnt lgkmcnt(4)
  v_mfma_f32_16x16x32_bf16 v[64:67], a[220:223], v[48:51], v[64:67]
  ds_read_b64_tr_b16 a[208:209], v1 offset:0
  v_add_f32 v192, v192, v33
  v_mfma_f32_16x16x32_bf16 v[68:71], a[220:223], v[52:55], v[68:71]
  ds_read_b64_tr_b16 a[210:211], v1 offset:6144
  v_exp_f32 v35, v35
  v_mfma_f32_16x16x32_bf16 v[72:75], a[220:223], v[56:59], v[72:75]
  v_cvt_pk_bf16_f32 v128, v32, v33
  v_mfma_f32_16x16x32_bf16 v[76:79], a[220:223], v[60:63], v[76:79]
  v_add_f32 v192, v192, v34
  s_waitcnt lgkmcnt(5)
  v_mfma_f32_16x16x32_bf16 v[64:67], a[192:195], v[80:83], v[64:67]
  ds_read_b64_tr_b16 a[212:213], v2 offset:0
  v_add_f32 v192, v192, v35
  v_mfma_f32_16x16x32_bf16 v[68:71], a[192:195], v[84:87], v[68:71]
  ds_read_b64_tr_b16 a[214:215], v2 offset:6144
  v_cvt_pk_bf16_f32 v129, v34, v35
  v_mfma_f32_16x16x32_bf16 v[72:75], a[192:195], v[88:91], v[72:75]
  v_mfma_f32_16x16x32_bf16 v[76:79], a[192:195], v[92:95], v[76:79]
  s_waitcnt lgkmcnt(6)
  v_mfma_f32_16x16x32_bf16 v[64:67], a[196:199], v[112:115], v[64:67]
  ds_read_b64_tr_b16 a[216:217], v3 offset:0
  v_exp_f32 v36, v36
  v_mfma_f32_16x16x32_bf16 v[68:71], a[196:199], v[116:119], v[68:71]
  ds_read_b64_tr_b16 a[218:219], v3 offset:6144
  v_exp_f32 v37, v37
  v_mfma_f32_16x16x32_bf16 v[72:75], a[196:199], v[120:123], v[72:75]
  v_add_f32 v193, v193, v36
  v_mfma_f32_16x16x32_bf16 v[76:79], a[196:199], v[124:127], v[76:79]
  v_exp_f32 v38, v38
  s_waitcnt lgkmcnt(7)
  v_mfma_f32_16x16x32_bf16 v[64:67], a[200:203], v[144:147], v[64:67]
  ds_read_b64_tr_b16 a[220:221], v4 offset:0
  v_add_f32 v193, v193, v37
  v_mfma_f32_16x16x32_bf16 v[68:71], a[200:203], v[148:151], v[68:71]
  ds_read_b64_tr_b16 a[222:223], v4 offset:6144
  v_exp_f32 v39, v39
  v_mfma_f32_16x16x32_bf16 v[72:75], a[200:203], v[152:155], v[72:75]
  v_cvt_pk_bf16_f32 v132, v36, v37
  v_mfma_f32_16x16x32_bf16 v[76:79], a[200:203], v[156:159], v[76:79]
  v_add_f32 v193, v193, v38
  s_waitcnt lgkmcnt(8)
  v_mfma_f32_16x16x32_bf16 v[64:67], a[204:207], v[176:179], v[64:67]
  ds_read_b64_tr_b16 a[192:193], v1 offset:128
  v_add_f32 v193, v193, v39
  v_mfma_f32_16x16x32_bf16 v[68:71], a[204:207], v[180:183], v[68:71]
  ds_read_b64_tr_b16 a[194:195], v1 offset:6272
  v_cvt_pk_bf16_f32 v133, v38, v39
  v_mfma_f32_16x16x32_bf16 v[72:75], a[204:207], v[184:187], v[72:75]
  buffer_load_dword v206, v205, s[64:67], s70 offen
  v_mfma_f32_16x16x32_bf16 v[76:79], a[204:207], v[188:191], v[76:79]
  s_add_u32 s70, s70, 4096
  s_waitcnt lgkmcnt(8)
  v_mfma_f32_16x16x32_bf16 a[0:3], a[208:211], v[96:99], a[0:3]
  ds_read_b64_tr_b16 a[196:197], v2 offset:128
  v_exp_f32 v40, v40
  v_mfma_f32_16x16x32_bf16 a[8:11], a[208:211], v[100:103], a[8:11]
  ds_read_b64_tr_b16 a[198:199], v2 offset:6272
  v_exp_f32 v41, v41
  v_mfma_f32_16x16x32_bf16 a[16:19], a[208:211], v[104:107], a[16:19]
  v_add_f32 v194, v194, v40
  v_mfma_f32_16x16x32_bf16 a[24:27], a[208:211], v[108:111], a[24:27]
  v_exp_f32 v42, v42
  s_waitcnt lgkmcnt(8)
  v_mfma_f32_16x16x32_bf16 a[4:7], a[212:215], v[96:99], a[4:7]
  ds_read_b64_tr_b16 a[200:201], v3 offset:128
  v_add_f32 v194, v194, v41
  v_mfma_f32_16x16x32_bf16 a[12:15], a[212:215], v[100:103], a[12:15]
  ds_read_b64_tr_b16 a[202:203], v3 offset:6272
  v_exp_f32 v43, v43
  v_mfma_f32_16x16x32_bf16 a[20:23], a[212:215], v[104:107], a[20:23]
  v_cvt_pk_bf16_f32 v136, v40, v41
  v_mfma_f32_16x16x32_bf16 a[28:31], a[212:215], v[108:111], a[28:31]
  v_add_f32 v194, v194, v42
  s_waitcnt lgkmcnt(8)
  v_mfma_f32_16x16x32_bf16 a[32:35], a[216:219], v[96:99], a[32:35]
  ds_read_b64_tr_b16 a[204:205], v4 offset:128
  v_add_f32 v194, v194, v43
  v_mfma_f32_16x16x32_bf16 a[40:43], a[216:219], v[100:103], a[40:43]
  ds_read_b64_tr_b16 a[206:207], v4 offset:6272
  v_cvt_pk_bf16_f32 v137, v42, v43
  v_mfma_f32_16x16x32_bf16 a[48:51], a[216:219], v[104:107], a[48:51]
  v_mfma_f32_16x16x32_bf16 a[56:59], a[216:219], v[108:111], a[56:59]
  s_waitcnt lgkmcnt(8)
  v_mfma_f32_16x16x32_bf16 a[36:39], a[220:223], v[96:99], a[36:39]
  ds_read_b64_tr_b16 a[208:209], v1 offset:256
  v_exp_f32 v44, v44
  v_mfma_f32_16x16x32_bf16 a[44:47], a[220:223], v[100:103], a[44:47]
  ds_read_b64_tr_b16 a[210:211], v1 offset:6400
  v_exp_f32 v45, v45
  v_mfma_f32_16x16x32_bf16 a[52:55], a[220:223], v[104:107], a[52:55]
  v_add_f32 v195, v195, v44
  v_mfma_f32_16x16x32_bf16 a[60:63], a[220:223], v[108:111], a[60:63]
  v_exp_f32 v46, v46
  s_waitcnt lgkmcnt(8)
  v_mfma_f32_16x16x32_bf16 a[64:67], a[192:195], v[96:99], a[64:67]
  ds_read_b64_tr_b16 a[212:213], v2 offset:256
  v_add_f32 v195, v195, v45
  v_mfma_f32_16x16x32_bf16 a[72:75], a[192:195], v[100:103], a[72:75]
  ds_read_b64_tr_b16 a[214:215], v2 offset:6400
  v_exp_f32 v47, v47
  v_mfma_f32_16x16x32_bf16 a[80:83], a[192:195], v[104:107], a[80:83]
  v_cvt_pk_bf16_f32 v140, v44, v45
  v_mfma_f32_16x16x32_bf16 a[88:91], a[192:195], v[108:111], a[88:91]
  v_add_f32 v195, v195, v46
  s_waitcnt lgkmcnt(8)
  v_mfma_f32_16x16x32_bf16 a[68:71], a[196:199], v[96:99], a[68:71]
  ds_read_b64_tr_b16 a[216:217], v3 offset:256
  v_add_f32 v195, v195, v47
  v_mfma_f32_16x16x32_bf16 a[76:79], a[196:199], v[100:103], a[76:79]
  ds_read_b64_tr_b16 a[218:219], v3 offset:6400
  v_cvt_pk_bf16_f32 v141, v46, v47
  v_mfma_f32_16x16x32_bf16 a[84:87], a[196:199], v[104:107], a[84:87]
  v_mfma_f32_16x16x32_bf16 a[92:95], a[196:199], v[108:111], a[92:95]
  s_waitcnt lgkmcnt(8)
  v_mfma_f32_16x16x32_bf16 a[96:99], a[200:203], v[96:99], a[96:99]
  ds_read_b64_tr_b16 a[220:221], v4 offset:256
  v_exp_f32 v64, v64
  v_mfma_f32_16x16x32_bf16 a[104:107], a[200:203], v[100:103], a[104:107]
  ds_read_b64_tr_b16 a[222:223], v4 offset:6400
  v_exp_f32 v65, v65
  v_mfma_f32_16x16x32_bf16 a[112:115], a[200:203], v[104:107], a[112:115]
  s_waitcnt vmcnt(16)
  s_barrier
  v_add_f32 v192, v192, v64
  v_mfma_f32_16x16x32_bf16 a[120:123], a[200:203], v[108:111], a[120:123]
  v_exp_f32 v66, v66
  s_waitcnt lgkmcnt(8)
  v_mfma_f32_16x16x32_bf16 a[100:103], a[204:207], v[96:99], a[100:103]
  ds_read_b128 a[192:195], v14 offset:24576
  v_add_f32 v192, v192, v65
  v_mfma_f32_16x16x32_bf16 a[108:111], a[204:207], v[100:103], a[108:111]
  s_add_u32 m0, s33, 151552
  v_exp_f32 v67, v67
  v_mfma_f32_16x16x32_bf16 a[116:119], a[204:207], v[104:107], a[116:119]
  buffer_load_dwordx4 v11, s[24:27], s38 offen offset:0 lds
  v_cvt_pk_bf16_f32 v130, v64, v65
  v_mfma_f32_16x16x32_bf16 a[124:127], a[204:207], v[108:111], a[124:127]
  v_add_f32 v192, v192, v66
  s_waitcnt lgkmcnt(7)
  v_mfma_f32_16x16x32_bf16 a[128:131], a[208:211], v[96:99], a[128:131]
  ds_read_b128 a[196:199], v15 offset:24576
  v_add_f32 v192, v192, v67
  v_mfma_f32_16x16x32_bf16 a[136:139], a[208:211], v[100:103], a[136:139]
  v_cvt_pk_bf16_f32 v131, v66, v67
  v_mfma_f32_16x16x32_bf16 a[144:147], a[208:211], v[104:107], a[144:147]
  v_mfma_f32_16x16x32_bf16 a[152:155], a[208:211], v[108:111], a[152:155]
  s_waitcnt lgkmcnt(6)
  v_mfma_f32_16x16x32_bf16 a[132:135], a[212:215], v[96:99], a[132:135]
  ds_read_b128 a[200:203], v14 offset:24704
  v_exp_f32 v68, v68
  v_mfma_f32_16x16x32_bf16 a[140:143], a[212:215], v[100:103], a[140:143]
  buffer_load_dwordx4 v12, s[24:27], s38 offen offset:1024 lds
  v_exp_f32 v69, v69
  v_mfma_f32_16x16x32_bf16 a[148:151], a[212:215], v[104:107], a[148:151]
  v_add_f32 v193, v193, v68
  v_mfma_f32_16x16x32_bf16 a[156:159], a[212:215], v[108:111], a[156:159]
  v_exp_f32 v70, v70
  s_waitcnt lgkmcnt(5)
  v_mfma_f32_16x16x32_bf16 a[160:163], a[216:219], v[96:99], a[160:163]
  ds_read_b128 a[204:207], v15 offset:24704
  v_add_f32 v193, v193, v69
  v_mfma_f32_16x16x32_bf16 a[168:171], a[216:219], v[100:103], a[168:171]
  v_exp_f32 v71, v71
  v_mfma_f32_16x16x32_bf16 a[176:179], a[216:219], v[104:107], a[176:179]
  v_cvt_pk_bf16_f32 v134, v68, v69
  v_mfma_f32_16x16x32_bf16 a[184:187], a[216:219], v[108:111], a[184:187]
  v_add_f32 v193, v193, v70
  s_waitcnt lgkmcnt(4)
  v_mfma_f32_16x16x32_bf16 a[164:167], a[220:223], v[96:99], a[164:167]
  ds_read_b128 a[208:211], v14 offset:24832
  v_add_f32 v193, v193, v71
  v_mfma_f32_16x16x32_bf16 a[172:175], a[220:223], v[100:103], a[172:175]
  buffer_load_dwordx4 v13, s[24:27], s38 offen offset:2048 lds
  v_cvt_pk_bf16_f32 v135, v70, v71
  v_mfma_f32_16x16x32_bf16 a[180:183], a[220:223], v[104:107], a[180:183]
  s_add_u32 s38, s38, 12288
  s_cmp_eq_u32 s38, 196608
  v_mfma_f32_16x16x32_bf16 a[188:191], a[220:223], v[108:111], a[188:191]
  s_waitcnt lgkmcnt(4)
  s_cbranch_scc1 re_p26
re_p22:
  v_mfma_f32_16x16x32_bf16 v[32:35], a[192:195], v[16:19], v[160:163]
  ds_read_b128 a[212:215], v15 offset:24832
  v_exp_f32 v72, v72
  v_mfma_f32_16x16x32_bf16 v[36:39], a[192:195], v[20:23], v[164:167]
  s_add_u32 m0, s33, 77824
  v_exp_f32 v73, v73
  v_mfma_f32_16x16x32_bf16 v[40:43], a[192:195], v[24:27], v[168:171]
  buffer_load_dwordx4 v8, s[20:23], s37 offen offset:0 lds
  v_add_f32 v194, v194, v72
  v_mfma_f32_16x16x32_bf16 v[44:47], a[192:195], v[28:31], v[172:175]
  v_exp_f32 v74, v74
  s_waitcnt lgkmcnt(4)
  v_mfma_f32_16x16x32_bf16 v[32:35], a[196:199], v[48:51], v[32:35]
  ds_read_b128 a[216:219], v14 offset:30720
  v_add_f32 v194, v194, v73
  v_mfma_f32_16x16x32_bf16 v[36:39], a[196:199], v[52:55], v[36:39]
  v_exp_f32 v75, v75
  v_mfma_f32_16x16x32_bf16 v[40:43], a[196:199], v[56:59], v[40:43]
  v_cvt_pk_bf16_f32 v138, v72, v73
  v_mfma_f32_16x16x32_bf16 v[44:47], a[196:199], v[60:63], v[44:47]
  v_add_f32 v194, v194, v74
  s_waitcnt lgkmcnt(4)
  v_mfma_f32_16x16x32_bf16 v[32:35], a[200:203], v[80:83], v[32:35]
  ds_read_b128 a[220:223], v15 offset:30720
  v_add_f32 v194, v194, v75
  v_mfma_f32_16x16x32_bf16 v[36:39], a[200:203], v[84:87], v[36:39]
  v_cvt_pk_bf16_f32 v139, v74, v75
  v_mfma_f32_16x16x32_bf16 v[40:43], a[200:203], v[88:91], v[40:43]
  buffer_load_dwordx4 v9, s[20:23], s37 offen offset:1024 lds
  v_mfma_f32_16x16x32_bf16 v[44:47], a[200:203], v[92:95], v[44:47]
  s_waitcnt lgkmcnt(4)
  v_mfma_f32_16x16x32_bf16 v[32:35], a[204:207], v[112:115], v[32:35]
  ds_read_b128 a[192:195], v14 offset:30848
  v_exp_f32 v76, v76
  v_mfma_f32_16x16x32_bf16 v[36:39], a[204:207], v[116:119], v[36:39]
  v_exp_f32 v77, v77
  v_mfma_f32_16x16x32_bf16 v[40:43], a[204:207], v[120:123], v[40:43]
  v_add_f32 v195, v195, v76
  v_mfma_f32_16x16x32_bf16 v[44:47], a[204:207], v[124:127], v[44:47]
  v_exp_f32 v78, v78
  s_waitcnt lgkmcnt(4)
  v_mfma_f32_16x16x32_bf16 v[32:35], a[208:211], v[144:147], v[32:35]
  ds_read_b128 a[196:199], v15 offset:30848
  v_add_f32 v195, v195, v77
  v_mfma_f32_16x16x32_bf16 v[36:39], a[208:211], v[148:151], v[36:39]
  v_exp_f32 v79, v79
  v_mfma_f32_16x16x32_bf16 v[40:43], a[208:211], v[152:155], v[40:43]
  buffer_load_dwordx4 v10, s[20:23], s37 offen offset:2048 lds
  v_cvt_pk_bf16_f32 v142, v76, v77
  v_mfma_f32_16x16x32_bf16 v[44:47], a[208:211], v[156:159], v[44:47]
  v_add_f32 v195, v195, v78
  s_waitcnt lgkmcnt(4)
  v_mfma_f32_16x16x32_bf16 v[32:35], a[212:215], v[176:179], v[32:35]
  ds_read_b128 a[200:203], v14 offset:30976
  v_add_f32 v195, v195, v79
  v_mfma_f32_16x16x32_bf16 v[36:39], a[212:215], v[180:183], v[36:39]
  s_add_u32 s37, s37, 12288
  v_cvt_pk_bf16_f32 v143, v78, v79
  v_mfma_f32_16x16x32_bf16 v[40:43], a[212:215], v[184:187], v[40:43]
  v_mfma_f32_16x16x32_bf16 v[44:47], a[212:215], v[188:191], v[44:47]
  s_waitcnt lgkmcnt(4)
  v_mfma_f32_16x16x32_bf16 v[64:67], a[216:219], v[16:19], v[160:163]
  ds_read_b128 a[204:207], v15 offset:30976
  v_exp_f32 v32, v32
  v_mfma_f32_16x16x32_bf16 v[68:71], a[216:219], v[20:23], v[164:167]
  v_exp_f32 v33, v33
  v_mfma_f32_16x16x32_bf16 v[72:75], a[216:219], v[24:27], v[168:171]
  v_add_f32 v192, v192, v32
  v_mfma_f32_16x16x32_bf16 v[76:79], a[216:219], v[28:31], v[172:175]
  v_exp_f32 v34, v34
  s_waitcnt lgkmcnt(4)
  v_mfma_f32_16x16x32_bf16 v[64:67], a[220:223], v[48:51], v[64:67]
  ds_read_b64_tr_b16 a[208:209], v1 offset:12288
  v_add_f32 v192, v192, v33
  v_mfma_f32_16x16x32_bf16 v[68:71], a[220:223], v[52:55], v[68:71]
  ds_read_b64_tr_b16 a[210:211], v1 offset:18432
  v_exp_f32 v35, v35
  v_mfma_f32_16x16x32_bf16 v[72:75], a[220:223], v[56:59], v[72:75]
  v_cvt_pk_bf16_f32 v96, v32, v33
  v_mfma_f32_16x16x32_bf16 v[76:79], a[220:223], v[60:63], v[76:79]
  v_add_f32 v192, v192, v34
  s_waitcnt lgkmcnt(5)
  v_mfma_f32_16x16x32_bf16 v[64:67], a[192:195], v[80:83], v[64:67]
  ds_read_b64_tr_b16 a[212:213], v2 offset:12288
  v_add_f32 v192, v192, v35
  v_mfma_f32_16x16x32_bf16 v[68:71], a[192:195], v[84:87], v[68:71]
  ds_read_b64_tr_b16 a[214:215], v2 offset:18432
  v_cvt_pk_bf16_f32 v97, v34, v35
  v_mfma_f32_16x16x32_bf16 v[72:75], a[192:195], v[88:91], v[72:75]
  v_mfma_f32_16x16x32_bf16 v[76:79], a[192:195], v[92:95], v[76:79]
  s_waitcnt lgkmcnt(6)
  v_mfma_f32_16x16x32_bf16 v[64:67], a[196:199], v[112:115], v[64:67]
  ds_read_b64_tr_b16 a[216:217], v3 offset:12288
  v_exp_f32 v36, v36
  v_mfma_f32_16x16x32_bf16 v[68:71], a[196:199], v[116:119], v[68:71]
  ds_read_b64_tr_b16 a[218:219], v3 offset:18432
  v_exp_f32 v37, v37
  v_mfma_f32_16x16x32_bf16 v[72:75], a[196:199], v[120:123], v[72:75]
  v_add_f32 v193, v193, v36
  v_mfma_f32_16x16x32_bf16 v[76:79], a[196:199], v[124:127], v[76:79]
  v_exp_f32 v38, v38
  s_waitcnt lgkmcnt(7)
  v_mfma_f32_16x16x32_bf16 v[64:67], a[200:203], v[144:147], v[64:67]
  ds_read_b64_tr_b16 a[220:221], v4 offset:12288
  v_add_f32 v193, v193, v37
  v_mfma_f32_16x16x32_bf16 v[68:71], a[200:203], v[148:151], v[68:71]
  ds_read_b64_tr_b16 a[222:223], v4 offset:18432
  v_exp_f32 v39, v39
  v_mfma_f32_16x16x32_bf16 v[72:75], a[200:203], v[152:155], v[72:75]
  v_cvt_pk_bf16_f32 v100, v36, v37
  v_mfma_f32_16x16x32_bf16 v[76:79], a[200:203], v[156:159], v[76:79]
  v_add_f32 v193, v193, v38
  s_waitcnt lgkmcnt(8)
  v_mfma_f32_16x16x32_bf16 v[64:67], a[204:207], v[176:179], v[64:67]
  ds_read_b64_tr_b16 a[192:193], v1 offset:12416
  v_add_f32 v193, v193, v39
  v_mfma_f32_16x16x32_bf16 v[68:71], a[204:207], v[180:183], v[68:71]
  ds_read_b64_tr_b16 a[194:195], v1 offset:18560
  v_cvt_pk_bf16_f32 v101, v38, v39
  v_mfma_f32_16x16x32_bf16 v[72:75], a[204:207], v[184:187], v[72:75]
  v_mfma_f32_16x16x32_bf16 v[76:79], a[204:207], v[188:191], v[76:79]
  s_waitcnt lgkmcnt(8)
  v_mfma_f32_16x16x32_bf16 a[0:3], a[208:211], v[128:131], a[0:3]
  ds_read_b64_tr_b16 a[196:197], v2 offset:12416
  v_exp_f32 v40, v40
  v_mfma_f32_16x16x32_bf16 a[8:11], a[208:211], v[132:135], a[8:11]
  ds_read_b64_tr_b16 a[198:199], v2 offset:18560
  v_exp_f32 v41, v41
  v_mfma_f32_16x16x32_bf16 a[16:19], a[208:211], v[136:139], a[16:19]
  v_add_f32 v194, v194, v40
  v_mfma_f32_16x16x32_bf16 a[24:27], a[208:211], v[140:143], a[24:27]
  v_exp_f32 v42, v42
  s_waitcnt lgkmcnt(8)
  v_mfma_f32_16x16x32_bf16 a[4:7], a[212:215], v[128:131], a[4:7]
  ds_read_b64_tr_b16 a[200:201], v3 offset:12416
  v_add_f32 v194, v194, v41
  v_mfma_f32_16x16x32_bf16 a[12:15], a[212:215], v[132:135], a[12:15]
  ds_read_b64_tr_b16 a[202:203], v3 offset:18560
  v_exp_f32 v43, v43
  v_mfma_f32_16x16x32_bf16 a[20:23], a[212:215], v[136:139], a[20:23]
  v_cvt_pk_bf16_f32 v104, v40, v41
  v_mfma_f32_16x16x32_bf16 a[28:31], a[212:215], v[140:143], a[28:31]
  v_add_f32 v194, v194, v42
  s_waitcnt lgkmcnt(8)
  v_mfma_f32_16x16x32_bf16 a[32:35], a[216:219], v[128:131], a[32:35]
  ds_read_b64_tr_b16 a[204:205], v4 offset:12416
  v_add_f32 v194, v194, v43
  v_mfma_f32_16x16x32_bf16 a[40:43], a[216:219], v[132:135], a[40:43]
  ds_read_b64_tr_b16 a[206:207], v4 offset:18560
  v_cvt_pk_bf16_f32 v105, v42, v43
  v_mfma_f32_16x16x32_bf16 a[48:51], a[216:219], v[136:139], a[48:51]
  v_mfma_f32_16x16x32_bf16 a[56:59], a[216:219], v[140:143], a[56:59]
  s_waitcnt lgkmcnt(8)
  v_mfma_f32_16x16x32_bf16 a[36:39], a[220:223], v[128:131], a[36:39]
  ds_read_b64_tr_b16 a[208:209], v1 offset:12544
  v_exp_f32 v44, v44
  v_mfma_f32_16x16x32_bf16 a[44:47], a[220:223], v[132:135], a[44:47]
  ds_read_b64_tr_b16 a[210:211], v1 offset:18688
  v_exp_f32 v45, v45
  v_mfma_f32_16x16x32_bf16 a[52:55], a[220:223], v[136:139], a[52:55]
  v_add_f32 v195, v195, v44
  v_mfma_f32_16x16x32_bf16 a[60:63], a[220:223], v[140:143], a[60:63]
  v_exp_f32 v46, v46
  s_waitcnt lgkmcnt(8)
  v_mfma_f32_16x16x32_bf16 a[64:67], a[192:195], v[128:131], a[64:67]
  ds_read_b64_tr_b16 a[212:213], v2 offset:12544
  v_add_f32 v195, v195, v45
  v_mfma_f32_16x16x32_bf16 a[72:75], a[192:195], v[132:135], a[72:75]
  ds_read_b64_tr_b16 a[214:215], v2 offset:18688
  v_exp_f32 v47, v47
  v_mfma_f32_16x16x32_bf16 a[80:83], a[192:195], v[136:139], a[80:83]
  v_cvt_pk_bf16_f32 v108, v44, v45
  v_mfma_f32_16x16x32_bf16 a[88:91], a[192:195], v[140:143], a[88:91]
  v_add_f32 v195, v195, v46
  s_waitcnt lgkmcnt(8)
  v_mfma_f32_16x16x32_bf16 a[68:71], a[196:199], v[128:131], a[68:71]
  ds_read_b64_tr_b16 a[216:217], v3 offset:12544
  v_add_f32 v195, v195, v47
  v_mfma_f32_16x16x32_bf16 a[76:79], a[196:199], v[132:135], a[76:79]
  ds_read_b64_tr_b16 a[218:219], v3 offset:18688
  v_cvt_pk_bf16_f32 v109, v46, v47
  v_mfma_f32_16x16x32_bf16 a[84:87], a[196:199], v[136:139], a[84:87]
  v_mfma_f32_16x16x32_bf16 a[92:95], a[196:199], v[140:143], a[92:95]
  s_waitcnt lgkmcnt(8)
  v_mfma_f32_16x16x32_bf16 a[96:99], a[200:203], v[128:131], a[96:99]
  ds_read_b64_tr_b16 a[220:221], v4 offset:12544
  v_exp_f32 v64, v64
  v_mfma_f32_16x16x32_bf16 a[104:107], a[200:203], v[132:135], a[104:107]
  ds_read_b64_tr_b16 a[222:223], v4 offset:18688
  v_exp_f32 v65, v65
  v_mfma_f32_16x16x32_bf16 a[112:115], a[200:203], v[136:139], a[112:115]
  s_waitcnt vmcnt(11)
  s_barrier
  v_add_f32 v192, v192, v64
  v_mfma_f32_16x16x32_bf16 a[120:123], a[200:203], v[140:143], a[120:123]
  v_exp_f32 v66, v66
  s_waitcnt lgkmcnt(8)
  v_mfma_f32_16x16x32_bf16 a[100:103], a[204:207], v[128:131], a[100:103]
  ds_read_b128 a[192:195], v14 offset:36864
  v_add_f32 v192, v192, v65
  v_mfma_f32_16x16x32_bf16 a[108:111], a[204:207], v[132:135], a[108:111]
  s_add_u32 m0, s33, 114688
  v_exp_f32 v67, v67
  v_mfma_f32_16x16x32_bf16 a[116:119], a[204:207], v[136:139], a[116:119]
  buffer_load_dwordx4 v11, s[24:27], s38 offen offset:0 lds
  v_cvt_pk_bf16_f32 v98, v64, v65
  v_mfma_f32_16x16x32_bf16 a[124:127], a[204:207], v[140:143], a[124:127]
  v_add_f32 v192, v192, v66
  s_waitcnt lgkmcnt(7)
  v_mfma_f32_16x16x32_bf16 a[128:131], a[208:211], v[128:131], a[128:131]
  ds_read_b128 a[196:199], v15 offset:36864
  v_add_f32 v192, v192, v67
  v_mfma_f32_16x16x32_bf16 a[136:139], a[208:211], v[132:135], a[136:139]
  v_cvt_pk_bf16_f32 v99, v66, v67
  v_mfma_f32_16x16x32_bf16 a[144:147], a[208:211], v[136:139], a[144:147]
  v_mfma_f32_16x16x32_bf16 a[152:155], a[208:211], v[140:143], a[152:155]
  s_waitcnt lgkmcnt(6)
  v_mfma_f32_16x16x32_bf16 a[132:135], a[212:215], v[128:131], a[132:135]
  ds_read_b128 a[200:203], v14 offset:36992
  v_exp_f32 v68, v68
  v_mfma_f32_16x16x32_bf16 a[140:143], a[212:215], v[132:135], a[140:143]
  buffer_load_dwordx4 v12, s[24:27], s38 offen offset:1024 lds
  v_exp_f32 v69, v69
  v_mfma_f32_16x16x32_bf16 a[148:151], a[212:215], v[136:139], a[148:151]
  v_add_f32 v193, v193, v68
  v_mfma_f32_16x16x32_bf16 a[156:159], a[212:215], v[140:143], a[156:159]
  v_exp_f32 v70, v70
  s_waitcnt lgkmcnt(5)
  v_mfma_f32_16x16x32_bf16 a[160:163], a[216:219], v[128:131], a[160:163]
  ds_read_b128 a[204:207], v15 offset:36992
  v_add_f32 v193, v193, v69
  v_mfma_f32_16x16x32_bf16 a[168:171], a[216:219], v[132:135], a[168:171]
  v_exp_f32 v71, v71
  v_mfma_f32_16x16x32_bf16 a[176:179], a[216:219], v[136:139], a[176:179]
  v_cvt_pk_bf16_f32 v102, v68, v69
  v_mfma_f32_16x16x32_bf16 a[184:187], a[216:219], v[140:143], a[184:187]
  v_add_f32 v193, v193, v70
  s_waitcnt lgkmcnt(4)
  v_mfma_f32_16x16x32_bf16 a[164:167], a[220:223], v[128:131], a[164:167]
  ds_read_b128 a[208:211], v14 offset:37120
  v_add_f32 v193, v193, v71
  v_mfma_f32_16x16x32_bf16 a[172:175], a[220:223], v[132:135], a[172:175]
  buffer_load_dwordx4 v13, s[24:27], s38 offen offset:2048 lds
  v_cvt_pk_bf16_f32 v103, v70, v71
  v_mfma_f32_16x16x32_bf16 a[180:183], a[220:223], v[136:139], a[180:183]
  s_add_u32 s38, s38, 12288
  v_mfma_f32_16x16x32_bf16 a[188:191], a[220:223], v[140:143], a[188:191]
  s_waitcnt lgkmcnt(4)
re_p23:
  v_mfma_f32_16x16x32_bf16 v[32:35], a[192:195], v[16:19], v[160:163]
  ds_read_b128 a[212:215], v15 offset:37120
  v_exp_f32 v72, v72
  v_mfma_f32_16x16x32_bf16 v[36:39], a[192:195], v[20:23], v[164:167]
  s_add_u32 m0, s33, 90112
  v_exp_f32 v73, v73
  v_mfma_f32_16x16x32_bf16 v[40:43], a[192:195], v[24:27], v[168:171]
  buffer_load_dwordx4 v8, s[20:23], s37 offen offset:0 lds
  v_add_f32 v194, v194, v72
  v_mfma_f32_16x16x32_bf16 v[44:47], a[192:195], v[28:31], v[172:175]
  v_exp_f32 v74, v74
  s_waitcnt lgkmcnt(4)
  v_mfma_f32_16x16x32_bf16 v[32:35], a[196:199], v[48:51], v[32:35]
  ds_read_b128 a[216:219], v14 offset:43008
  v_add_f32 v194, v194, v73
  v_mfma_f32_16x16x32_bf16 v[36:39], a[196:199], v[52:55], v[36:39]
  v_exp_f32 v75, v75
  v_mfma_f32_16x16x32_bf16 v[40:43], a[196:199], v[56:59], v[40:43]
  v_cvt_pk_bf16_f32 v106, v72, v73
  v_mfma_f32_16x16x32_bf16 v[44:47], a[196:199], v[60:63], v[44:47]
  v_add_f32 v194, v194, v74
  s_waitcnt lgkmcnt(4)
  v_mfma_f32_16x16x32_bf16 v[32:35], a[200:203], v[80:83], v[32:35]
  ds_read_b128 a[220:223], v15 offset:43008
  v_add_f32 v194, v194, v75
  v_mfma_f32_16x16x32_bf16 v[36:39], a[200:203], v[84:87], v[36:39]
  v_cvt_pk_bf16_f32 v107, v74, v75
  v_mfma_f32_16x16x32_bf16 v[40:43], a[200:203], v[88:91], v[40:43]
  buffer_load_dwordx4 v9, s[20:23], s37 offen offset:1024 lds
  v_mfma_f32_16x16x32_bf16 v[44:47], a[200:203], v[92:95], v[44:47]
  s_waitcnt lgkmcnt(4)
  v_mfma_f32_16x16x32_bf16 v[32:35], a[204:207], v[112:115], v[32:35]
  ds_read_b128 a[192:195], v14 offset:43136
  v_exp_f32 v76, v76
  v_mfma_f32_16x16x32_bf16 v[36:39], a[204:207], v[116:119], v[36:39]
  v_exp_f32 v77, v77
  v_mfma_f32_16x16x32_bf16 v[40:43], a[204:207], v[120:123], v[40:43]
  v_add_f32 v195, v195, v76
  v_mfma_f32_16x16x32_bf16 v[44:47], a[204:207], v[124:127], v[44:47]
  v_exp_f32 v78, v78
  s_waitcnt lgkmcnt(4)
  v_mfma_f32_16x16x32_bf16 v[32:35], a[208:211], v[144:147], v[32:35]
  ds_read_b128 a[196:199], v15 offset:43136
  v_add_f32 v195, v195, v77
  v_mfma_f32_16x16x32_bf16 v[36:39], a[208:211], v[148:151], v[36:39]
  v_exp_f32 v79, v79
  v_mfma_f32_16x16x32_bf16 v[40:43], a[208:211], v[152:155], v[40:43]
  buffer_load_dwordx4 v10, s[20:23], s37 offen offset:2048 lds
  v_cvt_pk_bf16_f32 v110, v76, v77
  v_mfma_f32_16x16x32_bf16 v[44:47], a[208:211], v[156:159], v[44:47]
  v_add_f32 v195, v195, v78
  s_waitcnt lgkmcnt(4)
  v_mfma_f32_16x16x32_bf16 v[32:35], a[212:215], v[176:179], v[32:35]
  ds_read_b128 a[200:203], v14 offset:43264
  v_add_f32 v195, v195, v79
  v_mfma_f32_16x16x32_bf16 v[36:39], a[212:215], v[180:183], v[36:39]
  s_add_u32 s37, s37, 12288
  v_cvt_pk_bf16_f32 v111, v78, v79
  v_mfma_f32_16x16x32_bf16 v[40:43], a[212:215], v[184:187], v[40:43]
  v_mfma_f32_16x16x32_bf16 v[44:47], a[212:215], v[188:191], v[44:47]
  s_waitcnt lgkmcnt(4)
  v_mfma_f32_16x16x32_bf16 v[64:67], a[216:219], v[16:19], v[160:163]
  ds_read_b128 a[204:207], v15 offset:43264
  v_exp_f32 v32, v32
  v_mfma_f32_16x16x32_bf16 v[68:71], a[216:219], v[20:23], v[164:167]
  v_exp_f32 v33, v33
  v_mfma_f32_16x16x32_bf16 v[72:75], a[216:219], v[24:27], v[168:171]
  v_add_f32 v192, v192, v32
  v_mfma_f32_16x16x32_bf16 v[76:79], a[216:219], v[28:31], v[172:175]
  v_exp_f32 v34, v34
  s_waitcnt lgkmcnt(4)
  v_mfma_f32_16x16x32_bf16 v[64:67], a[220:223], v[48:51], v[64:67]
  ds_read_b64_tr_b16 a[208:209], v1 offset:24576
  v_add_f32 v192, v192, v33
  v_mfma_f32_16x16x32_bf16 v[68:71], a[220:223], v[52:55], v[68:71]
  ds_read_b64_tr_b16 a[210:211], v1 offset:30720
  v_exp_f32 v35, v35
  v_mfma_f32_16x16x32_bf16 v[72:75], a[220:223], v[56:59], v[72:75]
  v_cvt_pk_bf16_f32 v128, v32, v33
  v_mfma_f32_16x16x32_bf16 v[76:79], a[220:223], v[60:63], v[76:79]
  v_add_f32 v192, v192, v34
  s_waitcnt lgkmcnt(5)
  v_mfma_f32_16x16x32_bf16 v[64:67], a[192:195], v[80:83], v[64:67]
  ds_read_b64_tr_b16 a[212:213], v2 offset:24576
  v_add_f32 v192, v192, v35
  v_mfma_f32_16x16x32_bf16 v[68:71], a[192:195], v[84:87], v[68:71]
  ds_read_b64_tr_b16 a[214:215], v2 offset:30720
  v_cvt_pk_bf16_f32 v129, v34, v35
  v_mfma_f32_16x16x32_bf16 v[72:75], a[192:195], v[88:91], v[72:75]
  v_mfma_f32_16x16x32_bf16 v[76:79], a[192:195], v[92:95], v[76:79]
  s_waitcnt lgkmcnt(6)
  v_mfma_f32_16x16x32_bf16 v[64:67], a[196:199], v[112:115], v[64:67]
  ds_read_b64_tr_b16 a[216:217], v3 offset:24576
  v_exp_f32 v36, v36
  v_mfma_f32_16x16x32_bf16 v[68:71], a[196:199], v[116:119], v[68:71]
  ds_read_b64_tr_b16 a[218:219], v3 offset:30720
  v_exp_f32 v37, v37
  v_mfma_f32_16x16x32_bf16 v[72:75], a[196:199], v[120:123], v[72:75]
  v_add_f32 v193, v193, v36
  v_mfma_f32_16x16x32_bf16 v[76:79], a[196:199], v[124:127], v[76:79]
  v_exp_f32 v38, v38
  s_waitcnt lgkmcnt(7)
  v_mfma_f32_16x16x32_bf16 v[64:67], a[200:203], v[144:147], v[64:67]
  ds_read_b64_tr_b16 a[220:221], v4 offset:24576
  v_add_f32 v193, v193, v37
  v_mfma_f32_16x16x32_bf16 v[68:71], a[200:203], v[148:151], v[68:71]
  ds_read_b64_tr_b16 a[222:223], v4 offset:30720
  v_exp_f32 v39, v39
  v_mfma_f32_16x16x32_bf16 v[72:75], a[200:203], v[152:155], v[72:75]
  v_cvt_pk_bf16_f32 v132, v36, v37
  v_mfma_f32_16x16x32_bf16 v[76:79], a[200:203], v[156:159], v[76:79]
  v_add_f32 v193, v193, v38
  s_waitcnt lgkmcnt(8)
  v_mfma_f32_16x16x32_bf16 v[64:67], a[204:207], v[176:179], v[64:67]
  ds_read_b64_tr_b16 a[192:193], v1 offset:24704
  v_add_f32 v193, v193, v39
  v_mfma_f32_16x16x32_bf16 v[68:71], a[204:207], v[180:183], v[68:71]
  ds_read_b64_tr_b16 a[194:195], v1 offset:30848
  v_cvt_pk_bf16_f32 v133, v38, v39
  v_mfma_f32_16x16x32_bf16 v[72:75], a[204:207], v[184:187], v[72:75]
  v_mfma_f32_16x16x32_bf16 v[76:79], a[204:207], v[188:191], v[76:79]
  s_waitcnt lgkmcnt(8)
  v_mfma_f32_16x16x32_bf16 a[0:3], a[208:211], v[96:99], a[0:3]
  ds_read_b64_tr_b16 a[196:197], v2 offset:24704
  v_exp_f32 v40, v40
  v_mfma_f32_16x16x32_bf16 a[8:11], a[208:211], v[100:103], a[8:11]
  ds_read_b64_tr_b16 a[198:199], v2 offset:30848
  v_exp_f32 v41, v41
  v_mfma_f32_16x16x32_bf16 a[16:19], a[208:211], v[104:107], a[16:19]
  v_add_f32 v194, v194, v40
  v_mfma_f32_16x16x32_bf16 a[24:27], a[208:211], v[108:111], a[24:27]
  v_exp_f32 v42, v42
  s_waitcnt lgkmcnt(8)
  v_mfma_f32_16x16x32_bf16 a[4:7], a[212:215], v[96:99], a[4:7]
  ds_read_b64_tr_b16 a[200:201], v3 offset:24704
  v_add_f32 v194, v194, v41
  v_mfma_f32_16x16x32_bf16 a[12:15], a[212:215], v[100:103], a[12:15]
  ds_read_b64_tr_b16 a[202:203], v3 offset:30848
  v_exp_f32 v43, v43
  v_mfma_f32_16x16x32_bf16 a[20:23], a[212:215], v[104:107], a[20:23]
  v_cvt_pk_bf16_f32 v136, v40, v41
  v_mfma_f32_16x16x32_bf16 a[28:31], a[212:215], v[108:111], a[28:31]
  v_add_f32 v194, v194, v42
  s_waitcnt lgkmcnt(8)
  v_mfma_f32_16x16x32_bf16 a[32:35], a[216:219], v[96:99], a[32:35]
  ds_read_b64_tr_b16 a[204:205], v4 offset:24704
  v_add_f32 v194, v194, v43
  v_mfma_f32_16x16x32_bf16 a[40:43], a[216:219], v[100:103], a[40:43]
  ds_read_b64_tr_b16 a[206:207], v4 offset:30848
  v_cvt_pk_bf16_f32 v137, v42, v43
  v_mfma_f32_16x16x32_bf16 a[48:51], a[216:219], v[104:107], a[48:51]
  v_mfma_f32_16x16x32_bf16 a[56:59], a[216:219], v[108:111], a[56:59]
  s_waitcnt lgkmcnt(8)
  v_mfma_f32_16x16x32_bf16 a[36:39], a[220:223], v[96:99], a[36:39]
  ds_read_b64_tr_b16 a[208:209], v1 offset:24832
  v_exp_f32 v44, v44
  v_mfma_f32_16x16x32_bf16 a[44:47], a[220:223], v[100:103], a[44:47]
  ds_read_b64_tr_b16 a[210:211], v1 offset:30976
  v_exp_f32 v45, v45
  v_mfma_f32_16x16x32_bf16 a[52:55], a[220:223], v[104:107], a[52:55]
  v_add_f32 v195, v195, v44
  v_mfma_f32_16x16x32_bf16 a[60:63], a[220:223], v[108:111], a[60:63]
  v_exp_f32 v46, v46
  s_waitcnt lgkmcnt(8)
  v_mfma_f32_16x16x32_bf16 a[64:67], a[192:195], v[96:99], a[64:67]
  ds_read_b64_tr_b16 a[212:213], v2 offset:24832
  v_add_f32 v195, v195, v45
  v_mfma_f32_16x16x32_bf16 a[72:75], a[192:195], v[100:103], a[72:75]
  ds_read_b64_tr_b16 a[214:215], v2 offset:30976
  v_exp_f32 v47, v47
  v_mfma_f32_16x16x32_bf16 a[80:83], a[192:195], v[104:107], a[80:83]
  v_cvt_pk_bf16_f32 v140, v44, v45
  v_mfma_f32_16x16x32_bf16 a[88:91], a[192:195], v[108:111], a[88:91]
  v_add_f32 v195, v195, v46
  s_waitcnt lgkmcnt(8)
  v_mfma_f32_16x16x32_bf16 a[68:71], a[196:199], v[96:99], a[68:71]
  ds_read_b64_tr_b16 a[216:217], v3 offset:24832
  v_add_f32 v195, v195, v47
  v_mfma_f32_16x16x32_bf16 a[76:79], a[196:199], v[100:103], a[76:79]
  ds_read_b64_tr_b16 a[218:219], v3 offset:30976
  v_cvt_pk_bf16_f32 v141, v46, v47
  v_mfma_f32_16x16x32_bf16 a[84:87], a[196:199], v[104:107], a[84:87]
  v_mfma_f32_16x16x32_bf16 a[92:95], a[196:199], v[108:111], a[92:95]
  s_waitcnt lgkmcnt(8)
  v_mfma_f32_16x16x32_bf16 a[96:99], a[200:203], v[96:99], a[96:99]
  ds_read_b64_tr_b16 a[220:221], v4 offset:24832
  v_exp_f32 v64, v64
  v_mfma_f32_16x16x32_bf16 a[104:107], a[200:203], v[100:103], a[104:107]
  ds_read_b64_tr_b16 a[222:223], v4 offset:30976
  v_exp_f32 v65, v65
  v_mfma_f32_16x16x32_bf16 a[112:115], a[200:203], v[104:107], a[112:115]
  s_waitcnt vmcnt(9)
  s_barrier
  v_add_f32 v192, v192, v64
  v_mfma_f32_16x16x32_bf16 a[120:123], a[200:203], v[108:111], a[120:123]
  v_exp_f32 v66, v66
  s_waitcnt lgkmcnt(8)
  v_mfma_f32_16x16x32_bf16 a[100:103], a[204:207], v[96:99], a[100:103]
  ds_read_b128 a[192:195], v14 offset:0
  v_add_f32 v192, v192, v65
  v_mfma_f32_16x16x32_bf16 a[108:111], a[204:207], v[100:103], a[108:111]
  s_add_u32 m0, s33, 126976
  v_exp_f32 v67, v67
  v_mfma_f32_16x16x32_bf16 a[116:119], a[204:207], v[104:107], a[116:119]
  buffer_load_dwordx4 v11, s[24:27], s38 offen offset:0 lds
  v_cvt_pk_bf16_f32 v130, v64, v65
  v_mfma_f32_16x16x32_bf16 a[124:127], a[204:207], v[108:111], a[124:127]
  v_add_f32 v192, v192, v66
  s_waitcnt lgkmcnt(7)
  v_mfma_f32_16x16x32_bf16 a[128:131], a[208:211], v[96:99], a[128:131]
  ds_read_b128 a[196:199], v15 offset:0
  v_add_f32 v192, v192, v67
  v_mfma_f32_16x16x32_bf16 a[136:139], a[208:211], v[100:103], a[136:139]
  v_cvt_pk_bf16_f32 v131, v66, v67
  v_mfma_f32_16x16x32_bf16 a[144:147], a[208:211], v[104:107], a[144:147]
  buffer_store_dword v5, v207, s[76:79], s71 offen sc1
  v_mfma_f32_16x16x32_bf16 a[152:155], a[208:211], v[108:111], a[152:155]
  s_waitcnt lgkmcnt(6)
  v_mfma_f32_16x16x32_bf16 a[132:135], a[212:215], v[96:99], a[132:135]
  ds_read_b128 a[200:203], v14 offset:128
  v_exp_f32 v68, v68
  v_mfma_f32_16x16x32_bf16 a[140:143], a[212:215], v[100:103], a[140:143]
  buffer_load_dwordx4 v12, s[24:27], s38 offen offset:1024 lds
  v_exp_f32 v69, v69
  v_mfma_f32_16x16x32_bf16 a[148:151], a[212:215], v[104:107], a[148:151]
  v_add_f32 v193, v193, v68
  v_mfma_f32_16x16x32_bf16 a[156:159], a[212:215], v[108:111], a[156:159]
  v_exp_f32 v70, v70
  s_waitcnt lgkmcnt(5)
  v_mfma_f32_16x16x32_bf16 a[160:163], a[216:219], v[96:99], a[160:163]
  ds_read_b128 a[204:207], v15 offset:128
  v_add_f32 v193, v193, v69
  v_mfma_f32_16x16x32_bf16 a[168:171], a[216:219], v[100:103], a[168:171]
  v_exp_f32 v71, v71
  v_mfma_f32_16x16x32_bf16 a[176:179], a[216:219], v[104:107], a[176:179]
  v_cvt_pk_bf16_f32 v134, v68, v69
  v_mfma_f32_16x16x32_bf16 a[184:187], a[216:219], v[108:111], a[184:187]
  v_add_f32 v193, v193, v70
  s_waitcnt lgkmcnt(4)
  v_mfma_f32_16x16x32_bf16 a[164:167], a[220:223], v[96:99], a[164:167]
  ds_read_b128 a[208:211], v14 offset:256
  v_add_f32 v193, v193, v71
  v_mfma_f32_16x16x32_bf16 a[172:175], a[220:223], v[100:103], a[172:175]
  buffer_load_dwordx4 v13, s[24:27], s38 offen offset:2048 lds
  v_cvt_pk_bf16_f32 v135, v70, v71
  v_mfma_f32_16x16x32_bf16 a[180:183], a[220:223], v[104:107], a[180:183]
  s_add_u32 s38, s38, 12288
  v_mfma_f32_16x16x32_bf16 a[188:191], a[220:223], v[108:111], a[188:191]
  s_waitcnt lgkmcnt(4)
re_p20:
  v_mfma_f32_16x16x32_bf16 v[32:35], a[192:195], v[16:19], v[160:163]
  ds_read_b128 a[212:215], v15 offset:256
  v_exp_f32 v72, v72
  v_mfma_f32_16x16x32_bf16 v[36:39], a[192:195], v[20:23], v[164:167]
  s_add_u32 m0, s33, 102400
  v_exp_f32 v73, v73
  v_mfma_f32_16x16x32_bf16 v[40:43], a[192:195], v[24:27], v[168:171]
  buffer_load_dwordx4 v8, s[20:23], s37 offen offset:0 lds
  v_add_f32 v194, v194, v72
  v_mfma_f32_16x16x32_bf16 v[44:47], a[192:195], v[28:31], v[172:175]
  v_exp_f32 v74, v74
  s_waitcnt lgkmcnt(4)
  v_mfma_f32_16x16x32_bf16 v[32:35], a[196:199], v[48:51], v[32:35]
  ds_read_b128 a[216:219], v14 offset:6144
  v_add_f32 v194, v194, v73
  v_mfma_f32_16x16x32_bf16 v[36:39], a[196:199], v[52:55], v[36:39]
  v_exp_f32 v75, v75
  v_mfma_f32_16x16x32_bf16 v[40:43], a[196:199], v[56:59], v[40:43]
  v_cvt_pk_bf16_f32 v138, v72, v73
  v_mfma_f32_16x16x32_bf16 v[44:47], a[196:199], v[60:63], v[44:47]
  v_add_f32 v194, v194, v74
  s_waitcnt lgkmcnt(4)
  v_mfma_f32_16x16x32_bf16 v[32:35], a[200:203], v[80:83], v[32:35]
  ds_read_b128 a[220:223], v15 offset:6144
  v_add_f32 v194, v194, v75
  v_mfma_f32_16x16x32_bf16 v[36:39], a[200:203], v[84:87], v[36:39]
  v_cvt_pk_bf16_f32 v139, v74, v75
  v_mfma_f32_16x16x32_bf16 v[40:43], a[200:203], v[88:91], v[40:43]
  buffer_load_dwordx4 v9, s[20:23], s37 offen offset:1024 lds
  v_mfma_f32_16x16x32_bf16 v[44:47], a[200:203], v[92:95], v[44:47]
  s_waitcnt lgkmcnt(4)
  v_mfma_f32_16x16x32_bf16 v[32:35], a[204:207], v[112:115], v[32:35]
  ds_read_b128 a[192:195], v14 offset:6272
  v_exp_f32 v76, v76
  v_mfma_f32_16x16x32_bf16 v[36:39], a[204:207], v[116:119], v[36:39]
  v_exp_f32 v77, v77
  v_mfma_f32_16x16x32_bf16 v[40:43], a[204:207], v[120:123], v[40:43]
  v_add_f32 v195, v195, v76
  v_mfma_f32_16x16x32_bf16 v[44:47], a[204:207], v[124:127], v[44:47]
  v_exp_f32 v78, v78
  s_waitcnt lgkmcnt(4)
  v_mfma_f32_16x16x32_bf16 v[32:35], a[208:211], v[144:147], v[32:35]
  ds_read_b128 a[196:199], v15 offset:6272
  v_add_f32 v195, v195, v77
  v_mfma_f32_16x16x32_bf16 v[36:39], a[208:211], v[148:151], v[36:39]
  v_exp_f32 v79, v79
  v_mfma_f32_16x16x32_bf16 v[40:43], a[208:211], v[152:155], v[40:43]
  buffer_load_dwordx4 v10, s[20:23], s37 offen offset:2048 lds
  v_cvt_pk_bf16_f32 v142, v76, v77
  v_mfma_f32_16x16x32_bf16 v[44:47], a[208:211], v[156:159], v[44:47]
  v_add_f32 v195, v195, v78
  s_waitcnt lgkmcnt(4)
  v_mfma_f32_16x16x32_bf16 v[32:35], a[212:215], v[176:179], v[32:35]
  ds_read_b128 a[200:203], v14 offset:6400
  v_add_f32 v195, v195, v79
  v_mfma_f32_16x16x32_bf16 v[36:39], a[212:215], v[180:183], v[36:39]
  s_add_u32 s37, s37, 12288
  v_cvt_pk_bf16_f32 v143, v78, v79
  v_mfma_f32_16x16x32_bf16 v[40:43], a[212:215], v[184:187], v[40:43]
  v_mfma_f32_16x16x32_bf16 v[44:47], a[212:215], v[188:191], v[44:47]
  s_waitcnt lgkmcnt(4)
  v_mfma_f32_16x16x32_bf16 v[64:67], a[216:219], v[16:19], v[160:163]
  ds_read_b128 a[204:207], v15 offset:6400
  v_exp_f32 v32, v32
  v_mfma_f32_16x16x32_bf16 v[68:71], a[216:219], v[20:23], v[164:167]
  v_exp_f32 v33, v33
  v_mfma_f32_16x16x32_bf16 v[72:75], a[216:219], v[24:27], v[168:171]
  v_add_f32 v192, v192, v32
  v_mfma_f32_16x16x32_bf16 v[76:79], a[216:219], v[28:31], v[172:175]
  v_exp_f32 v34, v34
  s_waitcnt lgkmcnt(4)
  v_mfma_f32_16x16x32_bf16 v[64:67], a[220:223], v[48:51], v[64:67]
  ds_read_b64_tr_b16 a[208:209], v1 offset:36864
  v_add_f32 v192, v192, v33
  v_mfma_f32_16x16x32_bf16 v[68:71], a[220:223], v[52:55], v[68:71]
  ds_read_b64_tr_b16 a[210:211], v1 offset:43008
  v_exp_f32 v35, v35
  v_mfma_f32_16x16x32_bf16 v[72:75], a[220:223], v[56:59], v[72:75]
  v_cvt_pk_bf16_f32 v96, v32, v33
  v_mfma_f32_16x16x32_bf16 v[76:79], a[220:223], v[60:63], v[76:79]
  v_add_f32 v192, v192, v34
  s_waitcnt lgkmcnt(5)
  v_mfma_f32_16x16x32_bf16 v[64:67], a[192:195], v[80:83], v[64:67]
  ds_read_b64_tr_b16 a[212:213], v2 offset:36864
  v_add_f32 v192, v192, v35
  v_mfma_f32_16x16x32_bf16 v[68:71], a[192:195], v[84:87], v[68:71]
  ds_read_b64_tr_b16 a[214:215], v2 offset:43008
  v_cvt_pk_bf16_f32 v97, v34, v35
  v_mfma_f32_16x16x32_bf16 v[72:75], a[192:195], v[88:91], v[72:75]
  v_mfma_f32_16x16x32_bf16 v[76:79], a[192:195], v[92:95], v[76:79]
  s_waitcnt lgkmcnt(6)
  v_mfma_f32_16x16x32_bf16 v[64:67], a[196:199], v[112:115], v[64:67]
  ds_read_b64_tr_b16 a[216:217], v3 offset:36864
  v_exp_f32 v36, v36
  v_mfma_f32_16x16x32_bf16 v[68:71], a[196:199], v[116:119], v[68:71]
  ds_read_b64_tr_b16 a[218:219], v3 offset:43008
  v_exp_f32 v37, v37
  v_mfma_f32_16x16x32_bf16 v[72:75], a[196:199], v[120:123], v[72:75]
  v_add_f32 v193, v193, v36
  v_mfma_f32_16x16x32_bf16 v[76:79], a[196:199], v[124:127], v[76:79]
  v_exp_f32 v38, v38
  s_waitcnt lgkmcnt(7)
  v_mfma_f32_16x16x32_bf16 v[64:67], a[200:203], v[144:147], v[64:67]
  ds_read_b64_tr_b16 a[220:221], v4 offset:36864
  v_add_f32 v193, v193, v37
  v_mfma_f32_16x16x32_bf16 v[68:71], a[200:203], v[148:151], v[68:71]
  ds_read_b64_tr_b16 a[222:223], v4 offset:43008
  v_exp_f32 v39, v39
  v_mfma_f32_16x16x32_bf16 v[72:75], a[200:203], v[152:155], v[72:75]
  s_add_u32 m0, s72, 0
  v_cvt_pk_bf16_f32 v100, v36, v37
  v_mfma_f32_16x16x32_bf16 v[76:79], a[200:203], v[156:159], v[76:79]
  v_add_f32 v193, v193, v38
  s_waitcnt lgkmcnt(8)
  v_mfma_f32_16x16x32_bf16 v[64:67], a[204:207], v[176:179], v[64:67]
  ds_read_b64_tr_b16 a[192:193], v1 offset:36992
  v_add_f32 v193, v193, v39
  v_mfma_f32_16x16x32_bf16 v[68:71], a[204:207], v[180:183], v[68:71]
  ds_read_b64_tr_b16 a[194:195], v1 offset:43136
  v_cvt_pk_bf16_f32 v101, v38, v39
  v_mfma_f32_16x16x32_bf16 v[72:75], a[204:207], v[184:187], v[72:75]
  buffer_load_dwordx4 v200, s[56:59], s69 offen offset:0 lds
  v_mfma_f32_16x16x32_bf16 v[76:79], a[204:207], v[188:191], v[76:79]
  s_waitcnt lgkmcnt(8)
  v_mfma_f32_16x16x32_bf16 a[0:3], a[208:211], v[128:131], a[0:3]
  ds_read_b64_tr_b16 a[196:197], v2 offset:36992
  v_exp_f32 v40, v40
  v_mfma_f32_16x16x32_bf16 a[8:11], a[208:211], v[132:135], a[8:11]
  ds_read_b64_tr_b16 a[198:199], v2 offset:43136
  v_exp_f32 v41, v41
  v_mfma_f32_16x16x32_bf16 a[16:19], a[208:211], v[136:139], a[16:19]
  buffer_load_dwordx4 v201, s[56:59], s69 offen offset:1024 lds
  v_add_f32 v194, v194, v40
  v_mfma_f32_16x16x32_bf16 a[24:27], a[208:211], v[140:143], a[24:27]
  v_exp_f32 v42, v42
  s_waitcnt lgkmcnt(8)
  v_mfma_f32_16x16x32_bf16 a[4:7], a[212:215], v[128:131], a[4:7]
  ds_read_b64_tr_b16 a[200:201], v3 offset:36992
  v_add_f32 v194, v194, v41
  v_mfma_f32_16x16x32_bf16 a[12:15], a[212:215], v[132:135], a[12:15]
  ds_read_b64_tr_b16 a[202:203], v3 offset:43136
  v_exp_f32 v43, v43
  v_mfma_f32_16x16x32_bf16 a[20:23], a[212:215], v[136:139], a[20:23]
  buffer_load_dwordx4 v202, s[56:59], s69 offen offset:2048 lds
  v_cvt_pk_bf16_f32 v104, v40, v41
  v_mfma_f32_16x16x32_bf16 a[28:31], a[212:215], v[140:143], a[28:31]
  v_add_f32 v194, v194, v42
  s_waitcnt lgkmcnt(8)
  v_mfma_f32_16x16x32_bf16 a[32:35], a[216:219], v[128:131], a[32:35]
  ds_read_b64_tr_b16 a[204:205], v4 offset:36992
  v_add_f32 v194, v194, v43
  v_mfma_f32_16x16x32_bf16 a[40:43], a[216:219], v[132:135], a[40:43]
  ds_read_b64_tr_b16 a[206:207], v4 offset:43136
  v_cvt_pk_bf16_f32 v105, v42, v43
  v_mfma_f32_16x16x32_bf16 a[48:51], a[216:219], v[136:139], a[48:51]
  buffer_load_dwordx4 v203, s[56:59], s69 offen offset:3072 lds
  v_mfma_f32_16x16x32_bf16 a[56:59], a[216:219], v[140:143], a[56:59]
  s_add_u32 m0, s72, 4096
  s_waitcnt lgkmcnt(8)
  v_mfma_f32_16x16x32_bf16 a[36:39], a[220:223], v[128:131], a[36:39]
  ds_read_b64_tr_b16 a[208:209], v1 offset:37120
  v_exp_f32 v44, v44
  v_mfma_f32_16x16x32_bf16 a[44:47], a[220:223], v[132:135], a[44:47]
  ds_read_b64_tr_b16 a[210:211], v1 offset:43264
  v_exp_f32 v45, v45
  v_mfma_f32_16x16x32_bf16 a[52:55], a[220:223], v[136:139], a[52:55]
  buffer_load_dwordx4 v204, s[56:59], s69 offen offset:0 lds
  v_add_f32 v195, v195, v44
  v_mfma_f32_16x16x32_bf16 a[60:63], a[220:223], v[140:143], a[60:63]
  v_exp_f32 v46, v46
  s_waitcnt lgkmcnt(8)
  v_mfma_f32_16x16x32_bf16 a[64:67], a[192:195], v[128:131], a[64:67]
  ds_read_b64_tr_b16 a[212:213], v2 offset:37120
  v_add_f32 v195, v195, v45
  v_mfma_f32_16x16x32_bf16 a[72:75], a[192:195], v[132:135], a[72:75]
  ds_read_b64_tr_b16 a[214:215], v2 offset:43264
  v_exp_f32 v47, v47
  v_mfma_f32_16x16x32_bf16 a[80:83], a[192:195], v[136:139], a[80:83]
  s_add_u32 s69, s69, 81920
  v_cvt_pk_bf16_f32 v108, v44, v45
  v_mfma_f32_16x16x32_bf16 a[88:91], a[192:195], v[140:143], a[88:91]
  v_add_f32 v195, v195, v46
  s_waitcnt lgkmcnt(8)
  v_mfma_f32_16x16x32_bf16 a[68:71], a[196:199], v[128:131], a[68:71]
  ds_read_b64_tr_b16 a[216:217], v3 offset:37120
  v_add_f32 v195, v195, v47
  v_mfma_f32_16x16x32_bf16 a[76:79], a[196:199], v[132:135], a[76:79]
  ds_read_b64_tr_b16 a[218:219], v3 offset:43264
  v_cvt_pk_bf16_f32 v109, v46, v47
  v_mfma_f32_16x16x32_bf16 a[84:87], a[196:199], v[136:139], a[84:87]
  s_add_u32 s72, s72, 20480
  v_mfma_f32_16x16x32_bf16 a[92:95], a[196:199], v[140:143], a[92:95]
  s_waitcnt lgkmcnt(8)
  v_mfma_f32_16x16x32_bf16 a[96:99], a[200:203], v[128:131], a[96:99]
  ds_read_b64_tr_b16 a[220:221], v4 offset:37120
  v_exp_f32 v64, v64
  v_mfma_f32_16x16x32_bf16 a[104:107], a[200:203], v[132:135], a[104:107]
  ds_read_b64_tr_b16 a[222:223], v4 offset:43264
  v_exp_f32 v65, v65
  v_mfma_f32_16x16x32_bf16 a[112:115], a[200:203], v[136:139], a[112:115]
  s_waitcnt vmcnt(15)
  s_barrier
  v_add_f32 v192, v192, v64
  v_mfma_f32_16x16x32_bf16 a[120:123], a[200:203], v[140:143], a[120:123]
  v_exp_f32 v66, v66
  s_waitcnt lgkmcnt(8)
  v_mfma_f32_16x16x32_bf16 a[100:103], a[204:207], v[128:131], a[100:103]
  ds_read_b128 a[192:195], v14 offset:12288
  v_add_f32 v192, v192, v65
  v_mfma_f32_16x16x32_bf16 a[108:111], a[204:207], v[132:135], a[108:111]
  s_add_u32 m0, s33, 139264
  v_exp_f32 v67, v67
  v_mfma_f32_16x16x32_bf16 a[116:119], a[204:207], v[136:139], a[116:119]
  buffer_load_dwordx4 v11, s[24:27], s38 offen offset:0 lds
  v_cvt_pk_bf16_f32 v98, v64, v65
  v_mfma_f32_16x16x32_bf16 a[124:127], a[204:207], v[140:143], a[124:127]
  v_add_f32 v192, v192, v66
  s_waitcnt lgkmcnt(7)
  v_mfma_f32_16x16x32_bf16 a[128:131], a[208:211], v[128:131], a[128:131]
  ds_read_b128 a[196:199], v15 offset:12288
  v_add_f32 v192, v192, v67
  v_mfma_f32_16x16x32_bf16 a[136:139], a[208:211], v[132:135], a[136:139]
  v_cvt_pk_bf16_f32 v99, v66, v67
  v_mfma_f32_16x16x32_bf16 a[144:147], a[208:211], v[136:139], a[144:147]
  v_mfma_f32_16x16x32_bf16 a[152:155], a[208:211], v[140:143], a[152:155]
  s_waitcnt lgkmcnt(6)
  v_mfma_f32_16x16x32_bf16 a[132:135], a[212:215], v[128:131], a[132:135]
  ds_read_b128 a[200:203], v14 offset:12416
  v_exp_f32 v68, v68
  v_mfma_f32_16x16x32_bf16 a[140:143], a[212:215], v[132:135], a[140:143]
  buffer_load_dwordx4 v12, s[24:27], s38 offen offset:1024 lds
  v_exp_f32 v69, v69
  v_mfma_f32_16x16x32_bf16 a[148:151], a[212:215], v[136:139], a[148:151]
  v_add_f32 v193, v193, v68
  v_mfma_f32_16x16x32_bf16 a[156:159], a[212:215], v[140:143], a[156:159]
  v_exp_f32 v70, v70
  s_waitcnt lgkmcnt(5)
  v_mfma_f32_16x16x32_bf16 a[160:163], a[216:219], v[128:131], a[160:163]
  ds_read_b128 a[204:207], v15 offset:12416
  v_add_f32 v193, v193, v69
  v_mfma_f32_16x16x32_bf16 a[168:171], a[216:219], v[132:135], a[168:171]
  v_exp_f32 v71, v71
  v_mfma_f32_16x16x32_bf16 a[176:179], a[216:219], v[136:139], a[176:179]
  v_cvt_pk_bf16_f32 v102, v68, v69
  v_mfma_f32_16x16x32_bf16 a[184:187], a[216:219], v[140:143], a[184:187]
  v_add_f32 v193, v193, v70
  s_waitcnt lgkmcnt(4)
  v_mfma_f32_16x16x32_bf16 a[164:167], a[220:223], v[128:131], a[164:167]
  ds_read_b128 a[208:211], v14 offset:12544
  v_add_f32 v193, v193, v71
  v_mfma_f32_16x16x32_bf16 a[172:175], a[220:223], v[132:135], a[172:175]
  buffer_load_dwordx4 v13, s[24:27], s38 offen offset:2048 lds
  v_cvt_pk_bf16_f32 v103, v70, v71
  v_mfma_f32_16x16x32_bf16 a[180:183], a[220:223], v[136:139], a[180:183]
  s_add_u32 s38, s38, 12288
  v_mfma_f32_16x16x32_bf16 a[188:191], a[220:223], v[140:143], a[188:191]
  s_waitcnt lgkmcnt(4)
  s_branch re_p21
.p2align 6
re_p26:
  v_mfma_f32_16x16x32_bf16 v[32:35], a[192:195], v[16:19], v[160:163]
  ds_read_b128 a[212:215], v15 offset:24832
  s_waitcnt vmcnt(4)
  v_cmp_ne_u32 vcc, s60, v197
  v_exp_f32 v72, v72
  v_mfma_f32_16x16x32_bf16 v[36:39], a[192:195], v[20:23], v[164:167]
  s_cbranch_vccnz re_phx
  re_phb:
  v_exp_f32 v73, v73
  v_mfma_f32_16x16x32_bf16 v[40:43], a[192:195], v[24:27], v[168:171]
  s_movk_i32 s36, 4096
  v_add_f32 v194, v194, v72
  v_mfma_f32_16x16x32_bf16 v[44:47], a[192:195], v[28:31], v[172:175]
  v_exp_f32 v74, v74
  s_waitcnt lgkmcnt(4)
  v_mfma_f32_16x16x32_bf16 v[32:35], a[196:199], v[48:51], v[32:35]
  ds_read_b128 a[216:219], v14 offset:30720
  v_add_f32 v194, v194, v73
  v_mfma_f32_16x16x32_bf16 v[36:39], a[196:199], v[52:55], v[36:39]
  buffer_load_dwordx4 a[224:227], v198, s[8:11], s36 offen offset:0 sc1
  v_exp_f32 v75, v75
  v_mfma_f32_16x16x32_bf16 v[40:43], a[196:199], v[56:59], v[40:43]
  v_cvt_pk_bf16_f32 v138, v72, v73
  v_mfma_f32_16x16x32_bf16 v[44:47], a[196:199], v[60:63], v[44:47]
  v_add_f32 v194, v194, v74
  s_waitcnt lgkmcnt(4)
  v_mfma_f32_16x16x32_bf16 v[32:35], a[200:203], v[80:83], v[32:35]
  ds_read_b128 a[220:223], v15 offset:30720
  v_add_f32 v194, v194, v75
  v_mfma_f32_16x16x32_bf16 v[36:39], a[200:203], v[84:87], v[36:39]
  buffer_load_dwordx4 a[228:231], v199, s[8:11], s36 offen offset:0 sc1
  v_cvt_pk_bf16_f32 v139, v74, v75
  v_mfma_f32_16x16x32_bf16 v[40:43], a[200:203], v[88:91], v[40:43]
  v_mfma_f32_16x16x32_bf16 v[44:47], a[200:203], v[92:95], v[44:47]
  s_waitcnt lgkmcnt(4)
  v_mfma_f32_16x16x32_bf16 v[32:35], a[204:207], v[112:115], v[32:35]
  ds_read_b128 a[192:195], v14 offset:30848
  v_exp_f32 v76, v76
  v_mfma_f32_16x16x32_bf16 v[36:39], a[204:207], v[116:119], v[36:39]
  buffer_load_dwordx4 a[232:235], v198, s[8:11], s36 offen offset:2048 sc1
  v_exp_f32 v77, v77
  v_mfma_f32_16x16x32_bf16 v[40:43], a[204:207], v[120:123], v[40:43]
  v_add_f32 v195, v195, v76
  v_mfma_f32_16x16x32_bf16 v[44:47], a[204:207], v[124:127], v[44:47]
  v_exp_f32 v78, v78
  s_waitcnt lgkmcnt(4)
  v_mfma_f32_16x16x32_bf16 v[32:35], a[208:211], v[144:147], v[32:35]
  ds_read_b128 a[196:199], v15 offset:30848
  buffer_load_dwordx4 a[236:239], v199, s[8:11], s36 offen offset:2048 sc1
  v_add_f32 v195, v195, v77
  v_mfma_f32_16x16x32_bf16 v[36:39], a[208:211], v[148:151], v[36:39]
  v_exp_f32 v79, v79
  v_mfma_f32_16x16x32_bf16 v[40:43], a[208:211], v[152:155], v[40:43]
  v_cvt_pk_bf16_f32 v142, v76, v77
  v_mfma_f32_16x16x32_bf16 v[44:47], a[208:211], v[156:159], v[44:47]
  v_add_f32 v195, v195, v78
  s_waitcnt lgkmcnt(4)
  v_mfma_f32_16x16x32_bf16 v[32:35], a[212:215], v[176:179], v[32:35]
  ds_read_b128 a[200:203], v14 offset:30976
  s_movk_i32 s36, 8192
  v_add_f32 v195, v195, v79
  v_mfma_f32_16x16x32_bf16 v[36:39], a[212:215], v[180:183], v[36:39]
  v_cvt_pk_bf16_f32 v143, v78, v79
  v_mfma_f32_16x16x32_bf16 v[40:43], a[212:215], v[184:187], v[40:43]
  v_mfma_f32_16x16x32_bf16 v[44:47], a[212:215], v[188:191], v[44:47]
  s_waitcnt lgkmcnt(4)
  v_mfma_f32_16x16x32_bf16 v[64:67], a[216:219], v[16:19], v[160:163]
  ds_read_b128 a[204:207], v15 offset:30976
  buffer_load_dwordx4 a[240:243], v198, s[8:11], s36 offen offset:0 sc1
  v_exp_f32 v32, v32
  v_mfma_f32_16x16x32_bf16 v[68:71], a[216:219], v[20:23], v[164:167]
  v_exp_f32 v33, v33
  v_mfma_f32_16x16x32_bf16 v[72:75], a[216:219], v[24:27], v[168:171]
  v_add_f32 v192, v192, v32
  v_mfma_f32_16x16x32_bf16 v[76:79], a[216:219], v[28:31], v[172:175]
  v_exp_f32 v34, v34
  s_waitcnt lgkmcnt(4)
  v_mfma_f32_16x16x32_bf16 v[64:67], a[220:223], v[48:51], v[64:67]
  ds_read_b64_tr_b16 a[208:209], v1 offset:12288
  buffer_load_dwordx4 a[244:247], v199, s[8:11], s36 offen offset:0 sc1
  v_add_f32 v192, v192, v33
  v_mfma_f32_16x16x32_bf16 v[68:71], a[220:223], v[52:55], v[68:71]
  ds_read_b64_tr_b16 a[210:211], v1 offset:18432
  v_exp_f32 v35, v35
  v_mfma_f32_16x16x32_bf16 v[72:75], a[220:223], v[56:59], v[72:75]
  v_cvt_pk_bf16_f32 v96, v32, v33
  v_mfma_f32_16x16x32_bf16 v[76:79], a[220:223], v[60:63], v[76:79]
  buffer_load_dwordx4 a[248:251], v198, s[8:11], s36 offen offset:2048 sc1
  v_add_f32 v192, v192, v34
  s_waitcnt lgkmcnt(5)
  v_mfma_f32_16x16x32_bf16 v[64:67], a[192:195], v[80:83], v[64:67]
  ds_read_b64_tr_b16 a[212:213], v2 offset:12288
  v_add_f32 v192, v192, v35
  v_mfma_f32_16x16x32_bf16 v[68:71], a[192:195], v[84:87], v[68:71]
  ds_read_b64_tr_b16 a[214:215], v2 offset:18432
  v_cvt_pk_bf16_f32 v97, v34, v35
  v_mfma_f32_16x16x32_bf16 v[72:75], a[192:195], v[88:91], v[72:75]
  v_mfma_f32_16x16x32_bf16 v[76:79], a[192:195], v[92:95], v[76:79]
  buffer_load_dwordx4 a[252:255], v199, s[8:11], s36 offen offset:2048 sc1
  s_waitcnt lgkmcnt(6)
  v_mfma_f32_16x16x32_bf16 v[64:67], a[196:199], v[112:115], v[64:67]
  ds_read_b64_tr_b16 a[216:217], v3 offset:12288
  v_exp_f32 v36, v36
  v_mfma_f32_16x16x32_bf16 v[68:71], a[196:199], v[116:119], v[68:71]
  ds_read_b64_tr_b16 a[218:219], v3 offset:18432
  v_exp_f32 v37, v37
  v_mfma_f32_16x16x32_bf16 v[72:75], a[196:199], v[120:123], v[72:75]
  v_add_f32 v193, v193, v36
  v_mfma_f32_16x16x32_bf16 v[76:79], a[196:199], v[124:127], v[76:79]
  s_movk_i32 s36, 12288
  v_exp_f32 v38, v38
  s_waitcnt lgkmcnt(7)
  v_mfma_f32_16x16x32_bf16 v[64:67], a[200:203], v[144:147], v[64:67]
  ds_read_b64_tr_b16 a[220:221], v4 offset:12288
  v_add_f32 v193, v193, v37
  v_mfma_f32_16x16x32_bf16 v[68:71], a[200:203], v[148:151], v[68:71]
  ds_read_b64_tr_b16 a[222:223], v4 offset:18432
  v_exp_f32 v39, v39
  v_mfma_f32_16x16x32_bf16 v[72:75], a[200:203], v[152:155], v[72:75]
  buffer_load_dwordx4 v[208:211], v198, s[8:11], s36 offen offset:0 sc1
  v_cvt_pk_bf16_f32 v100, v36, v37
  v_mfma_f32_16x16x32_bf16 v[76:79], a[200:203], v[156:159], v[76:79]
  v_add_f32 v193, v193, v38
  s_waitcnt lgkmcnt(8)
  v_mfma_f32_16x16x32_bf16 v[64:67], a[204:207], v[176:179], v[64:67]
  ds_read_b64_tr_b16 a[192:193], v1 offset:12416
  v_add_f32 v193, v193, v39
  v_mfma_f32_16x16x32_bf16 v[68:71], a[204:207], v[180:183], v[68:71]
  ds_read_b64_tr_b16 a[194:195], v1 offset:18560
  v_cvt_pk_bf16_f32 v101, v38, v39
  v_mfma_f32_16x16x32_bf16 v[72:75], a[204:207], v[184:187], v[72:75]
  buffer_load_dwordx4 v[212:215], v199, s[8:11], s36 offen offset:0 sc1
  v_mfma_f32_16x16x32_bf16 v[76:79], a[204:207], v[188:191], v[76:79]
  s_waitcnt lgkmcnt(8)
  v_mfma_f32_16x16x32_bf16 a[0:3], a[208:211], v[128:131], a[0:3]
  ds_read_b64_tr_b16 a[196:197], v2 offset:12416
  v_exp_f32 v40, v40
  v_mfma_f32_16x16x32_bf16 a[8:11], a[208:211], v[132:135], a[8:11]
  ds_read_b64_tr_b16 a[198:199], v2 offset:18560
  v_exp_f32 v41, v41
  v_mfma_f32_16x16x32_bf16 a[16:19], a[208:211], v[136:139], a[16:19]
  buffer_load_dwordx4 v[216:219], v198, s[8:11], s36 offen offset:2048 sc1
  v_add_f32 v194, v194, v40
  v_mfma_f32_16x16x32_bf16 a[24:27], a[208:211], v[140:143], a[24:27]
  v_exp_f32 v42, v42
  s_waitcnt lgkmcnt(8)
  v_mfma_f32_16x16x32_bf16 a[4:7], a[212:215], v[128:131], a[4:7]
  ds_read_b64_tr_b16 a[200:201], v3 offset:12416
  v_add_f32 v194, v194, v41
  v_mfma_f32_16x16x32_bf16 a[12:15], a[212:215], v[132:135], a[12:15]
  ds_read_b64_tr_b16 a[202:203], v3 offset:18560
  v_exp_f32 v43, v43
  v_mfma_f32_16x16x32_bf16 a[20:23], a[212:215], v[136:139], a[20:23]
  buffer_load_dwordx4 v[220:223], v199, s[8:11], s36 offen offset:2048 sc1
  v_cvt_pk_bf16_f32 v104, v40, v41
  v_mfma_f32_16x16x32_bf16 a[28:31], a[212:215], v[140:143], a[28:31]
  v_add_f32 v194, v194, v42
  s_waitcnt lgkmcnt(8)
  v_mfma_f32_16x16x32_bf16 a[32:35], a[216:219], v[128:131], a[32:35]
  ds_read_b64_tr_b16 a[204:205], v4 offset:12416
  v_add_f32 v194, v194, v43
  v_mfma_f32_16x16x32_bf16 a[40:43], a[216:219], v[132:135], a[40:43]
  ds_read_b64_tr_b16 a[206:207], v4 offset:18560
  s_movk_i32 s36, 16384
  v_cvt_pk_bf16_f32 v105, v42, v43
  v_mfma_f32_16x16x32_bf16 a[48:51], a[216:219], v[136:139], a[48:51]
  v_mfma_f32_16x16x32_bf16 a[56:59], a[216:219], v[140:143], a[56:59]
  s_waitcnt lgkmcnt(8)
  v_mfma_f32_16x16x32_bf16 a[36:39], a[220:223], v[128:131], a[36:39]
  ds_read_b64_tr_b16 a[208:209], v1 offset:12544
  v_exp_f32 v44, v44
  v_mfma_f32_16x16x32_bf16 a[44:47], a[220:223], v[132:135], a[44:47]
  ds_read_b64_tr_b16 a[210:211], v1 offset:18688
  buffer_load_dwordx4 v[224:227], v198, s[8:11], s36 offen offset:0 sc1
  v_exp_f32 v45, v45
  v_mfma_f32_16x16x32_bf16 a[52:55], a[220:223], v[136:139], a[52:55]
  v_add_f32 v195, v195, v44
  v_mfma_f32_16x16x32_bf16 a[60:63], a[220:223], v[140:143], a[60:63]
  v_exp_f32 v46, v46
  s_waitcnt lgkmcnt(8)
  v_mfma_f32_16x16x32_bf16 a[64:67], a[192:195], v[128:131], a[64:67]
  ds_read_b64_tr_b16 a[212:213], v2 offset:12544
  v_add_f32 v195, v195, v45
  v_mfma_f32_16x16x32_bf16 a[72:75], a[192:195], v[132:135], a[72:75]
  ds_read_b64_tr_b16 a[214:215], v2 offset:18688
  buffer_load_dwordx4 v[228:231], v199, s[8:11], s36 offen offset:0 sc1
  v_exp_f32 v47, v47
  v_mfma_f32_16x16x32_bf16 a[80:83], a[192:195], v[136:139], a[80:83]
  v_cvt_pk_bf16_f32 v108, v44, v45
  v_mfma_f32_16x16x32_bf16 a[88:91], a[192:195], v[140:143], a[88:91]
  v_add_f32 v195, v195, v46
  s_waitcnt lgkmcnt(8)
  v_mfma_f32_16x16x32_bf16 a[68:71], a[196:199], v[128:131], a[68:71]
  ds_read_b64_tr_b16 a[216:217], v3 offset:12544
  buffer_load_dwordx4 v[232:235], v198, s[8:11], s36 offen offset:2048 sc1
  v_add_f32 v195, v195, v47
  v_mfma_f32_16x16x32_bf16 a[76:79], a[196:199], v[132:135], a[76:79]
  ds_read_b64_tr_b16 a[218:219], v3 offset:18688
  v_cvt_pk_bf16_f32 v109, v46, v47
  v_mfma_f32_16x16x32_bf16 a[84:87], a[196:199], v[136:139], a[84:87]
  v_mfma_f32_16x16x32_bf16 a[92:95], a[196:199], v[140:143], a[92:95]
  s_waitcnt lgkmcnt(8)
  v_mfma_f32_16x16x32_bf16 a[96:99], a[200:203], v[128:131], a[96:99]
  ds_read_b64_tr_b16 a[220:221], v4 offset:12544
  buffer_load_dwordx4 v[236:239], v199, s[8:11], s36 offen offset:2048 sc1
  v_exp_f32 v64, v64
  v_mfma_f32_16x16x32_bf16 a[104:107], a[200:203], v[132:135], a[104:107]
  ds_read_b64_tr_b16 a[222:223], v4 offset:18688
  v_exp_f32 v65, v65
  v_mfma_f32_16x16x32_bf16 a[112:115], a[200:203], v[136:139], a[112:115]
  s_barrier
  v_add_f32 v192, v192, v64
  v_mfma_f32_16x16x32_bf16 a[120:123], a[200:203], v[140:143], a[120:123]
  v_exp_f32 v66, v66
  s_waitcnt lgkmcnt(8)
  v_mfma_f32_16x16x32_bf16 a[100:103], a[204:207], v[128:131], a[100:103]
  ds_read_b128 a[192:195], v14 offset:36864
  s_movk_i32 s36, 20480
  v_add_f32 v192, v192, v65
  v_mfma_f32_16x16x32_bf16 a[108:111], a[204:207], v[132:135], a[108:111]
  v_exp_f32 v67, v67
  v_mfma_f32_16x16x32_bf16 a[116:119], a[204:207], v[136:139], a[116:119]
  v_cvt_pk_bf16_f32 v98, v64, v65
  v_mfma_f32_16x16x32_bf16 a[124:127], a[204:207], v[140:143], a[124:127]
  v_add_f32 v192, v192, v66
  s_waitcnt lgkmcnt(7)
  v_mfma_f32_16x16x32_bf16 a[128:131], a[208:211], v[128:131], a[128:131]
  ds_read_b128 a[196:199], v15 offset:36864
  buffer_load_dwordx4 v[240:243], v198, s[8:11], s36 offen offset:0 sc1
  v_add_f32 v192, v192, v67
  v_mfma_f32_16x16x32_bf16 a[136:139], a[208:211], v[132:135], a[136:139]
  v_cvt_pk_bf16_f32 v99, v66, v67
  v_mfma_f32_16x16x32_bf16 a[144:147], a[208:211], v[136:139], a[144:147]
  v_mfma_f32_16x16x32_bf16 a[152:155], a[208:211], v[140:143], a[152:155]
  buffer_load_dwordx4 v[244:247], v199, s[8:11], s36 offen offset:0 sc1
  s_waitcnt lgkmcnt(6)
  v_mfma_f32_16x16x32_bf16 a[132:135], a[212:215], v[128:131], a[132:135]
  ds_read_b128 a[200:203], v14 offset:36992
  v_exp_f32 v68, v68
  v_mfma_f32_16x16x32_bf16 a[140:143], a[212:215], v[132:135], a[140:143]
  v_exp_f32 v69, v69
  v_mfma_f32_16x16x32_bf16 a[148:151], a[212:215], v[136:139], a[148:151]
  v_add_f32 v193, v193, v68
  v_mfma_f32_16x16x32_bf16 a[156:159], a[212:215], v[140:143], a[156:159]
  buffer_load_dwordx4 v[248:251], v198, s[8:11], s36 offen offset:2048 sc1
  v_exp_f32 v70, v70
  s_waitcnt lgkmcnt(5)
  v_mfma_f32_16x16x32_bf16 a[160:163], a[216:219], v[128:131], a[160:163]
  ds_read_b128 a[204:207], v15 offset:36992
  v_add_f32 v193, v193, v69
  v_mfma_f32_16x16x32_bf16 a[168:171], a[216:219], v[132:135], a[168:171]
  v_exp_f32 v71, v71
  v_mfma_f32_16x16x32_bf16 a[176:179], a[216:219], v[136:139], a[176:179]
  v_cvt_pk_bf16_f32 v102, v68, v69
  v_mfma_f32_16x16x32_bf16 a[184:187], a[216:219], v[140:143], a[184:187]
  buffer_load_dwordx4 v[252:255], v199, s[8:11], s36 offen offset:2048 sc1
  v_add_f32 v193, v193, v70
  s_waitcnt lgkmcnt(4)
  v_mfma_f32_16x16x32_bf16 a[164:167], a[220:223], v[128:131], a[164:167]
  ds_read_b128 a[208:211], v14 offset:37120
  v_add_f32 v193, v193, v71
  v_mfma_f32_16x16x32_bf16 a[172:175], a[220:223], v[132:135], a[172:175]
  v_cvt_pk_bf16_f32 v103, v70, v71
  v_mfma_f32_16x16x32_bf16 a[180:183], a[220:223], v[136:139], a[180:183]
  v_mfma_f32_16x16x32_bf16 a[188:191], a[220:223], v[140:143], a[188:191]
  s_waitcnt lgkmcnt(4)
re_p27:
  v_mfma_f32_16x16x32_bf16 v[32:35], a[192:195], v[16:19], v[160:163]
  ds_read_b128 a[212:215], v15 offset:37120
  s_add_u32 m0, s68, 61440
  v_exp_f32 v72, v72
  v_mfma_f32_16x16x32_bf16 v[36:39], a[192:195], v[20:23], v[164:167]
  v_exp_f32 v73, v73
  v_mfma_f32_16x16x32_bf16 v[40:43], a[192:195], v[24:27], v[168:171]
  v_add_f32 v194, v194, v72
  v_mfma_f32_16x16x32_bf16 v[44:47], a[192:195], v[28:31], v[172:175]
  buffer_load_dwordx4 v200, s[56:59], s69 offen offset:0 lds
  v_exp_f32 v74, v74
  s_waitcnt lgkmcnt(4)
  v_mfma_f32_16x16x32_bf16 v[32:35], a[196:199], v[48:51], v[32:35]
  ds_read_b128 a[216:219], v14 offset:43008
  v_add_f32 v194, v194, v73
  v_mfma_f32_16x16x32_bf16 v[36:39], a[196:199], v[52:55], v[36:39]
  v_exp_f32 v75, v75
  v_mfma_f32_16x16x32_bf16 v[40:43], a[196:199], v[56:59], v[40:43]
  buffer_load_dwordx4 v201, s[56:59], s69 offen offset:1024 lds
  v_cvt_pk_bf16_f32 v106, v72, v73
  v_mfma_f32_16x16x32_bf16 v[44:47], a[196:199], v[60:63], v[44:47]
  v_add_f32 v194, v194, v74
  s_waitcnt lgkmcnt(4)
  v_mfma_f32_16x16x32_bf16 v[32:35], a[200:203], v[80:83], v[32:35]
  ds_read_b128 a[220:223], v15 offset:43008
  v_add_f32 v194, v194, v75
  v_mfma_f32_16x16x32_bf16 v[36:39], a[200:203], v[84:87], v[36:39]
  buffer_load_dwordx4 v202, s[56:59], s69 offen offset:2048 lds
  v_cvt_pk_bf16_f32 v107, v74, v75
  v_mfma_f32_16x16x32_bf16 v[40:43], a[200:203], v[88:91], v[40:43]
  v_mfma_f32_16x16x32_bf16 v[44:47], a[200:203], v[92:95], v[44:47]
  s_waitcnt lgkmcnt(4)
  v_mfma_f32_16x16x32_bf16 v[32:35], a[204:207], v[112:115], v[32:35]
  ds_read_b128 a[192:195], v14 offset:43136
  buffer_load_dwordx4 v203, s[56:59], s69 offen offset:3072 lds
  v_exp_f32 v76, v76
  v_mfma_f32_16x16x32_bf16 v[36:39], a[204:207], v[116:119], v[36:39]
  v_exp_f32 v77, v77
  v_mfma_f32_16x16x32_bf16 v[40:43], a[204:207], v[120:123], v[40:43]
  v_add_f32 v195, v195, v76
  v_mfma_f32_16x16x32_bf16 v[44:47], a[204:207], v[124:127], v[44:47]
  s_add_u32 m0, s68, 65536
  v_exp_f32 v78, v78
  s_waitcnt lgkmcnt(4)
  v_mfma_f32_16x16x32_bf16 v[32:35], a[208:211], v[144:147], v[32:35]
  ds_read_b128 a[196:199], v15 offset:43136
  v_add_f32 v195, v195, v77
  v_mfma_f32_16x16x32_bf16 v[36:39], a[208:211], v[148:151], v[36:39]
  v_exp_f32 v79, v79
  v_mfma_f32_16x16x32_bf16 v[40:43], a[208:211], v[152:155], v[40:43]
  buffer_load_dwordx4 v204, s[56:59], s69 offen offset:0 lds
  v_cvt_pk_bf16_f32 v110, v76, v77
  v_mfma_f32_16x16x32_bf16 v[44:47], a[208:211], v[156:159], v[44:47]
  v_add_f32 v195, v195, v78
  s_waitcnt lgkmcnt(4)
  v_mfma_f32_16x16x32_bf16 v[32:35], a[212:215], v[176:179], v[32:35]
  ds_read_b128 a[200:203], v14 offset:43264
  v_add_f32 v195, v195, v79
  v_mfma_f32_16x16x32_bf16 v[36:39], a[212:215], v[180:183], v[36:39]
  s_add_u32 s69, s69, 81920
  v_cvt_pk_bf16_f32 v111, v78, v79
  v_mfma_f32_16x16x32_bf16 v[40:43], a[212:215], v[184:187], v[40:43]
  v_mfma_f32_16x16x32_bf16 v[44:47], a[212:215], v[188:191], v[44:47]
  s_waitcnt lgkmcnt(4)
  v_mfma_f32_16x16x32_bf16 v[64:67], a[216:219], v[16:19], v[160:163]
  ds_read_b128 a[204:207], v15 offset:43264
  s_add_u32 m0, s68, 81920
  v_exp_f32 v32, v32
  v_mfma_f32_16x16x32_bf16 v[68:71], a[216:219], v[20:23], v[164:167]
  v_exp_f32 v33, v33
  v_mfma_f32_16x16x32_bf16 v[72:75], a[216:219], v[24:27], v[168:171]
  v_add_f32 v192, v192, v32
  v_mfma_f32_16x16x32_bf16 v[76:79], a[216:219], v[28:31], v[172:175]
  buffer_load_dwordx4 v200, s[56:59], s69 offen offset:0 lds
  v_exp_f32 v34, v34
  s_waitcnt lgkmcnt(4)
  v_mfma_f32_16x16x32_bf16 v[64:67], a[220:223], v[48:51], v[64:67]
  ds_read_b64_tr_b16 a[208:209], v1 offset:24576
  v_add_f32 v192, v192, v33
  v_mfma_f32_16x16x32_bf16 v[68:71], a[220:223], v[52:55], v[68:71]
  ds_read_b64_tr_b16 a[210:211], v1 offset:30720
  v_exp_f32 v35, v35
  v_mfma_f32_16x16x32_bf16 v[72:75], a[220:223], v[56:59], v[72:75]
  buffer_load_dwordx4 v201, s[56:59], s69 offen offset:1024 lds
  v_cvt_pk_bf16_f32 v128, v32, v33
  v_mfma_f32_16x16x32_bf16 v[76:79], a[220:223], v[60:63], v[76:79]
  v_add_f32 v192, v192, v34
  s_waitcnt lgkmcnt(5)
  v_mfma_f32_16x16x32_bf16 v[64:67], a[192:195], v[80:83], v[64:67]
  ds_read_b64_tr_b16 a[212:213], v2 offset:24576
  v_add_f32 v192, v192, v35
  v_mfma_f32_16x16x32_bf16 v[68:71], a[192:195], v[84:87], v[68:71]
  ds_read_b64_tr_b16 a[214:215], v2 offset:30720
  buffer_load_dwordx4 v202, s[56:59], s69 offen offset:2048 lds
  v_cvt_pk_bf16_f32 v129, v34, v35
  v_mfma_f32_16x16x32_bf16 v[72:75], a[192:195], v[88:91], v[72:75]
  v_mfma_f32_16x16x32_bf16 v[76:79], a[192:195], v[92:95], v[76:79]
  s_waitcnt lgkmcnt(6)
  v_mfma_f32_16x16x32_bf16 v[64:67], a[196:199], v[112:115], v[64:67]
  ds_read_b64_tr_b16 a[216:217], v3 offset:24576
  buffer_load_dwordx4 v203, s[56:59], s69 offen offset:3072 lds
  v_exp_f32 v36, v36
  v_mfma_f32_16x16x32_bf16 v[68:71], a[196:199], v[116:119], v[68:71]
  ds_read_b64_tr_b16 a[218:219], v3 offset:30720
  v_exp_f32 v37, v37
  v_mfma_f32_16x16x32_bf16 v[72:75], a[196:199], v[120:123], v[72:75]
  v_add_f32 v193, v193, v36
  v_mfma_f32_16x16x32_bf16 v[76:79], a[196:199], v[124:127], v[76:79]
  s_add_u32 m0, s68, 86016
  v_exp_f32 v38, v38
  s_waitcnt lgkmcnt(7)
  v_mfma_f32_16x16x32_bf16 v[64:67], a[200:203], v[144:147], v[64:67]
  ds_read_b64_tr_b16 a[220:221], v4 offset:24576
  v_add_f32 v193, v193, v37
  v_mfma_f32_16x16x32_bf16 v[68:71], a[200:203], v[148:151], v[68:71]
  ds_read_b64_tr_b16 a[222:223], v4 offset:30720
  v_exp_f32 v39, v39
  v_mfma_f32_16x16x32_bf16 v[72:75], a[200:203], v[152:155], v[72:75]
  buffer_load_dwordx4 v204, s[56:59], s69 offen offset:0 lds
  v_cvt_pk_bf16_f32 v132, v36, v37
  v_mfma_f32_16x16x32_bf16 v[76:79], a[200:203], v[156:159], v[76:79]
  v_add_f32 v193, v193, v38
  s_waitcnt lgkmcnt(8)
  v_mfma_f32_16x16x32_bf16 v[64:67], a[204:207], v[176:179], v[64:67]
  ds_read_b64_tr_b16 a[192:193], v1 offset:24704
  v_add_f32 v193, v193, v39
  v_mfma_f32_16x16x32_bf16 v[68:71], a[204:207], v[180:183], v[68:71]
  ds_read_b64_tr_b16 a[194:195], v1 offset:30848
  s_add_u32 s69, s69, 81920
  v_cvt_pk_bf16_f32 v133, v38, v39
  v_mfma_f32_16x16x32_bf16 v[72:75], a[204:207], v[184:187], v[72:75]
  v_mfma_f32_16x16x32_bf16 v[76:79], a[204:207], v[188:191], v[76:79]
  s_waitcnt lgkmcnt(8)
  v_mfma_f32_16x16x32_bf16 a[0:3], a[208:211], v[96:99], a[0:3]
  ds_read_b64_tr_b16 a[196:197], v2 offset:24704
  v_exp_f32 v40, v40
  v_mfma_f32_16x16x32_bf16 a[8:11], a[208:211], v[100:103], a[8:11]
  ds_read_b64_tr_b16 a[198:199], v2 offset:30848
  v_exp_f32 v41, v41
  v_mfma_f32_16x16x32_bf16 a[16:19], a[208:211], v[104:107], a[16:19]
  s_waitcnt vmcnt(30)
  s_barrier
  v_add_f32 v194, v194, v40
  v_mfma_f32_16x16x32_bf16 a[24:27], a[208:211], v[108:111], a[24:27]
  s_add_u32 m0, s68, 102400
  v_exp_f32 v42, v42
  s_waitcnt lgkmcnt(8)
  v_mfma_f32_16x16x32_bf16 a[4:7], a[212:215], v[96:99], a[4:7]
  ds_read_b64_tr_b16 a[200:201], v3 offset:24704
  v_add_f32 v194, v194, v41
  v_mfma_f32_16x16x32_bf16 a[12:15], a[212:215], v[100:103], a[12:15]
  ds_read_b64_tr_b16 a[202:203], v3 offset:30848
  buffer_load_dwordx4 v200, s[56:59], s69 offen offset:0 lds
  v_exp_f32 v43, v43
  v_mfma_f32_16x16x32_bf16 a[20:23], a[212:215], v[104:107], a[20:23]
  v_cvt_pk_bf16_f32 v136, v40, v41
  v_mfma_f32_16x16x32_bf16 a[28:31], a[212:215], v[108:111], a[28:31]
  v_add_f32 v194, v194, v42
  s_waitcnt lgkmcnt(8)
  v_mfma_f32_16x16x32_bf16 a[32:35], a[216:219], v[96:99], a[32:35]
  ds_read_b64_tr_b16 a[204:205], v4 offset:24704
  buffer_load_dwordx4 v201, s[56:59], s69 offen offset:1024 lds
  v_add_f32 v194, v194, v43
  v_mfma_f32_16x16x32_bf16 a[40:43], a[216:219], v[100:103], a[40:43]
  ds_read_b64_tr_b16 a[206:207], v4 offset:30848
  v_cvt_pk_bf16_f32 v137, v42, v43
  v_mfma_f32_16x16x32_bf16 a[48:51], a[216:219], v[104:107], a[48:51]
  v_mfma_f32_16x16x32_bf16 a[56:59], a[216:219], v[108:111], a[56:59]
  buffer_load_dwordx4 v202, s[56:59], s69 offen offset:2048 lds
  s_waitcnt lgkmcnt(8)
  v_mfma_f32_16x16x32_bf16 a[36:39], a[220:223], v[96:99], a[36:39]
  ds_read_b64_tr_b16 a[208:209], v1 offset:24832
  v_exp_f32 v44, v44
  v_mfma_f32_16x16x32_bf16 a[44:47], a[220:223], v[100:103], a[44:47]
  ds_read_b64_tr_b16 a[210:211], v1 offset:30976
  v_exp_f32 v45, v45
  v_mfma_f32_16x16x32_bf16 a[52:55], a[220:223], v[104:107], a[52:55]
  buffer_load_dwordx4 v203, s[56:59], s69 offen offset:3072 lds
  v_add_f32 v195, v195, v44
  v_mfma_f32_16x16x32_bf16 a[60:63], a[220:223], v[108:111], a[60:63]
  v_exp_f32 v46, v46
  s_waitcnt lgkmcnt(8)
  v_mfma_f32_16x16x32_bf16 a[64:67], a[192:195], v[96:99], a[64:67]
  ds_read_b64_tr_b16 a[212:213], v2 offset:24832
  v_add_f32 v195, v195, v45
  v_mfma_f32_16x16x32_bf16 a[72:75], a[192:195], v[100:103], a[72:75]
  ds_read_b64_tr_b16 a[214:215], v2 offset:30976
  s_add_u32 m0, s68, 106496
  v_exp_f32 v47, v47
  v_mfma_f32_16x16x32_bf16 a[80:83], a[192:195], v[104:107], a[80:83]
  v_cvt_pk_bf16_f32 v140, v44, v45
  v_mfma_f32_16x16x32_bf16 a[88:91], a[192:195], v[108:111], a[88:91]
  v_add_f32 v195, v195, v46
  s_waitcnt lgkmcnt(8)
  v_mfma_f32_16x16x32_bf16 a[68:71], a[196:199], v[96:99], a[68:71]
  ds_read_b64_tr_b16 a[216:217], v3 offset:24832
  buffer_load_dwordx4 v204, s[56:59], s69 offen offset:0 lds
  v_add_f32 v195, v195, v47
  v_mfma_f32_16x16x32_bf16 a[76:79], a[196:199], v[100:103], a[76:79]
  ds_read_b64_tr_b16 a[218:219], v3 offset:30976
  v_cvt_pk_bf16_f32 v141, v46, v47
  v_mfma_f32_16x16x32_bf16 a[84:87], a[196:199], v[104:107], a[84:87]
  v_mfma_f32_16x16x32_bf16 a[92:95], a[196:199], v[108:111], a[92:95]
  s_add_u32 s69, s69, 81920
  s_waitcnt lgkmcnt(8)
  v_mfma_f32_16x16x32_bf16 a[96:99], a[200:203], v[96:99], a[96:99]
  ds_read_b64_tr_b16 a[220:221], v4 offset:24832
  v_exp_f32 v64, v64
  v_mfma_f32_16x16x32_bf16 a[104:107], a[200:203], v[100:103], a[104:107]
  ds_read_b64_tr_b16 a[222:223], v4 offset:30976
  v_exp_f32 v65, v65
  v_mfma_f32_16x16x32_bf16 a[112:115], a[200:203], v[104:107], a[112:115]
  s_movk_i32 s36, 0
  v_add_f32 v192, v192, v64
  v_mfma_f32_16x16x32_bf16 a[120:123], a[200:203], v[108:111], a[120:123]
  v_exp_f32 v66, v66
  s_waitcnt lgkmcnt(8)
  v_mfma_f32_16x16x32_bf16 a[100:103], a[204:207], v[96:99], a[100:103]
  ds_read_b64_tr_b16 a[192:193], v1 offset:36864
  v_add_f32 v192, v192, v65
  v_mfma_f32_16x16x32_bf16 a[108:111], a[204:207], v[100:103], a[108:111]
  ds_read_b64_tr_b16 a[194:195], v1 offset:43008
  v_exp_f32 v67, v67
  v_mfma_f32_16x16x32_bf16 a[116:119], a[204:207], v[104:107], a[116:119]
  buffer_load_dwordx4 v[32:35], v198, s[8:11], s36 offen offset:0 sc1
  v_cvt_pk_bf16_f32 v130, v64, v65
  v_mfma_f32_16x16x32_bf16 a[124:127], a[204:207], v[108:111], a[124:127]
  v_add_f32 v192, v192, v66
  s_waitcnt lgkmcnt(8)
  v_mfma_f32_16x16x32_bf16 a[128:131], a[208:211], v[96:99], a[128:131]
  ds_read_b64_tr_b16 a[196:197], v2 offset:36864
  v_add_f32 v192, v192, v67
  v_mfma_f32_16x16x32_bf16 a[136:139], a[208:211], v[100:103], a[136:139]
  ds_read_b64_tr_b16 a[198:199], v2 offset:43008
  v_cvt_pk_bf16_f32 v131, v66, v67
  v_mfma_f32_16x16x32_bf16 a[144:147], a[208:211], v[104:107], a[144:147]
  buffer_load_dwordx4 v[36:39], v199, s[8:11], s36 offen offset:0 sc1
  v_mfma_f32_16x16x32_bf16 a[152:155], a[208:211], v[108:111], a[152:155]
  s_waitcnt lgkmcnt(8)
  v_mfma_f32_16x16x32_bf16 a[132:135], a[212:215], v[96:99], a[132:135]
  ds_read_b64_tr_b16 a[200:201], v3 offset:36864
  v_exp_f32 v68, v68
  v_mfma_f32_16x16x32_bf16 a[140:143], a[212:215], v[100:103], a[140:143]
  ds_read_b64_tr_b16 a[202:203], v3 offset:43008
  v_exp_f32 v69, v69
  v_mfma_f32_16x16x32_bf16 a[148:151], a[212:215], v[104:107], a[148:151]
  buffer_load_dwordx4 v[40:43], v198, s[8:11], s36 offen offset:2048 sc1
  v_add_f32 v193, v193, v68
  v_mfma_f32_16x16x32_bf16 a[156:159], a[212:215], v[108:111], a[156:159]
  v_exp_f32 v70, v70
  s_waitcnt lgkmcnt(8)
  v_mfma_f32_16x16x32_bf16 a[160:163], a[216:219], v[96:99], a[160:163]
  ds_read_b64_tr_b16 a[204:205], v4 offset:36864
  v_add_f32 v193, v193, v69
  v_mfma_f32_16x16x32_bf16 a[168:171], a[216:219], v[100:103], a[168:171]
  ds_read_b64_tr_b16 a[206:207], v4 offset:43008
  v_exp_f32 v71, v71
  v_mfma_f32_16x16x32_bf16 a[176:179], a[216:219], v[104:107], a[176:179]
  buffer_load_dwordx4 v[44:47], v199, s[8:11], s36 offen offset:2048 sc1
  v_cvt_pk_bf16_f32 v134, v68, v69
  v_mfma_f32_16x16x32_bf16 a[184:187], a[216:219], v[108:111], a[184:187]
  v_add_f32 v193, v193, v70
  s_waitcnt lgkmcnt(8)
  v_mfma_f32_16x16x32_bf16 a[164:167], a[220:223], v[96:99], a[164:167]
  ds_read_b64_tr_b16 a[208:209], v1 offset:36992
  v_add_f32 v193, v193, v71
  v_mfma_f32_16x16x32_bf16 a[172:175], a[220:223], v[100:103], a[172:175]
  ds_read_b64_tr_b16 a[210:211], v1 offset:43136
  v_cvt_pk_bf16_f32 v135, v70, v71
  v_mfma_f32_16x16x32_bf16 a[180:183], a[220:223], v[104:107], a[180:183]
  v_mfma_f32_16x16x32_bf16 a[188:191], a[220:223], v[108:111], a[188:191]
  s_waitcnt lgkmcnt(8)
re_tail:
  v_exp_f32 v72, v72
  v_exp_f32 v76, v76
  v_exp_f32 v73, v73
  v_exp_f32 v77, v77
  v_add_f32 v194, v194, v72
  v_add_f32 v195, v195, v76
  v_exp_f32 v74, v74
  v_exp_f32 v78, v78
  v_add_f32 v194, v194, v73
  v_add_f32 v195, v195, v77
  v_exp_f32 v75, v75
  v_exp_f32 v79, v79
  v_cvt_pk_bf16_f32 v138, v72, v73
  v_cvt_pk_bf16_f32 v142, v76, v77
  v_add_f32 v194, v194, v74
  v_add_f32 v195, v195, v78
  v_add_f32 v194, v194, v75
  v_add_f32 v195, v195, v79
  v_cvt_pk_bf16_f32 v139, v74, v75
  v_cvt_pk_bf16_f32 v143, v78, v79
  s_nop 0
  v_mfma_f32_16x16x32_bf16 a[0:3], a[192:195], v[128:131], a[0:3]
  ds_read_b64_tr_b16 a[212:213], v2 offset:36992
  v_mov_b32 v6, 0x53800000
  s_lshl_b32 s73, s32, 2
  s_add_u32 s73, s73, 126976
  v_mfma_f32_16x16x32_bf16 a[8:11], a[192:195], v[132:135], a[8:11]
  ds_read_b64_tr_b16 a[214:215], v2 offset:43136
  v_mov_b32 v7, s73
  s_nop 1
  v_permlane32_swap_b32 v192, v193
  v_mfma_f32_16x16x32_bf16 a[16:19], a[192:195], v[136:139], a[16:19]
  v_permlane32_swap_b32 v194, v195
  s_nop 1
  v_add_f32 v192, v192, v193
  v_mfma_f32_16x16x32_bf16 a[24:27], a[192:195], v[140:143], a[24:27]
  v_add_f32 v194, v194, v195
  s_nop 1
  v_permlane16_swap_b32 v192, v194
  s_waitcnt lgkmcnt(8)
  v_mfma_f32_16x16x32_bf16 a[4:7], a[196:199], v[128:131], a[4:7]
  ds_read_b64_tr_b16 a[216:217], v3 offset:36992
  s_nop 1
  v_add_f32 v192, v192, v194
  v_cmp_nlt_f32 vcc, v192, v6
  v_mfma_f32_16x16x32_bf16 a[12:15], a[196:199], v[132:135], a[12:15]
  ds_read_b64_tr_b16 a[218:219], v3 offset:43136
  v_rcp_f32 v192, v192
  s_cmp_lg_u64 vcc, 0
  s_cselect_b32 s73, 1, 0
  v_mfma_f32_16x16x32_bf16 a[20:23], a[196:199], v[136:139], a[20:23]
  v_mov_b32 v6, s73
  ds_write_b32 v7, v6
  v_mov_b32 v194, v192
  v_mfma_f32_16x16x32_bf16 a[28:31], a[196:199], v[140:143], a[28:31]
  s_nop 1
  v_permlane16_swap_b32 v192, v194
  s_nop 1
  s_waitcnt lgkmcnt(9)
  v_mfma_f32_16x16x32_bf16 a[32:35], a[200:203], v[128:131], a[32:35]
  ds_read_b64_tr_b16 a[220:221], v4 offset:36992
  v_mov_b32 v193, v192
  v_mov_b32 v195, v194
  s_nop 1
  v_mfma_f32_16x16x32_bf16 a[40:43], a[200:203], v[132:135], a[40:43]
  ds_read_b64_tr_b16 a[222:223], v4 offset:43136
  v_permlane32_swap_b32 v192, v193
  v_permlane32_swap_b32 v194, v195
  s_nop 1
  v_mfma_f32_16x16x32_bf16 a[48:51], a[200:203], v[136:139], a[48:51]
  v_mov_b32 v160, v192
  v_mov_b32 v161, v192
  v_mov_b32 v164, v193
  v_mfma_f32_16x16x32_bf16 a[56:59], a[200:203], v[140:143], a[56:59]
  v_mov_b32 v165, v193
  v_mov_b32 v168, v194
  v_mov_b32 v169, v194
  s_waitcnt lgkmcnt(9)
  v_mfma_f32_16x16x32_bf16 a[36:39], a[204:207], v[128:131], a[36:39]
  ds_read_b64_tr_b16 a[192:193], v1 offset:37120
  v_mov_b32 v172, v195
  v_mov_b32 v173, v195
  v_mfma_f32_16x16x32_bf16 a[44:47], a[204:207], v[132:135], a[44:47]
  ds_read_b64_tr_b16 a[194:195], v1 offset:43264
  v_accvgpr_read_b32 v96, a0
  v_accvgpr_read_b32 v97, a1
  v_accvgpr_read_b32 v98, a2
  v_mfma_f32_16x16x32_bf16 a[52:55], a[204:207], v[136:139], a[52:55]
  v_accvgpr_read_b32 v99, a3
  v_accvgpr_read_b32 v100, a4
  v_accvgpr_read_b32 v101, a5
  v_mfma_f32_16x16x32_bf16 a[60:63], a[204:207], v[140:143], a[60:63]
  v_accvgpr_read_b32 v102, a6
  v_accvgpr_read_b32 v103, a7
  v_mul_f32 v96, v96, v160
  s_waitcnt lgkmcnt(9)
  v_mfma_f32_16x16x32_bf16 a[64:67], a[208:211], v[128:131], a[64:67]
  ds_read_b64_tr_b16 a[196:197], v2 offset:37120
  v_mul_f32 v97, v97, v160
  v_mul_f32 v98, v98, v160
  v_mul_f32 v99, v99, v160
  v_mfma_f32_16x16x32_bf16 a[72:75], a[208:211], v[132:135], a[72:75]
  ds_read_b64_tr_b16 a[198:199], v2 offset:43264
  v_mul_f32 v100, v100, v160
  v_mul_f32 v101, v101, v160
  v_mul_f32 v102, v102, v160
  v_mfma_f32_16x16x32_bf16 a[80:83], a[208:211], v[136:139], a[80:83]
  v_mul_f32 v103, v103, v160
  v_cvt_pk_bf16_f32 v96, v96, v97
  v_cvt_pk_bf16_f32 v97, v98, v99
  v_mfma_f32_16x16x32_bf16 a[88:91], a[208:211], v[140:143], a[88:91]
  v_cvt_pk_bf16_f32 v98, v100, v101
  v_cvt_pk_bf16_f32 v99, v102, v103
  buffer_store_dwordx4 v[96:99], v0, s[28:31], s42 offen offset:0 sc1
  s_waitcnt lgkmcnt(9)
  v_mfma_f32_16x16x32_bf16 a[68:71], a[212:215], v[128:131], a[68:71]
  ds_read_b64_tr_b16 a[200:201], v3 offset:37120
  v_accvgpr_read_b32 v104, a8
  v_accvgpr_read_b32 v105, a9
  v_accvgpr_read_b32 v106, a10
  v_mfma_f32_16x16x32_bf16 a[76:79], a[212:215], v[132:135], a[76:79]
  ds_read_b64_tr_b16 a[202:203], v3 offset:43264
  v_accvgpr_read_b32 v107, a11
  v_accvgpr_read_b32 v108, a12
  v_accvgpr_read_b32 v109, a13
  v_mfma_f32_16x16x32_bf16 a[84:87], a[212:215], v[136:139], a[84:87]
  v_accvgpr_read_b32 v110, a14
  v_accvgpr_read_b32 v111, a15
  v_mul_f32 v104, v104, v164
  v_mfma_f32_16x16x32_bf16 a[92:95], a[212:215], v[140:143], a[92:95]
  v_mul_f32 v105, v105, v164
  v_mul_f32 v106, v106, v164
  v_mul_f32 v107, v107, v164
  s_waitcnt lgkmcnt(9)
  v_mfma_f32_16x16x32_bf16 a[96:99], a[216:219], v[128:131], a[96:99]
  ds_read_b64_tr_b16 a[204:205], v4 offset:37120
  v_mul_f32 v108, v108, v164
  v_mul_f32 v109, v109, v164
  v_mul_f32 v110, v110, v164
  v_mfma_f32_16x16x32_bf16 a[104:107], a[216:219], v[132:135], a[104:107]
  ds_read_b64_tr_b16 a[206:207], v4 offset:43264
  v_mul_f32 v111, v111, v164
  v_cvt_pk_bf16_f32 v104, v104, v105
  v_cvt_pk_bf16_f32 v105, v106, v107
  v_mfma_f32_16x16x32_bf16 a[112:115], a[216:219], v[136:139], a[112:115]
  v_cvt_pk_bf16_f32 v106, v108, v109
  v_cvt_pk_bf16_f32 v107, v110, v111
  buffer_store_dwordx4 v[104:107], v0, s[28:31], s42 offen offset:1024 sc1
  v_mfma_f32_16x16x32_bf16 a[120:123], a[216:219], v[140:143], a[120:123]
  v_accvgpr_read_b32 v64, a16
  v_accvgpr_read_b32 v65, a17
  v_accvgpr_read_b32 v66, a18
  s_waitcnt lgkmcnt(8)
  v_mfma_f32_16x16x32_bf16 a[100:103], a[220:223], v[128:131], a[100:103]
  v_accvgpr_read_b32 v67, a19
  v_accvgpr_read_b32 v68, a20
  v_accvgpr_read_b32 v69, a21
  v_mfma_f32_16x16x32_bf16 a[108:111], a[220:223], v[132:135], a[108:111]
  v_accvgpr_read_b32 v70, a22
  v_accvgpr_read_b32 v71, a23
  v_mul_f32 v64, v64, v168
  v_mfma_f32_16x16x32_bf16 a[116:119], a[220:223], v[136:139], a[116:119]
  v_mul_f32 v65, v65, v168
  v_mul_f32 v66, v66, v168
  v_mul_f32 v67, v67, v168
  v_mfma_f32_16x16x32_bf16 a[124:127], a[220:223], v[140:143], a[124:127]
  v_mul_f32 v68, v68, v168
  v_mul_f32 v69, v69, v168
  v_mul_f32 v70, v70, v168
  s_waitcnt lgkmcnt(6)
  v_mfma_f32_16x16x32_bf16 a[128:131], a[192:195], v[128:131], a[128:131]
  v_mul_f32 v71, v71, v168
  v_cvt_pk_bf16_f32 v64, v64, v65
  v_cvt_pk_bf16_f32 v65, v66, v67
  v_mfma_f32_16x16x32_bf16 a[136:139], a[192:195], v[132:135], a[136:139]
  v_cvt_pk_bf16_f32 v66, v68, v69
  v_cvt_pk_bf16_f32 v67, v70, v71
  buffer_store_dwordx4 v[64:67], v0, s[28:31], s45 offen offset:0 sc1
  v_mfma_f32_16x16x32_bf16 a[144:147], a[192:195], v[136:139], a[144:147]
  v_accvgpr_read_b32 v72, a24
  v_accvgpr_read_b32 v73, a25
  v_accvgpr_read_b32 v74, a26
  v_mfma_f32_16x16x32_bf16 a[152:155], a[192:195], v[140:143], a[152:155]
  v_accvgpr_read_b32 v75, a27
  v_accvgpr_read_b32 v76, a28
  v_accvgpr_read_b32 v77, a29
  s_waitcnt lgkmcnt(4)
  v_mfma_f32_16x16x32_bf16 a[132:135], a[196:199], v[128:131], a[132:135]
  v_accvgpr_read_b32 v78, a30
  v_accvgpr_read_b32 v79, a31
  v_mul_f32 v72, v72, v172
  v_mfma_f32_16x16x32_bf16 a[140:143], a[196:199], v[132:135], a[140:143]
  v_mul_f32 v73, v73, v172
  v_mul_f32 v74, v74, v172
  v_mul_f32 v75, v75, v172
  v_mfma_f32_16x16x32_bf16 a[148:151], a[196:199], v[136:139], a[148:151]
  v_mul_f32 v76, v76, v172
  v_mul_f32 v77, v77, v172
  v_mul_f32 v78, v78, v172
  v_mfma_f32_16x16x32_bf16 a[156:159], a[196:199], v[140:143], a[156:159]
  v_mul_f32 v79, v79, v172
  v_cvt_pk_bf16_f32 v72, v72, v73
  v_cvt_pk_bf16_f32 v73, v74, v75
  s_waitcnt lgkmcnt(2)
  v_mfma_f32_16x16x32_bf16 a[160:163], a[200:203], v[128:131], a[160:163]
  v_cvt_pk_bf16_f32 v74, v76, v77
  v_cvt_pk_bf16_f32 v75, v78, v79
  buffer_store_dwordx4 v[72:75], v0, s[28:31], s45 offen offset:1024 sc1
  v_mfma_f32_16x16x32_bf16 a[168:171], a[200:203], v[132:135], a[168:171]
  v_accvgpr_read_b32 v96, a32
  v_accvgpr_read_b32 v97, a33
  v_accvgpr_read_b32 v98, a34
  v_mfma_f32_16x16x32_bf16 a[176:179], a[200:203], v[136:139], a[176:179]
  v_accvgpr_read_b32 v99, a35
  v_accvgpr_read_b32 v100, a36
  v_accvgpr_read_b32 v101, a37
  v_mfma_f32_16x16x32_bf16 a[184:187], a[200:203], v[140:143], a[184:187]
  v_accvgpr_read_b32 v102, a38
  v_accvgpr_read_b32 v103, a39
  v_mul_f32 v96, v96, v160
  s_waitcnt lgkmcnt(0)
  v_mfma_f32_16x16x32_bf16 a[164:167], a[204:207], v[128:131], a[164:167]
  v_mul_f32 v97, v97, v160
  v_mul_f32 v98, v98, v160
  v_mul_f32 v99, v99, v160
  v_mfma_f32_16x16x32_bf16 a[172:175], a[204:207], v[132:135], a[172:175]
  v_mul_f32 v100, v100, v160
  v_mul_f32 v101, v101, v160
  v_mul_f32 v102, v102, v160
  v_mfma_f32_16x16x32_bf16 a[180:183], a[204:207], v[136:139], a[180:183]
  v_mul_f32 v103, v103, v160
  v_cvt_pk_bf16_f32 v96, v96, v97
  v_cvt_pk_bf16_f32 v97, v98, v99
  v_mfma_f32_16x16x32_bf16 a[188:191], a[204:207], v[140:143], a[188:191]
  v_cvt_pk_bf16_f32 v98, v100, v101
  v_cvt_pk_bf16_f32 v99, v102, v103
  buffer_store_dwordx4 v[96:99], v0, s[28:31], s42 offen offset:2048 sc1
  s_waitcnt vmcnt(5)
  s_barrier
  v_mov_b32 v7, 126976
  ds_read_b128 v[192:195], v7
  v_accvgpr_read_b32 v104, a40
  v_accvgpr_read_b32 v105, a41
  v_accvgpr_read_b32 v106, a42
  v_accvgpr_read_b32 v107, a43
  v_accvgpr_read_b32 v108, a44
  v_accvgpr_read_b32 v109, a45
  v_accvgpr_read_b32 v110, a46
  v_accvgpr_read_b32 v111, a47
  v_pk_mul_f32 v[104:105], v[104:105], v[164:165]
  v_pk_mul_f32 v[106:107], v[106:107], v[164:165]
  v_pk_mul_f32 v[108:109], v[108:109], v[164:165]
  v_pk_mul_f32 v[110:111], v[110:111], v[164:165]
  v_cvt_pk_bf16_f32 v104, v104, v105
  v_cvt_pk_bf16_f32 v105, v106, v107
  v_cvt_pk_bf16_f32 v106, v108, v109
  v_cvt_pk_bf16_f32 v107, v110, v111
  buffer_store_dwordx4 v[104:107], v0, s[28:31], s42 offen offset:3072 sc1
  s_waitcnt lgkmcnt(0)
  v_or3_b32 v192, v192, v193, v194
  v_or_b32 v192, v192, v195
  s_nop 0
  v_readfirstlane_b32 s73, v192
  s_andn2_b32 s73, s73, s40
  s_cbranch_scc1 re_fb
re_tail2:
  s_load_dwordx2 s[52:53], s[0:1], 0
  s_load_dwordx4 s[80:83], s[0:1], 72
  v_accvgpr_read_b32 v64, a48
  v_accvgpr_read_b32 v65, a49
  v_accvgpr_read_b32 v66, a50
  v_accvgpr_read_b32 v67, a51
  v_accvgpr_read_b32 v68, a52
  v_accvgpr_read_b32 v69, a53
  v_accvgpr_read_b32 v70, a54
  v_accvgpr_read_b32 v71, a55
  v_pk_mul_f32 v[64:65], v[64:65], v[168:169]
  v_pk_mul_f32 v[66:67], v[66:67], v[168:169]
  v_pk_mul_f32 v[68:69], v[68:69], v[168:169]
  v_pk_mul_f32 v[70:71], v[70:71], v[168:169]
  v_cvt_pk_bf16_f32 v64, v64, v65
  v_cvt_pk_bf16_f32 v65, v66, v67
  v_cvt_pk_bf16_f32 v66, v68, v69
  v_cvt_pk_bf16_f32 v67, v70, v71
  s_lshr_b32 s37, s61, 1
  s_movk_i32 s36, 24576
  s_mov_b32 s69, 0
  s_bfe_u32 s34, s2, 0x20003
  s_and_b32 s35, s61, 1
  v_lshrrev_b32 v17, 4, v0
  buffer_store_dwordx4 v[64:67], v0, s[28:31], s45 offen offset:2048 sc1
  v_accvgpr_read_b32 v72, a56
  v_accvgpr_read_b32 v73, a57
  v_accvgpr_read_b32 v74, a58
  v_accvgpr_read_b32 v75, a59
  v_accvgpr_read_b32 v76, a60
  v_accvgpr_read_b32 v77, a61
  v_accvgpr_read_b32 v78, a62
  v_accvgpr_read_b32 v79, a63
  v_pk_mul_f32 v[72:73], v[72:73], v[172:173]
  v_pk_mul_f32 v[74:75], v[74:75], v[172:173]
  v_pk_mul_f32 v[76:77], v[76:77], v[172:173]
  v_pk_mul_f32 v[78:79], v[78:79], v[172:173]
  v_cvt_pk_bf16_f32 v72, v72, v73
  v_cvt_pk_bf16_f32 v73, v74, v75
  v_cvt_pk_bf16_f32 v74, v76, v77
  v_cvt_pk_bf16_f32 v75, v78, v79
  s_mul_i32 s38, s34, 320
  s_mul_i32 s70, s61, 1966080
  s_add_u32 s70, s70, s38
  v_lshrrev_b32 v19, 2, v17
  v_mul_u32_u24 v19, 320, v19
  v_and_b32 v20, 3, v17
  buffer_store_dwordx4 v[72:75], v0, s[28:31], s45 offen offset:3072 sc1
  v_accvgpr_read_b32 v96, a64
  v_accvgpr_read_b32 v97, a65
  v_accvgpr_read_b32 v98, a66
  v_accvgpr_read_b32 v99, a67
  v_accvgpr_read_b32 v100, a68
  v_accvgpr_read_b32 v101, a69
  v_accvgpr_read_b32 v102, a70
  v_accvgpr_read_b32 v103, a71
  v_pk_mul_f32 v[96:97], v[96:97], v[160:161]
  v_pk_mul_f32 v[98:99], v[98:99], v[160:161]
  v_pk_mul_f32 v[100:101], v[100:101], v[160:161]
  v_pk_mul_f32 v[102:103], v[102:103], v[160:161]
  v_cvt_pk_bf16_f32 v96, v96, v97
  v_cvt_pk_bf16_f32 v97, v98, v99
  v_cvt_pk_bf16_f32 v98, v100, v101
  v_cvt_pk_bf16_f32 v99, v102, v103
  v_lshl_add_u32 v19, v20, 3, v19
  v_bfe_u32 v20, v17, 4, 1
  v_lshl_add_u32 v6, v20, 5, v19
  v_xor_b32 v20, 1, v20
  v_lshl_add_u32 v7, v20, 5, v19
  v_add_u32 v8, 61440, v6
  buffer_store_dwordx4 v[96:99], v0, s[28:31], s43 offen offset:0 sc1
  v_accvgpr_read_b32 v104, a72
  v_accvgpr_read_b32 v105, a73
  v_accvgpr_read_b32 v106, a74
  v_accvgpr_read_b32 v107, a75
  v_accvgpr_read_b32 v108, a76
  v_accvgpr_read_b32 v109, a77
  v_accvgpr_read_b32 v110, a78
  v_accvgpr_read_b32 v111, a79
  v_pk_mul_f32 v[104:105], v[104:105], v[164:165]
  v_pk_mul_f32 v[106:107], v[106:107], v[164:165]
  v_pk_mul_f32 v[108:109], v[108:109], v[164:165]
  v_pk_mul_f32 v[110:111], v[110:111], v[164:165]
  v_cvt_pk_bf16_f32 v104, v104, v105
  v_cvt_pk_bf16_f32 v105, v106, v107
  v_cvt_pk_bf16_f32 v106, v108, v109
  v_cvt_pk_bf16_f32 v107, v110, v111
  v_add_u32 v9, 61440, v7
  s_mul_i32 s72, s35, 160
  s_add_u32 s72, s72, s38
  v_lshrrev_b32 v19, 4, v17
  v_lshlrev_b32 v19, 3, v19
  v_add_u32 v13, s72, v19
  buffer_store_dwordx4 v[104:107], v0, s[28:31], s43 offen offset:1024 sc1
  v_accvgpr_read_b32 v64, a80
  v_accvgpr_read_b32 v65, a81
  v_accvgpr_read_b32 v66, a82
  v_accvgpr_read_b32 v67, a83
  v_accvgpr_read_b32 v68, a84
  v_accvgpr_read_b32 v69, a85
  v_accvgpr_read_b32 v70, a86
  v_accvgpr_read_b32 v71, a87
  v_pk_mul_f32 v[64:65], v[64:65], v[168:169]
  v_pk_mul_f32 v[66:67], v[66:67], v[168:169]
  v_pk_mul_f32 v[68:69], v[68:69], v[168:169]
  v_pk_mul_f32 v[70:71], v[70:71], v[168:169]
  v_cvt_pk_bf16_f32 v64, v64, v65
  v_cvt_pk_bf16_f32 v65, v66, v67
  v_cvt_pk_bf16_f32 v66, v68, v69
  v_cvt_pk_bf16_f32 v67, v70, v71
  s_lshl_b32 s72, s51, 1
  s_add_u32 s72, s72, s37
  s_mul_i32 s72, s72, 20480
  v_and_b32 v20, 15, v17
  v_mul_u32_u24 v20, 1280, v20
  v_add3_u32 v12, v20, v13, s72
  buffer_store_dwordx4 v[64:67], v0, s[28:31], s46 offen offset:0 sc1
  v_accvgpr_read_b32 v72, a88
  v_accvgpr_read_b32 v73, a89
  v_accvgpr_read_b32 v74, a90
  v_accvgpr_read_b32 v75, a91
  v_accvgpr_read_b32 v76, a92
  v_accvgpr_read_b32 v77, a93
  v_accvgpr_read_b32 v78, a94
  v_accvgpr_read_b32 v79, a95
  v_pk_mul_f32 v[72:73], v[72:73], v[172:173]
  v_pk_mul_f32 v[74:75], v[74:75], v[172:173]
  v_pk_mul_f32 v[76:77], v[76:77], v[172:173]
  v_pk_mul_f32 v[78:79], v[78:79], v[172:173]
  v_cvt_pk_bf16_f32 v72, v72, v73
  v_cvt_pk_bf16_f32 v73, v74, v75
  v_cvt_pk_bf16_f32 v74, v76, v77
  v_cvt_pk_bf16_f32 v75, v78, v79
  v_and_b32 v1, 3, v17
  v_lshlrev_b32 v1, 2, v1
  v_add_u32 v2, 12288, v0
  v_lshrrev_b32 v3, 1, v0
  v_add_u32 v4, 12288, v3
  s_add_u32 s71, s71, 32
  buffer_store_dwordx4 v[72:75], v0, s[28:31], s46 offen offset:1024 sc1
  v_accvgpr_read_b32 v96, a96
  v_accvgpr_read_b32 v97, a97
  v_accvgpr_read_b32 v98, a98
  v_accvgpr_read_b32 v99, a99
  v_accvgpr_read_b32 v100, a100
  v_accvgpr_read_b32 v101, a101
  v_accvgpr_read_b32 v102, a102
  v_accvgpr_read_b32 v103, a103
  v_pk_mul_f32 v[96:97], v[96:97], v[160:161]
  v_pk_mul_f32 v[98:99], v[98:99], v[160:161]
  v_pk_mul_f32 v[100:101], v[100:101], v[160:161]
  v_pk_mul_f32 v[102:103], v[102:103], v[160:161]
  v_cvt_pk_bf16_f32 v96, v96, v97
  v_cvt_pk_bf16_f32 v97, v98, v99
  v_cvt_pk_bf16_f32 v98, v100, v101
  v_cvt_pk_bf16_f32 v99, v102, v103
  s_add_u32 s54, s54, 32
  s_mov_b32 s39, 0
  s_lshl_b32 s33, s51, 2
  s_add_u32 s33, s33, s34
  s_lshl_b32 s48, s33, 7
  s_add_u32 s48, s48, 3244032
  buffer_store_dwordx4 v[96:99], v0, s[28:31], s43 offen offset:2048 sc1
  v_accvgpr_read_b32 v104, a104
  v_accvgpr_read_b32 v105, a105
  v_accvgpr_read_b32 v106, a106
  v_accvgpr_read_b32 v107, a107
  v_accvgpr_read_b32 v108, a108
  v_accvgpr_read_b32 v109, a109
  v_accvgpr_read_b32 v110, a110
  v_accvgpr_read_b32 v111, a111
  v_pk_mul_f32 v[104:105], v[104:105], v[164:165]
  v_pk_mul_f32 v[106:107], v[106:107], v[164:165]
  v_pk_mul_f32 v[108:109], v[108:109], v[164:165]
  v_pk_mul_f32 v[110:111], v[110:111], v[164:165]
  v_cvt_pk_bf16_f32 v104, v104, v105
  v_cvt_pk_bf16_f32 v105, v106, v107
  v_cvt_pk_bf16_f32 v106, v108, v109
  v_cvt_pk_bf16_f32 v107, v110, v111
  s_lshl_b32 s49, s61, 2
  s_add_u32 s49, s49, s48
  s_mul_i32 s33, s33, 98304
  v_mov_b64 v[16:17], 0
  v_mov_b64 v[18:19], 0
  v_mov_b64 v[20:21], 0
  buffer_store_dwordx4 v[104:107], v0, s[28:31], s43 offen offset:3072 sc1
  v_accvgpr_read_b32 v64, a112
  v_accvgpr_read_b32 v65, a113
  v_accvgpr_read_b32 v66, a114
  v_accvgpr_read_b32 v67, a115
  v_accvgpr_read_b32 v68, a116
  v_accvgpr_read_b32 v69, a117
  v_accvgpr_read_b32 v70, a118
  v_accvgpr_read_b32 v71, a119
  v_pk_mul_f32 v[64:65], v[64:65], v[168:169]
  v_pk_mul_f32 v[66:67], v[66:67], v[168:169]
  v_pk_mul_f32 v[68:69], v[68:69], v[168:169]
  v_pk_mul_f32 v[70:71], v[70:71], v[168:169]
  v_cvt_pk_bf16_f32 v64, v64, v65
  v_cvt_pk_bf16_f32 v65, v66, v67
  v_cvt_pk_bf16_f32 v66, v68, v69
  v_cvt_pk_bf16_f32 v67, v70, v71
  v_mov_b64 v[22:23], 0
  v_mov_b64 v[24:25], 0
  v_mov_b64 v[26:27], 0
  v_mov_b64 v[28:29], 0
  v_mov_b64 v[30:31], 0
  v_mfma_f32_32x32x16_bf16 v[48:63], v[16:19], v[16:19], 0
  buffer_store_dwordx4 v[64:67], v0, s[28:31], s46 offen offset:2048 sc1
  s_add_u32 s56, s74, s70
  s_addc_u32 s57, s75, 0
  s_mov_b32 s58, 0
  s_mov_b32 s59, 0x20000
  s_sub_u32 s58, 1966080, s38
  s_add_u32 s16, s62, 37748736
  s_addc_u32 s17, s63, 0
  s_mov_b32 s18, 25165824
  s_mov_b32 s19, 0x20000
  v_accvgpr_read_b32 v72, a120
  v_accvgpr_read_b32 v73, a121
  v_accvgpr_read_b32 v74, a122
  v_accvgpr_read_b32 v75, a123
  v_accvgpr_read_b32 v76, a124
  v_accvgpr_read_b32 v77, a125
  v_accvgpr_read_b32 v78, a126
  v_accvgpr_read_b32 v79, a127
  v_pk_mul_f32 v[72:73], v[72:73], v[172:173]
  v_pk_mul_f32 v[74:75], v[74:75], v[172:173]
  v_pk_mul_f32 v[76:77], v[76:77], v[172:173]
  v_pk_mul_f32 v[78:79], v[78:79], v[172:173]
  v_cvt_pk_bf16_f32 v72, v72, v73
  v_cvt_pk_bf16_f32 v73, v74, v75
  v_cvt_pk_bf16_f32 v74, v76, v77
  v_cvt_pk_bf16_f32 v75, v78, v79
  v_mfma_f32_32x32x16_bf16 v[80:95], v[16:19], v[16:19], 0
  buffer_store_dwordx4 v[72:75], v0, s[28:31], s46 offen offset:3072 sc1
  s_waitcnt lgkmcnt(0)
  s_add_u32 s20, s52, 0
  s_addc_u32 s21, s53, 0
  s_mov_b32 s22, 2621440
  s_mov_b32 s23, 0x20000
  s_add_u32 s24, s82, 0
  s_addc_u32 s25, s83, 0
  s_mov_b32 s26, 2621440
  s_mov_b32 s27, 0x20000
  s_add_u32 s64, s80, 0
  s_addc_u32 s65, s81, 0
  s_mov_b32 s66, 1280
  s_mov_b32 s67, 0x20000
  v_accvgpr_read_b32 v96, a128
  v_accvgpr_read_b32 v97, a129
  v_accvgpr_read_b32 v98, a130
  v_accvgpr_read_b32 v99, a131
  v_accvgpr_read_b32 v100, a132
  v_accvgpr_read_b32 v101, a133
  v_accvgpr_read_b32 v102, a134
  v_accvgpr_read_b32 v103, a135
  v_pk_mul_f32 v[96:97], v[96:97], v[160:161]
  v_pk_mul_f32 v[98:99], v[98:99], v[160:161]
  v_pk_mul_f32 v[100:101], v[100:101], v[160:161]
  v_pk_mul_f32 v[102:103], v[102:103], v[160:161]
  v_cvt_pk_bf16_f32 v96, v96, v97
  v_cvt_pk_bf16_f32 v97, v98, v99
  v_cvt_pk_bf16_f32 v98, v100, v101
  v_cvt_pk_bf16_f32 v99, v102, v103
  buffer_store_dwordx4 v[96:99], v0, s[28:31], s44 offen offset:0 sc1
  v_accvgpr_read_b32 v104, a136
  v_accvgpr_read_b32 v105, a137
  v_accvgpr_read_b32 v106, a138
  v_accvgpr_read_b32 v107, a139
  v_accvgpr_read_b32 v108, a140
  v_accvgpr_read_b32 v109, a141
  v_accvgpr_read_b32 v110, a142
  v_accvgpr_read_b32 v111, a143
  v_pk_mul_f32 v[104:105], v[104:105], v[164:165]
  v_pk_mul_f32 v[106:107], v[106:107], v[164:165]
  v_pk_mul_f32 v[108:109], v[108:109], v[164:165]
  v_pk_mul_f32 v[110:111], v[110:111], v[164:165]
  v_cvt_pk_bf16_f32 v104, v104, v105
  v_cvt_pk_bf16_f32 v105, v106, v107
  v_cvt_pk_bf16_f32 v106, v108, v109
  v_cvt_pk_bf16_f32 v107, v110, v111
  buffer_store_dwordx4 v[104:107], v0, s[28:31], s44 offen offset:1024 sc1
  v_accvgpr_read_b32 v64, a144
  v_accvgpr_read_b32 v65, a145
  v_accvgpr_read_b32 v66, a146
  v_accvgpr_read_b32 v67, a147
  v_accvgpr_read_b32 v68, a148
  v_accvgpr_read_b32 v69, a149
  v_accvgpr_read_b32 v70, a150
  v_accvgpr_read_b32 v71, a151
  v_pk_mul_f32 v[64:65], v[64:65], v[168:169]
  v_pk_mul_f32 v[66:67], v[66:67], v[168:169]
  v_pk_mul_f32 v[68:69], v[68:69], v[168:169]
  v_pk_mul_f32 v[70:71], v[70:71], v[168:169]
  v_cvt_pk_bf16_f32 v64, v64, v65
  v_cvt_pk_bf16_f32 v65, v66, v67
  v_cvt_pk_bf16_f32 v66, v68, v69
  v_cvt_pk_bf16_f32 v67, v70, v71
  buffer_store_dwordx4 v[64:67], v0, s[28:31], s47 offen offset:0 sc1
  v_accvgpr_read_b32 v72, a152
  v_accvgpr_read_b32 v73, a153
  v_accvgpr_read_b32 v74, a154
  v_accvgpr_read_b32 v75, a155
  v_accvgpr_read_b32 v76, a156
  v_accvgpr_read_b32 v77, a157
  v_accvgpr_read_b32 v78, a158
  v_accvgpr_read_b32 v79, a159
  v_pk_mul_f32 v[72:73], v[72:73], v[172:173]
  v_pk_mul_f32 v[74:75], v[74:75], v[172:173]
  v_pk_mul_f32 v[76:77], v[76:77], v[172:173]
  v_pk_mul_f32 v[78:79], v[78:79], v[172:173]
  v_cvt_pk_bf16_f32 v72, v72, v73
  v_cvt_pk_bf16_f32 v73, v74, v75
  v_cvt_pk_bf16_f32 v74, v76, v77
  v_cvt_pk_bf16_f32 v75, v78, v79
  buffer_store_dwordx4 v[72:75], v0, s[28:31], s47 offen offset:1024 sc1
  v_accvgpr_read_b32 v96, a160
  v_accvgpr_read_b32 v97, a161
  v_accvgpr_read_b32 v98, a162
  v_accvgpr_read_b32 v99, a163
  v_accvgpr_read_b32 v100, a164
  v_accvgpr_read_b32 v101, a165
  v_accvgpr_read_b32 v102, a166
  v_accvgpr_read_b32 v103, a167
  v_pk_mul_f32 v[96:97], v[96:97], v[160:161]
  v_pk_mul_f32 v[98:99], v[98:99], v[160:161]
  v_pk_mul_f32 v[100:101], v[100:101], v[160:161]
  v_pk_mul_f32 v[102:103], v[102:103], v[160:161]
  v_cvt_pk_bf16_f32 v96, v96, v97
  v_cvt_pk_bf16_f32 v97, v98, v99
  v_cvt_pk_bf16_f32 v98, v100, v101
  v_cvt_pk_bf16_f32 v99, v102, v103
  buffer_store_dwordx4 v[96:99], v0, s[28:31], s44 offen offset:2048 sc1
  ds_read_b64_tr_b16 a[96:97], v6 offset:0
  ds_read_b64_tr_b16 a[98:99], v6 offset:5120
  ds_read_b64_tr_b16 a[100:101], v7 offset:0
  ds_read_b64_tr_b16 a[102:103], v7 offset:5120
  v_accvgpr_read_b32 v104, a168
  v_accvgpr_read_b32 v105, a169
  v_accvgpr_read_b32 v106, a170
  v_accvgpr_read_b32 v107, a171
  v_accvgpr_read_b32 v108, a172
  v_accvgpr_read_b32 v109, a173
  v_accvgpr_read_b32 v110, a174
  v_accvgpr_read_b32 v111, a175
  v_pk_mul_f32 v[104:105], v[104:105], v[164:165]
  v_pk_mul_f32 v[106:107], v[106:107], v[164:165]
  v_pk_mul_f32 v[108:109], v[108:109], v[164:165]
  v_pk_mul_f32 v[110:111], v[110:111], v[164:165]
  v_cvt_pk_bf16_f32 v104, v104, v105
  v_cvt_pk_bf16_f32 v105, v106, v107
  v_cvt_pk_bf16_f32 v106, v108, v109
  v_cvt_pk_bf16_f32 v107, v110, v111
  buffer_store_dwordx4 v[104:107], v0, s[28:31], s44 offen offset:3072 sc1
  ds_read_b64_tr_b16 a[104:105], v6 offset:64
  ds_read_b64_tr_b16 a[106:107], v6 offset:5184
  ds_read_b64_tr_b16 a[108:109], v7 offset:64
  ds_read_b64_tr_b16 a[110:111], v7 offset:5184
  v_accvgpr_read_b32 v64, a176
  v_accvgpr_read_b32 v65, a177
  v_accvgpr_read_b32 v66, a178
  v_accvgpr_read_b32 v67, a179
  v_accvgpr_read_b32 v68, a180
  v_accvgpr_read_b32 v69, a181
  v_accvgpr_read_b32 v70, a182
  v_accvgpr_read_b32 v71, a183
  v_pk_mul_f32 v[64:65], v[64:65], v[168:169]
  v_pk_mul_f32 v[66:67], v[66:67], v[168:169]
  v_pk_mul_f32 v[68:69], v[68:69], v[168:169]
  v_pk_mul_f32 v[70:71], v[70:71], v[168:169]
  v_cvt_pk_bf16_f32 v64, v64, v65
  v_cvt_pk_bf16_f32 v65, v66, v67
  v_cvt_pk_bf16_f32 v66, v68, v69
  v_cvt_pk_bf16_f32 v67, v70, v71
  buffer_store_dwordx4 v[64:67], v0, s[28:31], s47 offen offset:2048 sc1
  ds_read_b64_tr_b16 a[112:113], v6 offset:128
  ds_read_b64_tr_b16 a[114:115], v6 offset:5248
  ds_read_b64_tr_b16 a[116:117], v7 offset:128
  ds_read_b64_tr_b16 a[118:119], v7 offset:5248
  v_accvgpr_read_b32 v72, a184
  v_accvgpr_read_b32 v73, a185
  v_accvgpr_read_b32 v74, a186
  v_accvgpr_read_b32 v75, a187
  v_accvgpr_read_b32 v76, a188
  v_accvgpr_read_b32 v77, a189
  v_accvgpr_read_b32 v78, a190
  v_accvgpr_read_b32 v79, a191
  v_pk_mul_f32 v[72:73], v[72:73], v[172:173]
  v_pk_mul_f32 v[74:75], v[74:75], v[172:173]
  v_pk_mul_f32 v[76:77], v[76:77], v[172:173]
  v_pk_mul_f32 v[78:79], v[78:79], v[172:173]
  v_cvt_pk_bf16_f32 v72, v72, v73
  v_cvt_pk_bf16_f32 v73, v74, v75
  v_cvt_pk_bf16_f32 v74, v76, v77
  v_cvt_pk_bf16_f32 v75, v78, v79
  buffer_store_dwordx4 v[72:75], v0, s[28:31], s47 offen offset:3072 sc1
  ds_read_b64_tr_b16 a[120:121], v6 offset:192
  ds_read_b64_tr_b16 a[122:123], v6 offset:5312
  s_waitcnt lgkmcnt(10)
.p2align 6
re_l0:
  v_mfma_f32_16x16x32_bf16 v[96:99], a[96:99], v[32:35], 0
  ds_read_b64_tr_b16 a[124:125], v7 offset:192
  v_mfma_f32_16x16x32_bf16 v[136:139], a[96:99], v[36:39], 0
  ds_read_b64_tr_b16 a[126:127], v7 offset:5312
  v_mfma_f32_16x16x32_bf16 v[100:103], a[100:103], v[32:35], 0
  ds_read_b64_tr_b16 a[128:129], v6 offset:256
  v_mfma_f32_16x16x32_bf16 v[140:143], a[100:103], v[36:39], 0
  ds_read_b64_tr_b16 a[130:131], v6 offset:5376
  s_waitcnt lgkmcnt(10)
  v_mfma_f32_16x16x32_bf16 v[104:107], a[104:107], v[32:35], 0
  ds_read_b64_tr_b16 a[132:133], v7 offset:256
  v_mfma_f32_16x16x32_bf16 v[144:147], a[104:107], v[36:39], 0
  ds_read_b64_tr_b16 a[134:135], v7 offset:5376
  v_mfma_f32_16x16x32_bf16 v[108:111], a[108:111], v[32:35], 0
  ds_read_b64_tr_b16 a[96:97], v6 offset:10240
  s_xor_b32 s72, s61, 0
  s_mul_i32 s72, s72, 24576
  v_mfma_f32_16x16x32_bf16 v[148:151], a[108:111], v[36:39], 0
  ds_read_b64_tr_b16 a[98:99], v6 offset:15360
  s_add_u32 s72, s72, s33
  s_waitcnt lgkmcnt(10)
  v_mfma_f32_16x16x32_bf16 v[112:115], a[112:115], v[32:35], 0
  ds_read_b64_tr_b16 a[100:101], v7 offset:10240
  s_add_u32 s40, s72, 0
  v_mfma_f32_16x16x32_bf16 v[152:155], a[112:115], v[36:39], 0
  ds_read_b64_tr_b16 a[102:103], v7 offset:15360
  s_xor_b32 s72, s61, 1
  v_mfma_f32_16x16x32_bf16 v[116:119], a[116:119], v[32:35], 0
  ds_read_b64_tr_b16 a[104:105], v6 offset:10304
  s_mul_i32 s72, s72, 24576
  v_mfma_f32_16x16x32_bf16 v[156:159], a[116:119], v[36:39], 0
  ds_read_b64_tr_b16 a[106:107], v6 offset:15424
  s_add_u32 s72, s72, s33
  s_waitcnt lgkmcnt(10)
  v_mfma_f32_16x16x32_bf16 v[120:123], a[120:123], v[32:35], 0
  ds_read_b64_tr_b16 a[108:109], v7 offset:10304
  s_add_u32 s41, s72, 3072
  v_mfma_f32_16x16x32_bf16 v[160:163], a[120:123], v[36:39], 0
  ds_read_b64_tr_b16 a[110:111], v7 offset:15424
  s_xor_b32 s72, s61, 2
  v_mfma_f32_16x16x32_bf16 v[124:127], a[124:127], v[32:35], 0
  ds_read_b64_tr_b16 a[112:113], v6 offset:10368
  s_mul_i32 s72, s72, 24576
  v_mfma_f32_16x16x32_bf16 v[164:167], a[124:127], v[36:39], 0
  ds_read_b64_tr_b16 a[114:115], v6 offset:15488
  s_add_u32 s72, s72, s33
  s_waitcnt lgkmcnt(10)
  v_mfma_f32_16x16x32_bf16 v[128:131], a[128:131], v[32:35], 0
  ds_read_b64_tr_b16 a[116:117], v7 offset:10368
  s_add_u32 s42, s72, 6144
  v_mfma_f32_16x16x32_bf16 v[168:171], a[128:131], v[36:39], 0
  ds_read_b64_tr_b16 a[118:119], v7 offset:15488
  s_xor_b32 s72, s61, 3
  v_mfma_f32_16x16x32_bf16 v[132:135], a[132:135], v[32:35], 0
  ds_read_b64_tr_b16 a[120:121], v6 offset:10432
  s_mul_i32 s72, s72, 24576
  v_mfma_f32_16x16x32_bf16 v[172:175], a[132:135], v[36:39], 0
  ds_read_b64_tr_b16 a[122:123], v6 offset:15552
  s_add_u32 s72, s72, s33
  s_waitcnt lgkmcnt(10)
  v_mfma_f32_16x16x32_bf16 v[96:99], a[96:99], v[40:43], v[96:99]
  ds_read_b64_tr_b16 a[124:125], v7 offset:10432
  s_add_u32 s43, s72, 9216
  v_mfma_f32_16x16x32_bf16 v[136:139], a[96:99], v[44:47], v[136:139]
  ds_read_b64_tr_b16 a[126:127], v7 offset:15552
  s_add_u32 s44, s40, 3072
  v_mfma_f32_16x16x32_bf16 v[100:103], a[100:103], v[40:43], v[100:103]
  ds_read_b64_tr_b16 a[128:129], v6 offset:10496
  buffer_load_dwordx2 v[186:187], v13, s[64:67], 0 offen offset:0
  s_add_u32 s45, s40, 6144
  v_mfma_f32_16x16x32_bf16 v[140:143], a[100:103], v[44:47], v[140:143]
  ds_read_b64_tr_b16 a[130:131], v6 offset:15616
  s_add_u32 s46, s40, 9216
  s_waitcnt lgkmcnt(10)
  v_mfma_f32_16x16x32_bf16 v[104:107], a[104:107], v[40:43], v[104:107]
  ds_read_b64_tr_b16 a[132:133], v7 offset:10496
  v_mfma_f32_16x16x32_bf16 v[144:147], a[104:107], v[44:47], v[144:147]
  ds_read_b64_tr_b16 a[134:135], v7 offset:15616
  v_mfma_f32_16x16x32_bf16 v[108:111], a[108:111], v[40:43], v[108:111]
  ds_read_b64_tr_b16 a[96:97], v6 offset:20480
  buffer_load_dwordx2 v[188:189], v13, s[64:67], 0 offen offset:32
  v_mfma_f32_16x16x32_bf16 v[148:151], a[108:111], v[44:47], v[148:151]
  ds_read_b64_tr_b16 a[98:99], v6 offset:25600
  s_waitcnt lgkmcnt(10)
  v_mfma_f32_16x16x32_bf16 v[112:115], a[112:115], v[40:43], v[112:115]
  ds_read_b64_tr_b16 a[100:101], v7 offset:20480
  v_mfma_f32_16x16x32_bf16 v[152:155], a[112:115], v[44:47], v[152:155]
  ds_read_b64_tr_b16 a[102:103], v7 offset:25600
  v_mfma_f32_16x16x32_bf16 v[116:119], a[116:119], v[40:43], v[116:119]
  ds_read_b64_tr_b16 a[104:105], v6 offset:20544
  buffer_load_dwordx2 v[190:191], v13, s[64:67], 0 offen offset:64
  v_mfma_f32_16x16x32_bf16 v[156:159], a[116:119], v[44:47], v[156:159]
  ds_read_b64_tr_b16 a[106:107], v6 offset:25664
  s_waitcnt lgkmcnt(10)
  v_mfma_f32_16x16x32_bf16 v[120:123], a[120:123], v[40:43], v[120:123]
  ds_read_b64_tr_b16 a[108:109], v7 offset:20544
  v_mfma_f32_16x16x32_bf16 v[160:163], a[120:123], v[44:47], v[160:163]
  ds_read_b64_tr_b16 a[110:111], v7 offset:25664
  v_mfma_f32_16x16x32_bf16 v[124:127], a[124:127], v[40:43], v[124:127]
  ds_read_b64_tr_b16 a[112:113], v6 offset:20608
  buffer_load_dwordx2 v[192:193], v13, s[64:67], 0 offen offset:96
  v_mfma_f32_16x16x32_bf16 v[164:167], a[124:127], v[44:47], v[164:167]
  ds_read_b64_tr_b16 a[114:115], v6 offset:25728
  s_waitcnt lgkmcnt(10)
  v_mfma_f32_16x16x32_bf16 v[128:131], a[128:131], v[40:43], v[128:131]
  ds_read_b64_tr_b16 a[116:117], v7 offset:20608
  v_mfma_f32_16x16x32_bf16 v[168:171], a[128:131], v[44:47], v[168:171]
  ds_read_b64_tr_b16 a[118:119], v7 offset:25728
  v_mfma_f32_16x16x32_bf16 v[132:135], a[132:135], v[40:43], v[132:135]
  ds_read_b64_tr_b16 a[120:121], v6 offset:20672
  buffer_load_dwordx2 v[194:195], v13, s[64:67], 0 offen offset:128
  v_mfma_f32_16x16x32_bf16 v[172:175], a[132:135], v[44:47], v[172:175]
  ds_read_b64_tr_b16 a[122:123], v6 offset:25792
  s_waitcnt lgkmcnt(10)
  v_mfma_f32_16x16x32_bf16 v[96:99], a[96:99], a[224:227], v[96:99]
  ds_read_b64_tr_b16 a[124:125], v7 offset:20672
  v_mfma_f32_16x16x32_bf16 v[136:139], a[96:99], a[228:231], v[136:139]
  ds_read_b64_tr_b16 a[126:127], v7 offset:25792
  v_mfma_f32_16x16x32_bf16 v[100:103], a[100:103], a[224:227], v[100:103]
  ds_read_b64_tr_b16 a[128:129], v6 offset:20736
  buffer_load_dwordx2 v[176:177], v12, s[20:23], 0 offen offset:0
  v_mfma_f32_16x16x32_bf16 v[140:143], a[100:103], a[228:231], v[140:143]
  ds_read_b64_tr_b16 a[130:131], v6 offset:25856
  s_waitcnt lgkmcnt(10)
  v_mfma_f32_16x16x32_bf16 v[104:107], a[104:107], a[224:227], v[104:107]
  ds_read_b64_tr_b16 a[132:133], v7 offset:20736
  v_mov_b32 v32, 0
  v_mfma_f32_16x16x32_bf16 v[144:147], a[104:107], a[228:231], v[144:147]
  ds_read_b64_tr_b16 a[134:135], v7 offset:25856
  v_mov_b32 v33, 0
  v_mfma_f32_16x16x32_bf16 v[108:111], a[108:111], a[224:227], v[108:111]
  ds_read_b64_tr_b16 a[96:97], v6 offset:30720
  v_mov_b32 v34, 0
  v_mfma_f32_16x16x32_bf16 v[148:151], a[108:111], a[228:231], v[148:151]
  ds_read_b64_tr_b16 a[98:99], v6 offset:35840
  v_mov_b32 v35, 0
  s_waitcnt lgkmcnt(10)
  v_mfma_f32_16x16x32_bf16 v[112:115], a[112:115], a[224:227], v[112:115]
  ds_read_b64_tr_b16 a[100:101], v7 offset:30720
  v_mov_b32 v36, 0
  buffer_load_dwordx2 v[178:179], v12, s[20:23], 0 offen offset:32
  v_mfma_f32_16x16x32_bf16 v[152:155], a[112:115], a[228:231], v[152:155]
  ds_read_b64_tr_b16 a[102:103], v7 offset:35840
  v_mov_b32 v37, 0
  v_mfma_f32_16x16x32_bf16 v[116:119], a[116:119], a[224:227], v[116:119]
  ds_read_b64_tr_b16 a[104:105], v6 offset:30784
  v_mov_b32 v38, 0
  v_mfma_f32_16x16x32_bf16 v[156:159], a[116:119], a[228:231], v[156:159]
  ds_read_b64_tr_b16 a[106:107], v6 offset:35904
  v_mov_b32 v39, 0
  s_waitcnt lgkmcnt(10)
  v_mfma_f32_16x16x32_bf16 v[120:123], a[120:123], a[224:227], v[120:123]
  ds_read_b64_tr_b16 a[108:109], v7 offset:30784
  v_mfma_f32_16x16x32_bf16 v[160:163], a[120:123], a[228:231], v[160:163]
  ds_read_b64_tr_b16 a[110:111], v7 offset:35904
  v_mov_b32 v40, 0
  v_mfma_f32_16x16x32_bf16 v[124:127], a[124:127], a[224:227], v[124:127]
  ds_read_b64_tr_b16 a[112:113], v6 offset:30848
  v_mov_b32 v41, 0
  buffer_load_dwordx2 v[180:181], v12, s[20:23], 0 offen offset:64
  v_mfma_f32_16x16x32_bf16 v[164:167], a[124:127], a[228:231], v[164:167]
  ds_read_b64_tr_b16 a[114:115], v6 offset:35968
  v_mov_b32 v42, 0
  s_waitcnt lgkmcnt(10)
  v_mfma_f32_16x16x32_bf16 v[128:131], a[128:131], a[224:227], v[128:131]
  ds_read_b64_tr_b16 a[116:117], v7 offset:30848
  v_mov_b32 v43, 0
  v_mfma_f32_16x16x32_bf16 v[168:171], a[128:131], a[228:231], v[168:171]
  ds_read_b64_tr_b16 a[118:119], v7 offset:35968
  v_mov_b32 v44, 0
  v_mfma_f32_16x16x32_bf16 v[132:135], a[132:135], a[224:227], v[132:135]
  ds_read_b64_tr_b16 a[120:121], v6 offset:30912
  v_mov_b32 v45, 0
  v_mfma_f32_16x16x32_bf16 v[172:175], a[132:135], a[228:231], v[172:175]
  ds_read_b64_tr_b16 a[122:123], v6 offset:36032
  v_mov_b32 v46, 0
  s_waitcnt lgkmcnt(10)
  v_mfma_f32_16x16x32_bf16 v[96:99], a[96:99], a[232:235], v[96:99]
  ds_read_b64_tr_b16 a[124:125], v7 offset:30912
  v_mov_b32 v47, 0
  buffer_load_dwordx2 v[182:183], v12, s[20:23], 0 offen offset:96
  v_mfma_f32_16x16x32_bf16 v[136:139], a[96:99], a[236:239], v[136:139]
  ds_read_b64_tr_b16 a[126:127], v7 offset:36032
  v_mfma_f32_16x16x32_bf16 v[100:103], a[100:103], a[232:235], v[100:103]
  ds_read_b64_tr_b16 a[128:129], v6 offset:30976
  v_mov_b32 v64, 0
  v_mfma_f32_16x16x32_bf16 v[140:143], a[100:103], a[236:239], v[140:143]
  ds_read_b64_tr_b16 a[130:131], v6 offset:36096
  v_mov_b32 v65, 0
  s_waitcnt lgkmcnt(10)
  v_mfma_f32_16x16x32_bf16 v[104:107], a[104:107], a[232:235], v[104:107]
  ds_read_b64_tr_b16 a[132:133], v7 offset:30976
  s_add_u32 m0, s68, 0
  v_mov_b32 v66, 0
  v_mfma_f32_16x16x32_bf16 v[144:147], a[104:107], a[236:239], v[144:147]
  ds_read_b64_tr_b16 a[134:135], v7 offset:36096
  s_barrier
  v_mov_b32 v67, 0
  v_mfma_f32_16x16x32_bf16 v[108:111], a[108:111], a[232:235], v[108:111]
  ds_read_b64_tr_b16 a[96:97], v6 offset:40960
  buffer_load_dwordx4 v200, s[56:59], s69 offen offset:0 lds
  v_mov_b32 v68, 0
  v_mfma_f32_16x16x32_bf16 v[148:151], a[108:111], a[236:239], v[148:151]
  ds_read_b64_tr_b16 a[98:99], v6 offset:46080
  v_mov_b32 v69, 0
  s_waitcnt lgkmcnt(10)
  v_mfma_f32_16x16x32_bf16 v[112:115], a[112:115], a[232:235], v[112:115]
  ds_read_b64_tr_b16 a[100:101], v7 offset:40960
  v_mov_b32 v70, 0
  v_mfma_f32_16x16x32_bf16 v[152:155], a[112:115], a[236:239], v[152:155]
  ds_read_b64_tr_b16 a[102:103], v7 offset:46080
  v_mov_b32 v71, 0
  v_mfma_f32_16x16x32_bf16 v[116:119], a[116:119], a[232:235], v[116:119]
  ds_read_b64_tr_b16 a[104:105], v6 offset:41024
  buffer_load_dwordx4 v201, s[56:59], s69 offen offset:1024 lds
  s_waitcnt vmcnt(11)
  buffer_store_dword v5, v207, s[76:79], s71 offen sc1
  v_mfma_f32_16x16x32_bf16 v[156:159], a[116:119], a[236:239], v[156:159]
  ds_read_b64_tr_b16 a[106:107], v6 offset:46144
  v_mov_b32 v72, 0
  s_waitcnt lgkmcnt(10)
  v_mfma_f32_16x16x32_bf16 v[120:123], a[120:123], a[232:235], v[120:123]
  ds_read_b64_tr_b16 a[108:109], v7 offset:41024
  v_mov_b32 v73, 0
  v_mfma_f32_16x16x32_bf16 v[160:163], a[120:123], a[236:239], v[160:163]
  ds_read_b64_tr_b16 a[110:111], v7 offset:46144
  v_mov_b32 v74, 0
  v_mfma_f32_16x16x32_bf16 v[124:127], a[124:127], a[232:235], v[124:127]
  ds_read_b64_tr_b16 a[112:113], v6 offset:41088
  buffer_load_dwordx4 v202, s[56:59], s69 offen offset:2048 lds
  v_mov_b32 v75, 0
  v_mfma_f32_16x16x32_bf16 v[164:167], a[124:127], a[236:239], v[164:167]
  ds_read_b64_tr_b16 a[114:115], v6 offset:46208
  v_mov_b32 v76, 0
  s_waitcnt lgkmcnt(10)
  v_mfma_f32_16x16x32_bf16 v[128:131], a[128:131], a[232:235], v[128:131]
  ds_read_b64_tr_b16 a[116:117], v7 offset:41088
  v_mov_b32 v77, 0
  v_mfma_f32_16x16x32_bf16 v[168:171], a[128:131], a[236:239], v[168:171]
  ds_read_b64_tr_b16 a[118:119], v7 offset:46208
  v_mov_b32 v78, 0
  v_mfma_f32_16x16x32_bf16 v[132:135], a[132:135], a[232:235], v[132:135]
  ds_read_b64_tr_b16 a[120:121], v6 offset:41152
  buffer_load_dwordx4 v203, s[56:59], s69 offen offset:3072 lds
  v_mov_b32 v79, 0
  v_mfma_f32_16x16x32_bf16 v[172:175], a[132:135], a[236:239], v[172:175]
  ds_read_b64_tr_b16 a[122:123], v6 offset:46272
  s_waitcnt lgkmcnt(10)
  v_mfma_f32_16x16x32_bf16 v[96:99], a[96:99], a[240:243], v[96:99]
  ds_read_b64_tr_b16 a[124:125], v7 offset:41152
  v_mfma_f32_16x16x32_bf16 v[136:139], a[96:99], a[244:247], v[136:139]
  ds_read_b64_tr_b16 a[126:127], v7 offset:46272
  s_add_u32 m0, s68, 4096
  v_mfma_f32_16x16x32_bf16 v[100:103], a[100:103], a[240:243], v[100:103]
  ds_read_b64_tr_b16 a[128:129], v6 offset:41216
  v_mfma_f32_16x16x32_bf16 v[140:143], a[100:103], a[244:247], v[140:143]
  ds_read_b64_tr_b16 a[130:131], v6 offset:46336
  s_waitcnt lgkmcnt(10)
  v_mfma_f32_16x16x32_bf16 v[104:107], a[104:107], a[240:243], v[104:107]
  ds_read_b64_tr_b16 a[132:133], v7 offset:41216
  buffer_load_dwordx4 v204, s[56:59], s69 offen offset:0 lds
  v_mfma_f32_16x16x32_bf16 v[144:147], a[104:107], a[244:247], v[144:147]
  ds_read_b64_tr_b16 a[134:135], v7 offset:46336
  s_add_u32 s69, s69, 81920
  v_mfma_f32_16x16x32_bf16 v[108:111], a[108:111], a[240:243], v[108:111]
  ds_read_b64_tr_b16 a[96:97], v6 offset:51200
  buffer_load_dwordx2 v[184:185], v12, s[20:23], 0 offen offset:128
  v_mfma_f32_16x16x32_bf16 v[148:151], a[108:111], a[244:247], v[148:151]
  ds_read_b64_tr_b16 a[98:99], v6 offset:56320
  s_waitcnt lgkmcnt(10)
  v_mfma_f32_16x16x32_bf16 v[112:115], a[112:115], a[240:243], v[112:115]
  ds_read_b64_tr_b16 a[100:101], v7 offset:51200
  v_mfma_f32_16x16x32_bf16 v[152:155], a[112:115], a[244:247], v[152:155]
  ds_read_b64_tr_b16 a[102:103], v7 offset:56320
  v_mfma_f32_16x16x32_bf16 v[116:119], a[116:119], a[240:243], v[116:119]
  ds_read_b64_tr_b16 a[104:105], v6 offset:51264
  v_mfma_f32_16x16x32_bf16 v[156:159], a[116:119], a[244:247], v[156:159]
  ds_read_b64_tr_b16 a[106:107], v6 offset:56384
  s_waitcnt lgkmcnt(10)
  v_mfma_f32_16x16x32_bf16 v[120:123], a[120:123], a[240:243], v[120:123]
  ds_read_b64_tr_b16 a[108:109], v7 offset:51264
  v_mfma_f32_16x16x32_bf16 v[160:163], a[120:123], a[244:247], v[160:163]
  ds_read_b64_tr_b16 a[110:111], v7 offset:56384
  v_mfma_f32_16x16x32_bf16 v[124:127], a[124:127], a[240:243], v[124:127]
  ds_read_b64_tr_b16 a[112:113], v6 offset:51328
  v_mfma_f32_16x16x32_bf16 v[164:167], a[124:127], a[244:247], v[164:167]
  ds_read_b64_tr_b16 a[114:115], v6 offset:56448
  s_waitcnt lgkmcnt(10)
  v_mfma_f32_16x16x32_bf16 v[128:131], a[128:131], a[240:243], v[128:131]
  ds_read_b64_tr_b16 a[116:117], v7 offset:51328
  v_mfma_f32_16x16x32_bf16 v[168:171], a[128:131], a[244:247], v[168:171]
  ds_read_b64_tr_b16 a[118:119], v7 offset:56448
  v_mfma_f32_16x16x32_bf16 v[132:135], a[132:135], a[240:243], v[132:135]
  ds_read_b64_tr_b16 a[120:121], v6 offset:51392
  v_mfma_f32_16x16x32_bf16 v[172:175], a[132:135], a[244:247], v[172:175]
  ds_read_b64_tr_b16 a[122:123], v6 offset:56512
  s_waitcnt lgkmcnt(10)
  v_mfma_f32_16x16x32_bf16 v[96:99], a[96:99], a[248:251], v[96:99]
  ds_read_b64_tr_b16 a[124:125], v7 offset:51392
  v_mfma_f32_16x16x32_bf16 v[136:139], a[96:99], a[252:255], v[136:139]
  ds_read_b64_tr_b16 a[126:127], v7 offset:56512
  v_mfma_f32_16x16x32_bf16 v[100:103], a[100:103], a[248:251], v[100:103]
  ds_read_b64_tr_b16 a[128:129], v6 offset:51456
  v_mfma_f32_16x16x32_bf16 v[140:143], a[100:103], a[252:255], v[140:143]
  ds_read_b64_tr_b16 a[130:131], v6 offset:56576
  s_waitcnt lgkmcnt(10)
  v_mfma_f32_16x16x32_bf16 v[104:107], a[104:107], a[248:251], v[104:107]
  ds_read_b64_tr_b16 a[132:133], v7 offset:51456
  s_add_u32 m0, s68, 20480
  v_mfma_f32_16x16x32_bf16 v[144:147], a[104:107], a[252:255], v[144:147]
  ds_read_b64_tr_b16 a[134:135], v7 offset:56576
  s_barrier
  v_mfma_f32_16x16x32_bf16 v[108:111], a[108:111], a[248:251], v[108:111]
  ds_read_b64_tr_b16 a[96:97], v8 offset:0
  buffer_load_dwordx4 v200, s[56:59], s69 offen offset:0 lds
  v_mfma_f32_16x16x32_bf16 v[148:151], a[108:111], a[252:255], v[148:151]
  ds_read_b64_tr_b16 a[98:99], v8 offset:5120
  s_waitcnt lgkmcnt(10)
  v_mfma_f32_16x16x32_bf16 v[112:115], a[112:115], a[248:251], v[112:115]
  ds_read_b64_tr_b16 a[100:101], v9 offset:0
  v_mfma_f32_16x16x32_bf16 v[152:155], a[112:115], a[252:255], v[152:155]
  ds_read_b64_tr_b16 a[102:103], v9 offset:5120
  v_mfma_f32_16x16x32_bf16 v[116:119], a[116:119], a[248:251], v[116:119]
  ds_read_b64_tr_b16 a[104:105], v8 offset:64
  buffer_load_dwordx4 v201, s[56:59], s69 offen offset:1024 lds
  buffer_load_dword v197, v196, s[76:79], s54 offen sc1
  v_mfma_f32_16x16x32_bf16 v[156:159], a[116:119], a[252:255], v[156:159]
  ds_read_b64_tr_b16 a[106:107], v8 offset:5184
  s_waitcnt lgkmcnt(10)
  v_mfma_f32_16x16x32_bf16 v[120:123], a[120:123], a[248:251], v[120:123]
  ds_read_b64_tr_b16 a[108:109], v9 offset:64
  v_mfma_f32_16x16x32_bf16 v[160:163], a[120:123], a[252:255], v[160:163]
  ds_read_b64_tr_b16 a[110:111], v9 offset:5184
  v_mfma_f32_16x16x32_bf16 v[124:127], a[124:127], a[248:251], v[124:127]
  ds_read_b64_tr_b16 a[112:113], v8 offset:128
  buffer_load_dwordx4 v202, s[56:59], s69 offen offset:2048 lds
  v_mfma_f32_16x16x32_bf16 v[164:167], a[124:127], a[252:255], v[164:167]
  ds_read_b64_tr_b16 a[114:115], v8 offset:5248
  s_waitcnt lgkmcnt(10)
  v_mfma_f32_16x16x32_bf16 v[128:131], a[128:131], a[248:251], v[128:131]
  ds_read_b64_tr_b16 a[116:117], v9 offset:128
  v_mfma_f32_16x16x32_bf16 v[168:171], a[128:131], a[252:255], v[168:171]
  ds_read_b64_tr_b16 a[118:119], v9 offset:5248
  v_mfma_f32_16x16x32_bf16 v[132:135], a[132:135], a[248:251], v[132:135]
  ds_read_b64_tr_b16 a[120:121], v8 offset:192
  buffer_load_dwordx4 v203, s[56:59], s69 offen offset:3072 lds
  v_mfma_f32_16x16x32_bf16 v[172:175], a[132:135], a[252:255], v[172:175]
  ds_read_b64_tr_b16 a[122:123], v8 offset:5312
  s_waitcnt lgkmcnt(10)
  v_mfma_f32_16x16x32_bf16 v[96:99], a[96:99], v[208:211], v[96:99]
  ds_read_b64_tr_b16 a[124:125], v9 offset:192
  v_mfma_f32_16x16x32_bf16 v[136:139], a[96:99], v[212:215], v[136:139]
  ds_read_b64_tr_b16 a[126:127], v9 offset:5312
  s_add_u32 m0, s68, 24576
  v_mfma_f32_16x16x32_bf16 v[100:103], a[100:103], v[208:211], v[100:103]
  ds_read_b64_tr_b16 a[128:129], v8 offset:256
  v_mfma_f32_16x16x32_bf16 v[140:143], a[100:103], v[212:215], v[140:143]
  ds_read_b64_tr_b16 a[130:131], v8 offset:5376
  s_waitcnt lgkmcnt(10)
  v_mfma_f32_16x16x32_bf16 v[104:107], a[104:107], v[208:211], v[104:107]
  ds_read_b64_tr_b16 a[132:133], v9 offset:256
  buffer_load_dwordx4 v204, s[56:59], s69 offen offset:0 lds
  v_mfma_f32_16x16x32_bf16 v[144:147], a[104:107], v[212:215], v[144:147]
  ds_read_b64_tr_b16 a[134:135], v9 offset:5376
  s_add_u32 s69, s69, 81920
  v_mfma_f32_16x16x32_bf16 v[108:111], a[108:111], v[208:211], v[108:111]
  ds_read_b64_tr_b16 a[96:97], v8 offset:10240
  v_mfma_f32_16x16x32_bf16 v[148:151], a[108:111], v[212:215], v[148:151]
  ds_read_b64_tr_b16 a[98:99], v8 offset:15360
  s_waitcnt lgkmcnt(10)
  v_mfma_f32_16x16x32_bf16 v[112:115], a[112:115], v[208:211], v[112:115]
  ds_read_b64_tr_b16 a[100:101], v9 offset:10240
  v_mfma_f32_16x16x32_bf16 v[152:155], a[112:115], v[212:215], v[152:155]
  ds_read_b64_tr_b16 a[102:103], v9 offset:15360
  v_mfma_f32_16x16x32_bf16 v[116:119], a[116:119], v[208:211], v[116:119]
  ds_read_b64_tr_b16 a[104:105], v8 offset:10304
  v_mfma_f32_16x16x32_bf16 v[156:159], a[116:119], v[212:215], v[156:159]
  ds_read_b64_tr_b16 a[106:107], v8 offset:15424
  s_waitcnt lgkmcnt(10)
  v_mfma_f32_16x16x32_bf16 v[120:123], a[120:123], v[208:211], v[120:123]
  ds_read_b64_tr_b16 a[108:109], v9 offset:10304
  v_mfma_f32_16x16x32_bf16 v[160:163], a[120:123], v[212:215], v[160:163]
  ds_read_b64_tr_b16 a[110:111], v9 offset:15424
  v_mfma_f32_16x16x32_bf16 v[124:127], a[124:127], v[208:211], v[124:127]
  ds_read_b64_tr_b16 a[112:113], v8 offset:10368
  v_mfma_f32_16x16x32_bf16 v[164:167], a[124:127], v[212:215], v[164:167]
  ds_read_b64_tr_b16 a[114:115], v8 offset:15488
  s_waitcnt lgkmcnt(10)
  v_mfma_f32_16x16x32_bf16 v[128:131], a[128:131], v[208:211], v[128:131]
  ds_read_b64_tr_b16 a[116:117], v9 offset:10368
  v_mfma_f32_16x16x32_bf16 v[168:171], a[128:131], v[212:215], v[168:171]
  ds_read_b64_tr_b16 a[118:119], v9 offset:15488
  v_mfma_f32_16x16x32_bf16 v[132:135], a[132:135], v[208:211], v[132:135]
  ds_read_b64_tr_b16 a[120:121], v8 offset:10432
  v_mfma_f32_16x16x32_bf16 v[172:175], a[132:135], v[212:215], v[172:175]
  ds_read_b64_tr_b16 a[122:123], v8 offset:15552
  s_waitcnt lgkmcnt(10)
  v_mfma_f32_16x16x32_bf16 v[96:99], a[96:99], v[216:219], v[96:99]
  ds_read_b64_tr_b16 a[124:125], v9 offset:10432
  v_mfma_f32_16x16x32_bf16 v[136:139], a[96:99], v[220:223], v[136:139]
  ds_read_b64_tr_b16 a[126:127], v9 offset:15552
  v_mfma_f32_16x16x32_bf16 v[100:103], a[100:103], v[216:219], v[100:103]
  ds_read_b64_tr_b16 a[128:129], v8 offset:10496
  v_mfma_f32_16x16x32_bf16 v[140:143], a[100:103], v[220:223], v[140:143]
  ds_read_b64_tr_b16 a[130:131], v8 offset:15616
  s_waitcnt lgkmcnt(10)
  v_mfma_f32_16x16x32_bf16 v[104:107], a[104:107], v[216:219], v[104:107]
  ds_read_b64_tr_b16 a[132:133], v9 offset:10496
  s_add_u32 m0, s68, 40960
  v_mfma_f32_16x16x32_bf16 v[144:147], a[104:107], v[220:223], v[144:147]
  ds_read_b64_tr_b16 a[134:135], v9 offset:15616
  s_barrier
  v_mfma_f32_16x16x32_bf16 v[108:111], a[108:111], v[216:219], v[108:111]
  ds_read_b64_tr_b16 a[96:97], v8 offset:20480
  buffer_load_dwordx4 v200, s[56:59], s69 offen offset:0 lds
  s_waitcnt vmcnt(4)
  v_cmp_ne_u32 vcc, s60, v197
  v_mfma_f32_16x16x32_bf16 v[148:151], a[108:111], v[220:223], v[148:151]
  ds_read_b64_tr_b16 a[98:99], v8 offset:25600
  s_cbranch_vccnz re_pox
  re_pob:
  s_waitcnt lgkmcnt(10)
  v_mfma_f32_16x16x32_bf16 v[112:115], a[112:115], v[216:219], v[112:115]
  ds_read_b64_tr_b16 a[100:101], v9 offset:20480
  v_mfma_f32_16x16x32_bf16 v[152:155], a[112:115], v[220:223], v[152:155]
  ds_read_b64_tr_b16 a[102:103], v9 offset:25600
  v_mfma_f32_16x16x32_bf16 v[116:119], a[116:119], v[216:219], v[116:119]
  ds_read_b64_tr_b16 a[104:105], v8 offset:20544
  buffer_load_dwordx4 v201, s[56:59], s69 offen offset:1024 lds
  buffer_load_dwordx4 a[0:3], v198, s[8:11], s36 offen offset:0 sc1
  v_mfma_f32_16x16x32_bf16 v[156:159], a[116:119], v[220:223], v[156:159]
  ds_read_b64_tr_b16 a[106:107], v8 offset:25664
  s_waitcnt lgkmcnt(10)
  v_mfma_f32_16x16x32_bf16 v[120:123], a[120:123], v[216:219], v[120:123]
  ds_read_b64_tr_b16 a[108:109], v9 offset:20544
  v_mfma_f32_16x16x32_bf16 v[160:163], a[120:123], v[220:223], v[160:163]
  ds_read_b64_tr_b16 a[110:111], v9 offset:25664
  buffer_load_dwordx4 a[4:7], v199, s[8:11], s36 offen offset:0 sc1
  v_mfma_f32_16x16x32_bf16 v[124:127], a[124:127], v[216:219], v[124:127]
  ds_read_b64_tr_b16 a[112:113], v8 offset:20608
  buffer_load_dwordx4 v202, s[56:59], s69 offen offset:2048 lds
  v_mfma_f32_16x16x32_bf16 v[164:167], a[124:127], v[220:223], v[164:167]
  ds_read_b64_tr_b16 a[114:115], v8 offset:25728
  s_waitcnt lgkmcnt(10)
  v_mfma_f32_16x16x32_bf16 v[128:131], a[128:131], v[216:219], v[128:131]
  ds_read_b64_tr_b16 a[116:117], v9 offset:20608
  v_mfma_f32_16x16x32_bf16 v[168:171], a[128:131], v[220:223], v[168:171]
  ds_read_b64_tr_b16 a[118:119], v9 offset:25728
  buffer_load_dwordx4 a[8:11], v198, s[8:11], s36 offen offset:2048 sc1
  v_mfma_f32_16x16x32_bf16 v[132:135], a[132:135], v[216:219], v[132:135]
  ds_read_b64_tr_b16 a[120:121], v8 offset:20672
  buffer_load_dwordx4 v203, s[56:59], s69 offen offset:3072 lds
  v_mfma_f32_16x16x32_bf16 v[172:175], a[132:135], v[220:223], v[172:175]
  ds_read_b64_tr_b16 a[122:123], v8 offset:25792
  s_waitcnt lgkmcnt(10)
  v_mfma_f32_16x16x32_bf16 v[96:99], a[96:99], v[224:227], v[96:99]
  ds_read_b64_tr_b16 a[124:125], v9 offset:20672
  buffer_load_dwordx4 a[12:15], v199, s[8:11], s36 offen offset:2048 sc1
  v_mfma_f32_16x16x32_bf16 v[136:139], a[96:99], v[228:231], v[136:139]
  ds_read_b64_tr_b16 a[126:127], v9 offset:25792
  s_add_u32 m0, s68, 45056
  v_mfma_f32_16x16x32_bf16 v[100:103], a[100:103], v[224:227], v[100:103]
  ds_read_b64_tr_b16 a[128:129], v8 offset:20736
  v_mfma_f32_16x16x32_bf16 v[140:143], a[100:103], v[228:231], v[140:143]
  ds_read_b64_tr_b16 a[130:131], v8 offset:25856
  s_waitcnt lgkmcnt(10)
  v_mfma_f32_16x16x32_bf16 v[104:107], a[104:107], v[224:227], v[104:107]
  ds_read_b64_tr_b16 a[132:133], v9 offset:20736
  buffer_load_dwordx4 v204, s[56:59], s69 offen offset:0 lds
  s_add_u32 s36, s36, 4096
  v_mfma_f32_16x16x32_bf16 v[144:147], a[104:107], v[228:231], v[144:147]
  ds_read_b64_tr_b16 a[134:135], v9 offset:25856
  s_add_u32 s69, s69, 81920
  v_mfma_f32_16x16x32_bf16 v[108:111], a[108:111], v[224:227], v[108:111]
  ds_read_b64_tr_b16 a[96:97], v8 offset:30720
  v_mfma_f32_16x16x32_bf16 v[148:151], a[108:111], v[228:231], v[148:151]
  ds_read_b64_tr_b16 a[98:99], v8 offset:35840
  buffer_load_dwordx4 a[16:19], v198, s[8:11], s36 offen offset:0 sc1
  s_waitcnt lgkmcnt(10)
  v_mfma_f32_16x16x32_bf16 v[112:115], a[112:115], v[224:227], v[112:115]
  ds_read_b64_tr_b16 a[100:101], v9 offset:30720
  v_mfma_f32_16x16x32_bf16 v[152:155], a[112:115], v[228:231], v[152:155]
  ds_read_b64_tr_b16 a[102:103], v9 offset:35840
  v_mfma_f32_16x16x32_bf16 v[116:119], a[116:119], v[224:227], v[116:119]
  ds_read_b64_tr_b16 a[104:105], v8 offset:30784
  v_mfma_f32_16x16x32_bf16 v[156:159], a[116:119], v[228:231], v[156:159]
  ds_read_b64_tr_b16 a[106:107], v8 offset:35904
  buffer_load_dwordx4 a[20:23], v199, s[8:11], s36 offen offset:0 sc1
  s_waitcnt lgkmcnt(10)
  v_mfma_f32_16x16x32_bf16 v[120:123], a[120:123], v[224:227], v[120:123]
  ds_read_b64_tr_b16 a[108:109], v9 offset:30784
  v_mfma_f32_16x16x32_bf16 v[160:163], a[120:123], v[228:231], v[160:163]
  ds_read_b64_tr_b16 a[110:111], v9 offset:35904
  v_mfma_f32_16x16x32_bf16 v[124:127], a[124:127], v[224:227], v[124:127]
  ds_read_b64_tr_b16 a[112:113], v8 offset:30848
  buffer_load_dwordx4 a[24:27], v198, s[8:11], s36 offen offset:2048 sc1
  v_mfma_f32_16x16x32_bf16 v[164:167], a[124:127], v[228:231], v[164:167]
  ds_read_b64_tr_b16 a[114:115], v8 offset:35968
  s_waitcnt lgkmcnt(10)
  v_mfma_f32_16x16x32_bf16 v[128:131], a[128:131], v[224:227], v[128:131]
  ds_read_b64_tr_b16 a[116:117], v9 offset:30848
  v_mfma_f32_16x16x32_bf16 v[168:171], a[128:131], v[228:231], v[168:171]
  ds_read_b64_tr_b16 a[118:119], v9 offset:35968
  v_mfma_f32_16x16x32_bf16 v[132:135], a[132:135], v[224:227], v[132:135]
  ds_read_b64_tr_b16 a[120:121], v8 offset:30912
  buffer_load_dwordx4 a[28:31], v199, s[8:11], s36 offen offset:2048 sc1
  v_mfma_f32_16x16x32_bf16 v[172:175], a[132:135], v[228:231], v[172:175]
  ds_read_b64_tr_b16 a[122:123], v8 offset:36032
  s_waitcnt lgkmcnt(10)
  v_mfma_f32_16x16x32_bf16 v[96:99], a[96:99], v[232:235], v[96:99]
  ds_read_b64_tr_b16 a[124:125], v9 offset:30912
  v_mfma_f32_16x16x32_bf16 v[136:139], a[96:99], v[236:239], v[136:139]
  ds_read_b64_tr_b16 a[126:127], v9 offset:36032
  s_add_u32 s36, s36, 4096
  v_mfma_f32_16x16x32_bf16 v[100:103], a[100:103], v[232:235], v[100:103]
  ds_read_b64_tr_b16 a[128:129], v8 offset:30976
  v_mfma_f32_16x16x32_bf16 v[140:143], a[100:103], v[236:239], v[140:143]
  ds_read_b64_tr_b16 a[130:131], v8 offset:36096
  s_waitcnt lgkmcnt(10)
  v_mfma_f32_16x16x32_bf16 v[104:107], a[104:107], v[232:235], v[104:107]
  ds_read_b64_tr_b16 a[132:133], v9 offset:30976
  s_add_u32 m0, s68, 61440
  v_mfma_f32_16x16x32_bf16 v[144:147], a[104:107], v[236:239], v[144:147]
  ds_read_b64_tr_b16 a[134:135], v9 offset:36096
  s_barrier
  buffer_load_dwordx4 a[32:35], v198, s[8:11], s36 offen offset:0 sc1
  v_mfma_f32_16x16x32_bf16 v[108:111], a[108:111], v[232:235], v[108:111]
  ds_read_b64_tr_b16 a[96:97], v9 offset:41088
  buffer_load_dwordx4 v200, s[56:59], s69 offen offset:0 lds
  v_mfma_f32_16x16x32_bf16 v[148:151], a[108:111], v[236:239], v[148:151]
  ds_read_b64_tr_b16 a[98:99], v9 offset:46208
  s_waitcnt lgkmcnt(10)
  v_mfma_f32_16x16x32_bf16 v[112:115], a[112:115], v[232:235], v[112:115]
  ds_read_b64_tr_b16 a[100:101], v8 offset:41152
  buffer_load_dwordx4 a[36:39], v199, s[8:11], s36 offen offset:0 sc1
  v_mfma_f32_16x16x32_bf16 v[152:155], a[112:115], v[236:239], v[152:155]
  ds_read_b64_tr_b16 a[102:103], v8 offset:46272
  v_mfma_f32_16x16x32_bf16 v[116:119], a[116:119], v[232:235], v[116:119]
  ds_read_b64_tr_b16 a[104:105], v9 offset:41152
  buffer_load_dwordx4 v201, s[56:59], s69 offen offset:1024 lds
  v_mfma_f32_16x16x32_bf16 v[156:159], a[116:119], v[236:239], v[156:159]
  ds_read_b64_tr_b16 a[106:107], v9 offset:46272
  s_waitcnt lgkmcnt(10)
  v_mfma_f32_16x16x32_bf16 v[120:123], a[120:123], v[232:235], v[120:123]
  ds_read_b64_tr_b16 a[108:109], v8 offset:41216
  buffer_load_dwordx4 a[40:43], v198, s[8:11], s36 offen offset:2048 sc1
  v_mfma_f32_16x16x32_bf16 v[160:163], a[120:123], v[236:239], v[160:163]
  ds_read_b64_tr_b16 a[110:111], v8 offset:46336
  v_mfma_f32_16x16x32_bf16 v[124:127], a[124:127], v[232:235], v[124:127]
  ds_read_b64_tr_b16 a[112:113], v9 offset:41216
  buffer_load_dwordx4 v202, s[56:59], s69 offen offset:2048 lds
  v_mfma_f32_16x16x32_bf16 v[164:167], a[124:127], v[236:239], v[164:167]
  ds_read_b64_tr_b16 a[114:115], v9 offset:46336
  buffer_load_dwordx4 a[44:47], v199, s[8:11], s36 offen offset:2048 sc1
  s_waitcnt lgkmcnt(10)
  v_mfma_f32_16x16x32_bf16 v[128:131], a[128:131], v[232:235], v[128:131]
  ds_read_b64_tr_b16 a[116:117], v9 offset:51328
  v_mfma_f32_16x16x32_bf16 v[168:171], a[128:131], v[236:239], v[168:171]
  ds_read_b64_tr_b16 a[118:119], v9 offset:56448
  v_mfma_f32_16x16x32_bf16 v[132:135], a[132:135], v[232:235], v[132:135]
  ds_read_b64_tr_b16 a[120:121], v8 offset:51392
  buffer_load_dwordx4 v203, s[56:59], s69 offen offset:3072 lds
  v_mfma_f32_16x16x32_bf16 v[172:175], a[132:135], v[236:239], v[172:175]
  ds_read_b64_tr_b16 a[122:123], v8 offset:56512
  s_add_u32 s36, s36, 4096
  s_waitcnt lgkmcnt(10)
  v_mfma_f32_16x16x32_bf16 v[116:119], a[96:99], v[240:243], v[116:119]
  ds_read_b64_tr_b16 a[124:125], v9 offset:51392
  v_mfma_f32_16x16x32_bf16 v[156:159], a[96:99], v[244:247], v[156:159]
  ds_read_b64_tr_b16 a[126:127], v9 offset:56512
  s_add_u32 m0, s68, 65536
  v_mfma_f32_16x16x32_bf16 v[120:123], a[100:103], v[240:243], v[120:123]
  ds_read_b64_tr_b16 a[128:129], v8 offset:51456
  v_mfma_f32_16x16x32_bf16 v[160:163], a[100:103], v[244:247], v[160:163]
  ds_read_b64_tr_b16 a[130:131], v8 offset:56576
  s_waitcnt lgkmcnt(10)
  v_mfma_f32_16x16x32_bf16 v[124:127], a[104:107], v[240:243], v[124:127]
  ds_read_b64_tr_b16 a[132:133], v9 offset:51456
  buffer_load_dwordx4 v204, s[56:59], s69 offen offset:0 lds
  v_mfma_f32_16x16x32_bf16 v[164:167], a[104:107], v[244:247], v[164:167]
  ds_read_b64_tr_b16 a[134:135], v9 offset:56576
  s_add_u32 s69, s69, 81920
  v_mfma_f32_16x16x32_bf16 v[128:131], a[108:111], v[240:243], v[128:131]
  ds_read_b64_tr_b16 a[96:97], v8 offset:40960
  v_mfma_f32_16x16x32_bf16 v[168:171], a[108:111], v[244:247], v[168:171]
  ds_read_b64_tr_b16 a[98:99], v8 offset:46080
  s_waitcnt lgkmcnt(10)
  v_mfma_f32_16x16x32_bf16 v[132:135], a[112:115], v[240:243], v[132:135]
  ds_read_b64_tr_b16 a[100:101], v9 offset:40960
  v_mfma_f32_16x16x32_bf16 v[172:175], a[112:115], v[244:247], v[172:175]
  ds_read_b64_tr_b16 a[102:103], v9 offset:46080
  v_mfma_f32_16x16x32_bf16 v[116:119], a[116:119], v[248:251], v[116:119]
  ds_read_b64_tr_b16 a[104:105], v8 offset:41024
  v_mfma_f32_16x16x32_bf16 v[156:159], a[116:119], v[252:255], v[156:159]
  ds_read_b64_tr_b16 a[106:107], v8 offset:46144
  s_waitcnt lgkmcnt(10)
  v_mfma_f32_16x16x32_bf16 v[120:123], a[120:123], v[248:251], v[120:123]
  ds_read_b64_tr_b16 a[108:109], v9 offset:41024
  v_mfma_f32_16x16x32_bf16 v[160:163], a[120:123], v[252:255], v[160:163]
  ds_read_b64_tr_b16 a[110:111], v9 offset:46144
  v_mfma_f32_16x16x32_bf16 v[124:127], a[124:127], v[248:251], v[124:127]
  ds_read_b64_tr_b16 a[112:113], v8 offset:41088
  v_mfma_f32_16x16x32_bf16 v[164:167], a[124:127], v[252:255], v[164:167]
  ds_read_b64_tr_b16 a[114:115], v8 offset:46208
  s_waitcnt lgkmcnt(10)
  v_mfma_f32_16x16x32_bf16 v[128:131], a[128:131], v[248:251], v[128:131]
  ds_read_b64_tr_b16 a[116:117], v8 offset:51200
  v_mfma_f32_16x16x32_bf16 v[168:171], a[128:131], v[252:255], v[168:171]
  ds_read_b64_tr_b16 a[118:119], v8 offset:56320
  v_mfma_f32_16x16x32_bf16 v[132:135], a[132:135], v[248:251], v[132:135]
  ds_read_b64_tr_b16 a[120:121], v9 offset:51200
  v_mfma_f32_16x16x32_bf16 v[172:175], a[132:135], v[252:255], v[172:175]
  ds_read_b64_tr_b16 a[122:123], v9 offset:56320
  s_waitcnt lgkmcnt(10)
  v_mfma_f32_16x16x32_bf16 v[96:99], a[96:99], v[240:243], v[96:99]
  ds_read_b64_tr_b16 a[124:125], v8 offset:51264
  v_mfma_f32_16x16x32_bf16 v[136:139], a[96:99], v[244:247], v[136:139]
  ds_read_b64_tr_b16 a[126:127], v8 offset:56384
  v_cvt_pk_bf16_f32 v208, v116, v117
  v_cvt_pk_bf16_f32 v209, v118, v119
  v_mfma_f32_16x16x32_bf16 v[100:103], a[100:103], v[240:243], v[100:103]
  ds_read_b64_tr_b16 a[128:129], v9 offset:51264
  v_cvt_pk_bf16_f32 v210, v120, v121
  v_mfma_f32_16x16x32_bf16 v[140:143], a[100:103], v[244:247], v[140:143]
  ds_read_b64_tr_b16 a[130:131], v9 offset:56384
  v_cvt_pk_bf16_f32 v211, v122, v123
  buffer_store_dwordx4 v[208:211], v2, s[16:19], s41 offen offset:0 sc1
  s_waitcnt lgkmcnt(10)
  v_mfma_f32_16x16x32_bf16 v[104:107], a[104:107], v[240:243], v[104:107]
  ds_read_b64_tr_b16 a[132:133], v8 offset:51328
  s_add_u32 m0, s68, 81920
  v_cvt_pk_bf16_f32 v212, v124, v125
  v_mfma_f32_16x16x32_bf16 v[144:147], a[104:107], v[244:247], v[144:147]
  ds_read_b64_tr_b16 a[134:135], v8 offset:56448
  s_barrier
  v_cvt_pk_bf16_f32 v213, v126, v127
  v_cvt_pk_bf16_f32 v214, v128, v129
  v_mfma_f32_16x16x32_bf16 v[108:111], a[108:111], v[240:243], v[108:111]
  ds_read_b64_tr_b16 a[96:97], v6 offset:0
  buffer_load_dwordx4 v200, s[56:59], s69 offen offset:0 lds
  v_cvt_pk_bf16_f32 v215, v130, v131
  v_mfma_f32_16x16x32_bf16 v[148:151], a[108:111], v[244:247], v[148:151]
  ds_read_b64_tr_b16 a[98:99], v6 offset:5120
  buffer_store_dwordx4 v[212:215], v2, s[16:19], s41 offen offset:1024 sc1
  v_cvt_pk_bf16_f32 v216, v132, v133
  s_waitcnt lgkmcnt(10)
  v_mfma_f32_16x16x32_bf16 v[112:115], a[112:115], v[240:243], v[112:115]
  ds_read_b64_tr_b16 a[100:101], v7 offset:0
  v_cvt_pk_bf16_f32 v217, v134, v135
  v_mfma_f32_16x16x32_bf16 v[152:155], a[112:115], v[244:247], v[152:155]
  ds_read_b64_tr_b16 a[102:103], v7 offset:5120
  buffer_store_dwordx2 v[216:217], v4, s[16:19], s41 offen offset:2048 sc1
  v_mfma_f32_16x16x32_bf16 v[96:99], a[116:119], v[248:251], v[96:99]
  ds_read_b64_tr_b16 a[104:105], v6 offset:64
  buffer_load_dwordx4 v201, s[56:59], s69 offen offset:1024 lds
  v_cvt_pk_bf16_f32 v220, v156, v157
  v_cvt_pk_bf16_f32 v221, v158, v159
  v_mfma_f32_16x16x32_bf16 v[136:139], a[116:119], v[252:255], v[136:139]
  ds_read_b64_tr_b16 a[106:107], v6 offset:5184
  v_cvt_pk_bf16_f32 v222, v160, v161
  s_waitcnt lgkmcnt(10)
  v_mfma_f32_16x16x32_bf16 v[100:103], a[120:123], v[248:251], v[100:103]
  ds_read_b64_tr_b16 a[108:109], v7 offset:64
  v_cvt_pk_bf16_f32 v223, v162, v163
  buffer_store_dwordx4 v[220:223], v2, s[16:19], s43 offen offset:0 sc1
  v_mfma_f32_16x16x32_bf16 v[140:143], a[120:123], v[252:255], v[140:143]
  ds_read_b64_tr_b16 a[110:111], v7 offset:5184
  v_cvt_pk_bf16_f32 v224, v164, v165
  v_mfma_f32_16x16x32_bf16 v[104:107], a[124:127], v[248:251], v[104:107]
  ds_read_b64_tr_b16 a[112:113], v6 offset:128
  buffer_load_dwordx4 v202, s[56:59], s69 offen offset:2048 lds
  v_cvt_pk_bf16_f32 v225, v166, v167
  v_cvt_pk_bf16_f32 v226, v168, v169
  v_mfma_f32_16x16x32_bf16 v[144:147], a[124:127], v[252:255], v[144:147]
  ds_read_b64_tr_b16 a[114:115], v6 offset:5248
  v_cvt_pk_bf16_f32 v227, v170, v171
  s_waitcnt lgkmcnt(10)
  v_mfma_f32_16x16x32_bf16 v[108:111], a[128:131], v[248:251], v[108:111]
  ds_read_b64_tr_b16 a[116:117], v7 offset:128
  buffer_store_dwordx4 v[224:227], v2, s[16:19], s43 offen offset:1024 sc1
  v_cvt_pk_bf16_f32 v228, v172, v173
  v_mfma_f32_16x16x32_bf16 v[148:151], a[128:131], v[252:255], v[148:151]
  ds_read_b64_tr_b16 a[118:119], v7 offset:5248
  v_cvt_pk_bf16_f32 v229, v174, v175
  v_mfma_f32_16x16x32_bf16 v[112:115], a[132:135], v[248:251], v[112:115]
  ds_read_b64_tr_b16 a[120:121], v6 offset:192
  buffer_load_dwordx4 v203, s[56:59], s69 offen offset:3072 lds
  buffer_store_dwordx2 v[228:229], v4, s[16:19], s43 offen offset:2048 sc1
  v_mfma_f32_16x16x32_bf16 v[152:155], a[132:135], v[252:255], v[152:155]
  ds_read_b64_tr_b16 a[122:123], v6 offset:5312
  s_waitcnt lgkmcnt(10)
  s_nop 7
  v_cvt_pk_bf16_f32 v232, v136, v137
  v_cvt_pk_bf16_f32 v233, v138, v139
  v_cvt_pk_bf16_f32 v234, v140, v141
  v_cvt_pk_bf16_f32 v235, v142, v143
  buffer_store_dwordx4 v[232:235], v2, s[16:19], s42 offen offset:0 sc1
  v_cvt_pk_bf16_f32 v236, v144, v145
  v_cvt_pk_bf16_f32 v237, v146, v147
  v_cvt_pk_bf16_f32 v238, v148, v149
  v_cvt_pk_bf16_f32 v239, v150, v151
  buffer_store_dwordx4 v[236:239], v2, s[16:19], s42 offen offset:1024 sc1
  v_cvt_pk_bf16_f32 v240, v152, v153
  v_cvt_pk_bf16_f32 v241, v154, v155
  buffer_store_dwordx2 v[240:241], v4, s[16:19], s42 offen offset:2048 sc1
  s_mov_b64 vcc, -1
  s_waitcnt vmcnt(27)
.p2align 6
re_loop:
  v_mfma_f32_16x16x32_bf16 v[16:19], a[96:99], a[0:3], v[16:19]
  ds_read_b64_tr_b16 a[124:125], v7 offset:192
  v_mfma_f32_16x16x32_bf16 v[56:59], a[96:99], a[4:7], v[56:59]
  ds_read_b64_tr_b16 a[126:127], v7 offset:5312
  s_add_u32 m0, s68, 86016
  v_mfma_f32_16x16x32_bf16 v[20:23], a[100:103], a[0:3], v[20:23]
  ds_read_b64_tr_b16 a[128:129], v6 offset:256
  v_mfma_f32_16x16x32_bf16 v[60:63], a[100:103], a[4:7], v[60:63]
  ds_read_b64_tr_b16 a[130:131], v6 offset:5376
  s_waitcnt lgkmcnt(10)
  v_mfma_f32_16x16x32_bf16 v[24:27], a[104:107], a[0:3], v[24:27]
  ds_read_b64_tr_b16 a[132:133], v7 offset:256
  buffer_load_dwordx4 v204, s[56:59], s69 offen offset:0 lds
  v_mfma_f32_16x16x32_bf16 v[64:67], a[104:107], a[4:7], v[64:67]
  ds_read_b64_tr_b16 a[134:135], v7 offset:5376
  s_add_u32 s69, s69, 81920
  v_mfma_f32_16x16x32_bf16 v[28:31], a[108:111], a[0:3], v[28:31]
  ds_read_b64_tr_b16 a[96:97], v6 offset:10240
  v_mfma_f32_16x16x32_bf16 v[68:71], a[108:111], a[4:7], v[68:71]
  ds_read_b64_tr_b16 a[98:99], v6 offset:15360
  s_waitcnt lgkmcnt(10)
  v_mfma_f32_16x16x32_bf16 v[32:35], a[112:115], a[0:3], v[32:35]
  ds_read_b64_tr_b16 a[100:101], v7 offset:10240
  buffer_load_dwordx4 a[48:51], v198, s[8:11], s36 offen offset:0 sc1
  v_mfma_f32_16x16x32_bf16 v[72:75], a[112:115], a[4:7], v[72:75]
  ds_read_b64_tr_b16 a[102:103], v7 offset:15360
  v_mfma_f32_16x16x32_bf16 v[36:39], a[116:119], a[0:3], v[36:39]
  ds_read_b64_tr_b16 a[104:105], v6 offset:10304
  v_mfma_f32_16x16x32_bf16 v[76:79], a[116:119], a[4:7], v[76:79]
  ds_read_b64_tr_b16 a[106:107], v6 offset:15424
  s_waitcnt lgkmcnt(10)
  v_mfma_f32_16x16x32_bf16 v[40:43], a[120:123], a[0:3], v[40:43]
  ds_read_b64_tr_b16 a[108:109], v7 offset:10304
  v_mfma_f32_16x16x32_bf16 v[80:83], a[120:123], a[4:7], v[80:83]
  ds_read_b64_tr_b16 a[110:111], v7 offset:15424
  buffer_load_dwordx4 a[52:55], v199, s[8:11], s36 offen offset:0 sc1
  v_mfma_f32_16x16x32_bf16 v[44:47], a[124:127], a[0:3], v[44:47]
  ds_read_b64_tr_b16 a[112:113], v6 offset:10368
  v_mfma_f32_16x16x32_bf16 v[84:87], a[124:127], a[4:7], v[84:87]
  ds_read_b64_tr_b16 a[114:115], v6 offset:15488
  s_waitcnt lgkmcnt(10)
  v_mfma_f32_16x16x32_bf16 v[48:51], a[128:131], a[0:3], v[48:51]
  ds_read_b64_tr_b16 a[116:117], v7 offset:10368
  v_mfma_f32_16x16x32_bf16 v[88:91], a[128:131], a[4:7], v[88:91]
  ds_read_b64_tr_b16 a[118:119], v7 offset:15488
  buffer_load_dwordx4 a[56:59], v198, s[8:11], s36 offen offset:2048 sc1
  v_mfma_f32_16x16x32_bf16 v[52:55], a[132:135], a[0:3], v[52:55]
  ds_read_b64_tr_b16 a[120:121], v6 offset:10432
  v_mfma_f32_16x16x32_bf16 v[92:95], a[132:135], a[4:7], v[92:95]
  ds_read_b64_tr_b16 a[122:123], v6 offset:15552
  s_waitcnt lgkmcnt(10)
  v_mfma_f32_16x16x32_bf16 v[16:19], a[96:99], a[8:11], v[16:19]
  ds_read_b64_tr_b16 a[124:125], v7 offset:10432
  v_mfma_f32_16x16x32_bf16 v[56:59], a[96:99], a[12:15], v[56:59]
  ds_read_b64_tr_b16 a[126:127], v7 offset:15552
  v_mfma_f32_16x16x32_bf16 v[20:23], a[100:103], a[8:11], v[20:23]
  ds_read_b64_tr_b16 a[128:129], v6 offset:10496
  buffer_load_dwordx4 a[60:63], v199, s[8:11], s36 offen offset:2048 sc1
  v_mfma_f32_16x16x32_bf16 v[60:63], a[100:103], a[12:15], v[60:63]
  ds_read_b64_tr_b16 a[130:131], v6 offset:15616
  s_waitcnt lgkmcnt(10)
  v_mfma_f32_16x16x32_bf16 v[24:27], a[104:107], a[8:11], v[24:27]
  ds_read_b64_tr_b16 a[132:133], v7 offset:10496
  s_add_u32 s36, s36, 4096
  s_add_u32 m0, s68, 102400
  v_mfma_f32_16x16x32_bf16 v[64:67], a[104:107], a[12:15], v[64:67]
  ds_read_b64_tr_b16 a[134:135], v7 offset:15616
  s_barrier
  v_mfma_f32_16x16x32_bf16 v[28:31], a[108:111], a[8:11], v[28:31]
  ds_read_b64_tr_b16 a[96:97], v6 offset:20480
  buffer_load_dwordx4 v200, s[56:59], s69 offen offset:0 lds
  v_mfma_f32_16x16x32_bf16 v[68:71], a[108:111], a[12:15], v[68:71]
  ds_read_b64_tr_b16 a[98:99], v6 offset:25600
  s_waitcnt lgkmcnt(10)
  v_mfma_f32_16x16x32_bf16 v[32:35], a[112:115], a[8:11], v[32:35]
  ds_read_b64_tr_b16 a[100:101], v7 offset:20480
  v_mfma_f32_16x16x32_bf16 v[72:75], a[112:115], a[12:15], v[72:75]
  ds_read_b64_tr_b16 a[102:103], v7 offset:25600
  v_mfma_f32_16x16x32_bf16 v[36:39], a[116:119], a[8:11], v[36:39]
  ds_read_b64_tr_b16 a[104:105], v6 offset:20544
  buffer_load_dwordx4 v201, s[56:59], s69 offen offset:1024 lds
  v_mfma_f32_16x16x32_bf16 v[76:79], a[116:119], a[12:15], v[76:79]
  ds_read_b64_tr_b16 a[106:107], v6 offset:25664
  s_waitcnt lgkmcnt(10)
  v_mfma_f32_16x16x32_bf16 v[40:43], a[120:123], a[8:11], v[40:43]
  ds_read_b64_tr_b16 a[108:109], v7 offset:20544
  v_mfma_f32_16x16x32_bf16 v[80:83], a[120:123], a[12:15], v[80:83]
  ds_read_b64_tr_b16 a[110:111], v7 offset:25664
  v_mfma_f32_16x16x32_bf16 v[44:47], a[124:127], a[8:11], v[44:47]
  ds_read_b64_tr_b16 a[112:113], v6 offset:20608
  buffer_load_dwordx4 v202, s[56:59], s69 offen offset:2048 lds
  v_mfma_f32_16x16x32_bf16 v[84:87], a[124:127], a[12:15], v[84:87]
  ds_read_b64_tr_b16 a[114:115], v6 offset:25728
  s_waitcnt lgkmcnt(10)
  v_mfma_f32_16x16x32_bf16 v[48:51], a[128:131], a[8:11], v[48:51]
  ds_read_b64_tr_b16 a[116:117], v7 offset:20608
  s_cbranch_vccnz re_p3w0x
re_p3w0b:
  v_mfma_f32_16x16x32_bf16 v[88:91], a[128:131], a[12:15], v[88:91]
  ds_read_b64_tr_b16 a[118:119], v7 offset:25728
  v_mfma_f32_16x16x32_bf16 v[52:55], a[132:135], a[8:11], v[52:55]
  ds_read_b64_tr_b16 a[120:121], v6 offset:20672
  buffer_load_dwordx4 v203, s[56:59], s69 offen offset:3072 lds
  v_mfma_f32_16x16x32_bf16 v[92:95], a[132:135], a[12:15], v[92:95]
  ds_read_b64_tr_b16 a[122:123], v6 offset:25792
  s_waitcnt vmcnt(23)
  s_waitcnt lgkmcnt(10)
  v_mfma_f32_16x16x32_bf16 v[16:19], a[96:99], a[16:19], v[16:19]
  ds_read_b64_tr_b16 a[124:125], v7 offset:20672
  v_mfma_f32_16x16x32_bf16 v[56:59], a[96:99], a[20:23], v[56:59]
  ds_read_b64_tr_b16 a[126:127], v7 offset:25792
  s_add_u32 m0, s68, 106496
  v_mfma_f32_16x16x32_bf16 v[20:23], a[100:103], a[16:19], v[20:23]
  ds_read_b64_tr_b16 a[128:129], v6 offset:20736
  v_mfma_f32_16x16x32_bf16 v[60:63], a[100:103], a[20:23], v[60:63]
  ds_read_b64_tr_b16 a[130:131], v6 offset:25856
  s_waitcnt lgkmcnt(10)
  v_mfma_f32_16x16x32_bf16 v[24:27], a[104:107], a[16:19], v[24:27]
  ds_read_b64_tr_b16 a[132:133], v7 offset:20736
  buffer_load_dwordx4 v204, s[56:59], s69 offen offset:0 lds
  v_mfma_f32_16x16x32_bf16 v[64:67], a[104:107], a[20:23], v[64:67]
  ds_read_b64_tr_b16 a[134:135], v7 offset:25856
  s_add_u32 s69, s69, 81920
  v_mfma_f32_16x16x32_bf16 v[28:31], a[108:111], a[16:19], v[28:31]
  ds_read_b64_tr_b16 a[96:97], v6 offset:30720
  v_mfma_f32_16x16x32_bf16 v[68:71], a[108:111], a[20:23], v[68:71]
  ds_read_b64_tr_b16 a[98:99], v6 offset:35840
  s_waitcnt lgkmcnt(10)
  v_mfma_f32_16x16x32_bf16 v[32:35], a[112:115], a[16:19], v[32:35]
  ds_read_b64_tr_b16 a[100:101], v7 offset:30720
  buffer_load_dwordx4 a[64:67], v198, s[8:11], s36 offen offset:0 sc1
  v_mfma_f32_16x16x32_bf16 v[72:75], a[112:115], a[20:23], v[72:75]
  ds_read_b64_tr_b16 a[102:103], v7 offset:35840
  v_mfma_f32_16x16x32_bf16 v[36:39], a[116:119], a[16:19], v[36:39]
  ds_read_b64_tr_b16 a[104:105], v6 offset:30784
  v_mfma_f32_16x16x32_bf16 v[76:79], a[116:119], a[20:23], v[76:79]
  ds_read_b64_tr_b16 a[106:107], v6 offset:35904
  s_waitcnt lgkmcnt(10)
  v_mfma_f32_16x16x32_bf16 v[40:43], a[120:123], a[16:19], v[40:43]
  ds_read_b64_tr_b16 a[108:109], v7 offset:30784
  v_mfma_f32_16x16x32_bf16 v[80:83], a[120:123], a[20:23], v[80:83]
  ds_read_b64_tr_b16 a[110:111], v7 offset:35904
  buffer_load_dwordx4 a[68:71], v199, s[8:11], s36 offen offset:0 sc1
  v_mfma_f32_16x16x32_bf16 v[44:47], a[124:127], a[16:19], v[44:47]
  ds_read_b64_tr_b16 a[112:113], v6 offset:30848
  v_mfma_f32_16x16x32_bf16 v[84:87], a[124:127], a[20:23], v[84:87]
  ds_read_b64_tr_b16 a[114:115], v6 offset:35968
  s_waitcnt lgkmcnt(10)
  v_mfma_f32_16x16x32_bf16 v[48:51], a[128:131], a[16:19], v[48:51]
  ds_read_b64_tr_b16 a[116:117], v7 offset:30848
  v_mfma_f32_16x16x32_bf16 v[88:91], a[128:131], a[20:23], v[88:91]
  ds_read_b64_tr_b16 a[118:119], v7 offset:35968
  buffer_load_dwordx4 a[72:75], v198, s[8:11], s36 offen offset:2048 sc1
  v_mfma_f32_16x16x32_bf16 v[52:55], a[132:135], a[16:19], v[52:55]
  ds_read_b64_tr_b16 a[120:121], v6 offset:30912
  v_mfma_f32_16x16x32_bf16 v[92:95], a[132:135], a[20:23], v[92:95]
  ds_read_b64_tr_b16 a[122:123], v6 offset:36032
  s_waitcnt lgkmcnt(10)
  v_mfma_f32_16x16x32_bf16 v[16:19], a[96:99], a[24:27], v[16:19]
  ds_read_b64_tr_b16 a[124:125], v7 offset:30912
  v_mfma_f32_16x16x32_bf16 v[56:59], a[96:99], a[28:31], v[56:59]
  ds_read_b64_tr_b16 a[126:127], v7 offset:36032
  v_mfma_f32_16x16x32_bf16 v[20:23], a[100:103], a[24:27], v[20:23]
  ds_read_b64_tr_b16 a[128:129], v6 offset:30976
  buffer_load_dwordx4 a[76:79], v199, s[8:11], s36 offen offset:2048 sc1
  v_mfma_f32_16x16x32_bf16 v[60:63], a[100:103], a[28:31], v[60:63]
  ds_read_b64_tr_b16 a[130:131], v6 offset:36096
  s_waitcnt lgkmcnt(10)
  v_mfma_f32_16x16x32_bf16 v[24:27], a[104:107], a[24:27], v[24:27]
  ds_read_b64_tr_b16 a[132:133], v7 offset:30976
  s_add_u32 s36, s36, 4096
  s_add_u32 m0, s68, 0
  v_mfma_f32_16x16x32_bf16 v[64:67], a[104:107], a[28:31], v[64:67]
  ds_read_b64_tr_b16 a[134:135], v7 offset:36096
  s_barrier
  v_mfma_f32_16x16x32_bf16 v[28:31], a[108:111], a[24:27], v[28:31]
  ds_read_b64_tr_b16 a[96:97], v6 offset:40960
  buffer_load_dwordx4 v200, s[56:59], s69 offen offset:0 lds
  v_mfma_f32_16x16x32_bf16 v[68:71], a[108:111], a[28:31], v[68:71]
  ds_read_b64_tr_b16 a[98:99], v6 offset:46080
  s_waitcnt lgkmcnt(10)
  v_mfma_f32_16x16x32_bf16 v[32:35], a[112:115], a[24:27], v[32:35]
  ds_read_b64_tr_b16 a[100:101], v7 offset:40960
  v_mfma_f32_16x16x32_bf16 v[72:75], a[112:115], a[28:31], v[72:75]
  ds_read_b64_tr_b16 a[102:103], v7 offset:46080
  v_mfma_f32_16x16x32_bf16 v[36:39], a[116:119], a[24:27], v[36:39]
  ds_read_b64_tr_b16 a[104:105], v6 offset:41024
  buffer_load_dwordx4 v201, s[56:59], s69 offen offset:1024 lds
  v_mfma_f32_16x16x32_bf16 v[76:79], a[116:119], a[28:31], v[76:79]
  ds_read_b64_tr_b16 a[106:107], v6 offset:46144
  s_waitcnt lgkmcnt(10)
  v_mfma_f32_16x16x32_bf16 v[40:43], a[120:123], a[24:27], v[40:43]
  ds_read_b64_tr_b16 a[108:109], v7 offset:41024
  v_mfma_f32_16x16x32_bf16 v[80:83], a[120:123], a[28:31], v[80:83]
  ds_read_b64_tr_b16 a[110:111], v7 offset:46144
  v_mfma_f32_16x16x32_bf16 v[44:47], a[124:127], a[24:27], v[44:47]
  ds_read_b64_tr_b16 a[112:113], v6 offset:41088
  buffer_load_dwordx4 v202, s[56:59], s69 offen offset:2048 lds
  v_mfma_f32_16x16x32_bf16 v[84:87], a[124:127], a[28:31], v[84:87]
  ds_read_b64_tr_b16 a[114:115], v6 offset:46208
  s_waitcnt lgkmcnt(10)
  v_mfma_f32_16x16x32_bf16 v[48:51], a[128:131], a[24:27], v[48:51]
  ds_read_b64_tr_b16 a[116:117], v7 offset:41088
  v_mfma_f32_16x16x32_bf16 v[88:91], a[128:131], a[28:31], v[88:91]
  ds_read_b64_tr_b16 a[118:119], v7 offset:46208
  v_mfma_f32_16x16x32_bf16 v[52:55], a[132:135], a[24:27], v[52:55]
  ds_read_b64_tr_b16 a[120:121], v6 offset:41152
  buffer_load_dwordx4 v203, s[56:59], s69 offen offset:3072 lds
  v_mfma_f32_16x16x32_bf16 v[92:95], a[132:135], a[28:31], v[92:95]
  ds_read_b64_tr_b16 a[122:123], v6 offset:46272
  s_waitcnt vmcnt(22)
  s_waitcnt lgkmcnt(10)
  v_mfma_f32_16x16x32_bf16 v[16:19], a[96:99], a[32:35], v[16:19]
  ds_read_b64_tr_b16 a[124:125], v7 offset:41152
  v_mfma_f32_16x16x32_bf16 v[56:59], a[96:99], a[36:39], v[56:59]
  ds_read_b64_tr_b16 a[126:127], v7 offset:46272
  s_add_u32 m0, s68, 4096
  v_mfma_f32_16x16x32_bf16 v[20:23], a[100:103], a[32:35], v[20:23]
  ds_read_b64_tr_b16 a[128:129], v6 offset:41216
  v_mfma_f32_16x16x32_bf16 v[60:63], a[100:103], a[36:39], v[60:63]
  ds_read_b64_tr_b16 a[130:131], v6 offset:46336
  s_waitcnt lgkmcnt(10)
  v_mfma_f32_16x16x32_bf16 v[24:27], a[104:107], a[32:35], v[24:27]
  ds_read_b64_tr_b16 a[132:133], v7 offset:41216
  buffer_load_dwordx4 v204, s[56:59], s69 offen offset:0 lds
  v_mfma_f32_16x16x32_bf16 v[64:67], a[104:107], a[36:39], v[64:67]
  ds_read_b64_tr_b16 a[134:135], v7 offset:46336
  s_add_u32 s69, s69, 81920
  v_mfma_f32_16x16x32_bf16 v[28:31], a[108:111], a[32:35], v[28:31]
  ds_read_b64_tr_b16 a[96:97], v6 offset:51200
  v_mfma_f32_16x16x32_bf16 v[68:71], a[108:111], a[36:39], v[68:71]
  ds_read_b64_tr_b16 a[98:99], v6 offset:56320
  s_waitcnt lgkmcnt(10)
  v_mfma_f32_16x16x32_bf16 v[32:35], a[112:115], a[32:35], v[32:35]
  ds_read_b64_tr_b16 a[100:101], v7 offset:51200
  buffer_load_dwordx4 a[80:83], v198, s[8:11], s36 offen offset:0 sc1
  v_mfma_f32_16x16x32_bf16 v[72:75], a[112:115], a[36:39], v[72:75]
  ds_read_b64_tr_b16 a[102:103], v7 offset:56320
  v_mfma_f32_16x16x32_bf16 v[36:39], a[116:119], a[32:35], v[36:39]
  ds_read_b64_tr_b16 a[104:105], v6 offset:51264
  v_mfma_f32_16x16x32_bf16 v[76:79], a[116:119], a[36:39], v[76:79]
  ds_read_b64_tr_b16 a[106:107], v6 offset:56384
  s_waitcnt lgkmcnt(10)
  v_mfma_f32_16x16x32_bf16 v[40:43], a[120:123], a[32:35], v[40:43]
  ds_read_b64_tr_b16 a[108:109], v7 offset:51264
  v_mfma_f32_16x16x32_bf16 v[80:83], a[120:123], a[36:39], v[80:83]
  ds_read_b64_tr_b16 a[110:111], v7 offset:56384
  buffer_load_dwordx4 a[84:87], v199, s[8:11], s36 offen offset:0 sc1
  v_mfma_f32_16x16x32_bf16 v[44:47], a[124:127], a[32:35], v[44:47]
  ds_read_b64_tr_b16 a[112:113], v6 offset:51328
  v_mfma_f32_16x16x32_bf16 v[84:87], a[124:127], a[36:39], v[84:87]
  ds_read_b64_tr_b16 a[114:115], v6 offset:56448
  s_waitcnt lgkmcnt(10)
  v_mfma_f32_16x16x32_bf16 v[48:51], a[128:131], a[32:35], v[48:51]
  ds_read_b64_tr_b16 a[116:117], v7 offset:51328
  v_mfma_f32_16x16x32_bf16 v[88:91], a[128:131], a[36:39], v[88:91]
  ds_read_b64_tr_b16 a[118:119], v7 offset:56448
  buffer_load_dwordx4 a[88:91], v198, s[8:11], s36 offen offset:2048 sc1
  v_mfma_f32_16x16x32_bf16 v[52:55], a[132:135], a[32:35], v[52:55]
  ds_read_b64_tr_b16 a[120:121], v6 offset:51392
  v_mfma_f32_16x16x32_bf16 v[92:95], a[132:135], a[36:39], v[92:95]
  ds_read_b64_tr_b16 a[122:123], v6 offset:56512
  s_waitcnt lgkmcnt(10)
  v_mfma_f32_16x16x32_bf16 v[16:19], a[96:99], a[40:43], v[16:19]
  ds_read_b64_tr_b16 a[124:125], v7 offset:51392
  v_mfma_f32_16x16x32_bf16 v[56:59], a[96:99], a[44:47], v[56:59]
  ds_read_b64_tr_b16 a[126:127], v7 offset:56512
  v_mfma_f32_16x16x32_bf16 v[20:23], a[100:103], a[40:43], v[20:23]
  ds_read_b64_tr_b16 a[128:129], v6 offset:51456
  buffer_load_dwordx4 a[92:95], v199, s[8:11], s36 offen offset:2048 sc1
  v_mfma_f32_16x16x32_bf16 v[60:63], a[100:103], a[44:47], v[60:63]
  ds_read_b64_tr_b16 a[130:131], v6 offset:56576
  s_waitcnt lgkmcnt(10)
  v_mfma_f32_16x16x32_bf16 v[24:27], a[104:107], a[40:43], v[24:27]
  ds_read_b64_tr_b16 a[132:133], v7 offset:51456
  s_add_u32 s36, s36, 4096
  s_add_u32 m0, s68, 20480
  v_mfma_f32_16x16x32_bf16 v[64:67], a[104:107], a[44:47], v[64:67]
  ds_read_b64_tr_b16 a[134:135], v7 offset:56576
  s_barrier
  v_mfma_f32_16x16x32_bf16 v[28:31], a[108:111], a[40:43], v[28:31]
  ds_read_b64_tr_b16 a[96:97], v8 offset:0
  buffer_load_dwordx4 v200, s[56:59], s69 offen offset:0 lds
  v_mfma_f32_16x16x32_bf16 v[68:71], a[108:111], a[44:47], v[68:71]
  ds_read_b64_tr_b16 a[98:99], v8 offset:5120
  s_waitcnt lgkmcnt(10)
  v_mfma_f32_16x16x32_bf16 v[32:35], a[112:115], a[40:43], v[32:35]
  ds_read_b64_tr_b16 a[100:101], v9 offset:0
  v_mfma_f32_16x16x32_bf16 v[72:75], a[112:115], a[44:47], v[72:75]
  ds_read_b64_tr_b16 a[102:103], v9 offset:5120
  v_mfma_f32_16x16x32_bf16 v[36:39], a[116:119], a[40:43], v[36:39]
  ds_read_b64_tr_b16 a[104:105], v8 offset:64
  buffer_load_dwordx4 v201, s[56:59], s69 offen offset:1024 lds
  v_mfma_f32_16x16x32_bf16 v[76:79], a[116:119], a[44:47], v[76:79]
  ds_read_b64_tr_b16 a[106:107], v8 offset:5184
  s_waitcnt lgkmcnt(10)
  v_mfma_f32_16x16x32_bf16 v[40:43], a[120:123], a[40:43], v[40:43]
  ds_read_b64_tr_b16 a[108:109], v9 offset:64
  v_mfma_f32_16x16x32_bf16 v[80:83], a[120:123], a[44:47], v[80:83]
  ds_read_b64_tr_b16 a[110:111], v9 offset:5184
  v_mfma_f32_16x16x32_bf16 v[44:47], a[124:127], a[40:43], v[44:47]
  ds_read_b64_tr_b16 a[112:113], v8 offset:128
  buffer_load_dwordx4 v202, s[56:59], s69 offen offset:2048 lds
  v_mfma_f32_16x16x32_bf16 v[84:87], a[124:127], a[44:47], v[84:87]
  ds_read_b64_tr_b16 a[114:115], v8 offset:5248
  s_waitcnt lgkmcnt(10)
  v_mfma_f32_16x16x32_bf16 v[48:51], a[128:131], a[40:43], v[48:51]
  ds_read_b64_tr_b16 a[116:117], v9 offset:128
  v_mfma_f32_16x16x32_bf16 v[88:91], a[128:131], a[44:47], v[88:91]
  ds_read_b64_tr_b16 a[118:119], v9 offset:5248
  v_mfma_f32_16x16x32_bf16 v[52:55], a[132:135], a[40:43], v[52:55]
  ds_read_b64_tr_b16 a[120:121], v8 offset:192
  buffer_load_dwordx4 v203, s[56:59], s69 offen offset:3072 lds
  v_mfma_f32_16x16x32_bf16 v[92:95], a[132:135], a[44:47], v[92:95]
  ds_read_b64_tr_b16 a[122:123], v8 offset:5312
  s_waitcnt vmcnt(22)
  s_waitcnt lgkmcnt(10)
  v_mfma_f32_16x16x32_bf16 v[16:19], a[96:99], a[48:51], v[16:19]
  ds_read_b64_tr_b16 a[124:125], v9 offset:192
  v_mfma_f32_16x16x32_bf16 v[56:59], a[96:99], a[52:55], v[56:59]
  ds_read_b64_tr_b16 a[126:127], v9 offset:5312
  s_add_u32 m0, s68, 24576
  v_mfma_f32_16x16x32_bf16 v[20:23], a[100:103], a[48:51], v[20:23]
  ds_read_b64_tr_b16 a[128:129], v8 offset:256
  v_mfma_f32_16x16x32_bf16 v[60:63], a[100:103], a[52:55], v[60:63]
  ds_read_b64_tr_b16 a[130:131], v8 offset:5376
  s_waitcnt lgkmcnt(10)
  v_mfma_f32_16x16x32_bf16 v[24:27], a[104:107], a[48:51], v[24:27]
  ds_read_b64_tr_b16 a[132:133], v9 offset:256
  buffer_load_dwordx4 v204, s[56:59], s69 offen offset:0 lds
  v_mfma_f32_16x16x32_bf16 v[64:67], a[104:107], a[52:55], v[64:67]
  ds_read_b64_tr_b16 a[134:135], v9 offset:5376
  s_add_u32 s69, s69, 81920
  v_mfma_f32_16x16x32_bf16 v[28:31], a[108:111], a[48:51], v[28:31]
  ds_read_b64_tr_b16 a[96:97], v8 offset:10240
  v_mfma_f32_16x16x32_bf16 v[68:71], a[108:111], a[52:55], v[68:71]
  ds_read_b64_tr_b16 a[98:99], v8 offset:15360
  s_waitcnt lgkmcnt(10)
  v_mfma_f32_16x16x32_bf16 v[32:35], a[112:115], a[48:51], v[32:35]
  ds_read_b64_tr_b16 a[100:101], v9 offset:10240
  buffer_load_dwordx4 a[0:3], v198, s[8:11], s36 offen offset:0 sc1
  v_mfma_f32_16x16x32_bf16 v[72:75], a[112:115], a[52:55], v[72:75]
  ds_read_b64_tr_b16 a[102:103], v9 offset:15360
  v_mfma_f32_16x16x32_bf16 v[36:39], a[116:119], a[48:51], v[36:39]
  ds_read_b64_tr_b16 a[104:105], v8 offset:10304
  v_mfma_f32_16x16x32_bf16 v[76:79], a[116:119], a[52:55], v[76:79]
  ds_read_b64_tr_b16 a[106:107], v8 offset:15424
  buffer_load_dword v197, v1, s[76:79], s48 offen sc1
  s_waitcnt lgkmcnt(10)
  v_mfma_f32_16x16x32_bf16 v[40:43], a[120:123], a[48:51], v[40:43]
  ds_read_b64_tr_b16 a[108:109], v9 offset:10304
  v_mfma_f32_16x16x32_bf16 v[80:83], a[120:123], a[52:55], v[80:83]
  ds_read_b64_tr_b16 a[110:111], v9 offset:15424
  buffer_load_dwordx4 a[4:7], v199, s[8:11], s36 offen offset:0 sc1
  v_mfma_f32_16x16x32_bf16 v[44:47], a[124:127], a[48:51], v[44:47]
  ds_read_b64_tr_b16 a[112:113], v8 offset:10368
  v_mfma_f32_16x16x32_bf16 v[84:87], a[124:127], a[52:55], v[84:87]
  ds_read_b64_tr_b16 a[114:115], v8 offset:15488
  s_waitcnt lgkmcnt(10)
  v_mfma_f32_16x16x32_bf16 v[48:51], a[128:131], a[48:51], v[48:51]
  ds_read_b64_tr_b16 a[116:117], v9 offset:10368
  v_mfma_f32_16x16x32_bf16 v[88:91], a[128:131], a[52:55], v[88:91]
  ds_read_b64_tr_b16 a[118:119], v9 offset:15488
  buffer_load_dwordx4 a[8:11], v198, s[8:11], s36 offen offset:2048 sc1
  v_mfma_f32_16x16x32_bf16 v[52:55], a[132:135], a[48:51], v[52:55]
  ds_read_b64_tr_b16 a[120:121], v8 offset:10432
  v_mfma_f32_16x16x32_bf16 v[92:95], a[132:135], a[52:55], v[92:95]
  ds_read_b64_tr_b16 a[122:123], v8 offset:15552
  s_waitcnt lgkmcnt(10)
  v_mfma_f32_16x16x32_bf16 v[16:19], a[96:99], a[56:59], v[16:19]
  ds_read_b64_tr_b16 a[124:125], v9 offset:10432
  v_mfma_f32_16x16x32_bf16 v[56:59], a[96:99], a[60:63], v[56:59]
  ds_read_b64_tr_b16 a[126:127], v9 offset:15552
  v_mfma_f32_16x16x32_bf16 v[20:23], a[100:103], a[56:59], v[20:23]
  ds_read_b64_tr_b16 a[128:129], v8 offset:10496
  buffer_load_dwordx4 a[12:15], v199, s[8:11], s36 offen offset:2048 sc1
  v_mfma_f32_16x16x32_bf16 v[60:63], a[100:103], a[60:63], v[60:63]
  ds_read_b64_tr_b16 a[130:131], v8 offset:15616
  s_waitcnt lgkmcnt(10)
  v_mfma_f32_16x16x32_bf16 v[24:27], a[104:107], a[56:59], v[24:27]
  ds_read_b64_tr_b16 a[132:133], v9 offset:10496
  s_add_u32 s36, s36, 4096
  s_add_u32 m0, s68, 40960
  v_mfma_f32_16x16x32_bf16 v[64:67], a[104:107], a[60:63], v[64:67]
  ds_read_b64_tr_b16 a[134:135], v9 offset:15616
  s_barrier
  v_mfma_f32_16x16x32_bf16 v[28:31], a[108:111], a[56:59], v[28:31]
  ds_read_b64_tr_b16 a[96:97], v8 offset:20480
  buffer_load_dwordx4 v200, s[56:59], s69 offen offset:0 lds
  v_mfma_f32_16x16x32_bf16 v[68:71], a[108:111], a[60:63], v[68:71]
  ds_read_b64_tr_b16 a[98:99], v8 offset:25600
  s_waitcnt lgkmcnt(10)
  v_mfma_f32_16x16x32_bf16 v[32:35], a[112:115], a[56:59], v[32:35]
  ds_read_b64_tr_b16 a[100:101], v9 offset:20480
  v_mfma_f32_16x16x32_bf16 v[72:75], a[112:115], a[60:63], v[72:75]
  ds_read_b64_tr_b16 a[102:103], v9 offset:25600
  v_mfma_f32_16x16x32_bf16 v[36:39], a[116:119], a[56:59], v[36:39]
  ds_read_b64_tr_b16 a[104:105], v8 offset:20544
  buffer_load_dwordx4 v201, s[56:59], s69 offen offset:1024 lds
  v_mfma_f32_16x16x32_bf16 v[76:79], a[116:119], a[60:63], v[76:79]
  ds_read_b64_tr_b16 a[106:107], v8 offset:25664
  s_waitcnt lgkmcnt(10)
  v_mfma_f32_16x16x32_bf16 v[40:43], a[120:123], a[56:59], v[40:43]
  ds_read_b64_tr_b16 a[108:109], v9 offset:20544
  v_mfma_f32_16x16x32_bf16 v[80:83], a[120:123], a[60:63], v[80:83]
  ds_read_b64_tr_b16 a[110:111], v9 offset:25664
  v_mfma_f32_16x16x32_bf16 v[44:47], a[124:127], a[56:59], v[44:47]
  ds_read_b64_tr_b16 a[112:113], v8 offset:20608
  buffer_load_dwordx4 v202, s[56:59], s69 offen offset:2048 lds
  v_mfma_f32_16x16x32_bf16 v[84:87], a[124:127], a[60:63], v[84:87]
  ds_read_b64_tr_b16 a[114:115], v8 offset:25728
  s_waitcnt lgkmcnt(10)
  v_mfma_f32_16x16x32_bf16 v[48:51], a[128:131], a[56:59], v[48:51]
  ds_read_b64_tr_b16 a[116:117], v9 offset:20608
  v_mfma_f32_16x16x32_bf16 v[88:91], a[128:131], a[60:63], v[88:91]
  ds_read_b64_tr_b16 a[118:119], v9 offset:25728
  v_mfma_f32_16x16x32_bf16 v[52:55], a[132:135], a[56:59], v[52:55]
  ds_read_b64_tr_b16 a[120:121], v8 offset:20672
  buffer_load_dwordx4 v203, s[56:59], s69 offen offset:3072 lds
  v_mfma_f32_16x16x32_bf16 v[92:95], a[132:135], a[60:63], v[92:95]
  ds_read_b64_tr_b16 a[122:123], v8 offset:25792
  s_waitcnt vmcnt(23)
  s_waitcnt lgkmcnt(10)
  v_mfma_f32_16x16x32_bf16 v[16:19], a[96:99], a[64:67], v[16:19]
  ds_read_b64_tr_b16 a[124:125], v9 offset:20672
  v_mfma_f32_16x16x32_bf16 v[56:59], a[96:99], a[68:71], v[56:59]
  ds_read_b64_tr_b16 a[126:127], v9 offset:25792
  s_add_u32 m0, s68, 45056
  v_mfma_f32_16x16x32_bf16 v[20:23], a[100:103], a[64:67], v[20:23]
  ds_read_b64_tr_b16 a[128:129], v8 offset:20736
  v_mfma_f32_16x16x32_bf16 v[60:63], a[100:103], a[68:71], v[60:63]
  ds_read_b64_tr_b16 a[130:131], v8 offset:25856
  s_waitcnt lgkmcnt(10)
  v_mfma_f32_16x16x32_bf16 v[24:27], a[104:107], a[64:67], v[24:27]
  ds_read_b64_tr_b16 a[132:133], v9 offset:20736
  buffer_load_dwordx4 v204, s[56:59], s69 offen offset:0 lds
  v_mfma_f32_16x16x32_bf16 v[64:67], a[104:107], a[68:71], v[64:67]
  ds_read_b64_tr_b16 a[134:135], v9 offset:25856
  s_add_u32 s69, s69, 81920
  v_mfma_f32_16x16x32_bf16 v[28:31], a[108:111], a[64:67], v[28:31]
  ds_read_b64_tr_b16 a[96:97], v8 offset:30720
  v_mfma_f32_16x16x32_bf16 v[68:71], a[108:111], a[68:71], v[68:71]
  ds_read_b64_tr_b16 a[98:99], v8 offset:35840
  s_waitcnt lgkmcnt(10)
  v_mfma_f32_16x16x32_bf16 v[32:35], a[112:115], a[64:67], v[32:35]
  ds_read_b64_tr_b16 a[100:101], v9 offset:30720
  buffer_load_dwordx4 a[16:19], v198, s[8:11], s36 offen offset:0 sc1
  v_mfma_f32_16x16x32_bf16 v[72:75], a[112:115], a[68:71], v[72:75]
  ds_read_b64_tr_b16 a[102:103], v9 offset:35840
  v_mfma_f32_16x16x32_bf16 v[36:39], a[116:119], a[64:67], v[36:39]
  ds_read_b64_tr_b16 a[104:105], v8 offset:30784
  v_mfma_f32_16x16x32_bf16 v[76:79], a[116:119], a[68:71], v[76:79]
  ds_read_b64_tr_b16 a[106:107], v8 offset:35904
  s_waitcnt lgkmcnt(10)
  v_mfma_f32_16x16x32_bf16 v[40:43], a[120:123], a[64:67], v[40:43]
  ds_read_b64_tr_b16 a[108:109], v9 offset:30784
  v_mfma_f32_16x16x32_bf16 v[80:83], a[120:123], a[68:71], v[80:83]
  ds_read_b64_tr_b16 a[110:111], v9 offset:35904
  buffer_load_dwordx4 a[20:23], v199, s[8:11], s36 offen offset:0 sc1
  v_mfma_f32_16x16x32_bf16 v[44:47], a[124:127], a[64:67], v[44:47]
  ds_read_b64_tr_b16 a[112:113], v8 offset:30848
  v_mfma_f32_16x16x32_bf16 v[84:87], a[124:127], a[68:71], v[84:87]
  ds_read_b64_tr_b16 a[114:115], v8 offset:35968
  s_waitcnt lgkmcnt(10)
  v_mfma_f32_16x16x32_bf16 v[48:51], a[128:131], a[64:67], v[48:51]
  ds_read_b64_tr_b16 a[116:117], v9 offset:30848
  v_mfma_f32_16x16x32_bf16 v[88:91], a[128:131], a[68:71], v[88:91]
  ds_read_b64_tr_b16 a[118:119], v9 offset:35968
  buffer_load_dwordx4 a[24:27], v198, s[8:11], s36 offen offset:2048 sc1
  v_mfma_f32_16x16x32_bf16 v[52:55], a[132:135], a[64:67], v[52:55]
  ds_read_b64_tr_b16 a[120:121], v8 offset:30912
  v_mfma_f32_16x16x32_bf16 v[92:95], a[132:135], a[68:71], v[92:95]
  ds_read_b64_tr_b16 a[122:123], v8 offset:36032
  s_waitcnt lgkmcnt(10)
  v_mfma_f32_16x16x32_bf16 v[16:19], a[96:99], a[72:75], v[16:19]
  ds_read_b64_tr_b16 a[124:125], v9 offset:30912
  v_mfma_f32_16x16x32_bf16 v[56:59], a[96:99], a[76:79], v[56:59]
  ds_read_b64_tr_b16 a[126:127], v9 offset:36032
  v_mfma_f32_16x16x32_bf16 v[20:23], a[100:103], a[72:75], v[20:23]
  ds_read_b64_tr_b16 a[128:129], v8 offset:30976
  buffer_load_dwordx4 a[28:31], v199, s[8:11], s36 offen offset:2048 sc1
  v_mfma_f32_16x16x32_bf16 v[60:63], a[100:103], a[76:79], v[60:63]
  ds_read_b64_tr_b16 a[130:131], v8 offset:36096
  s_waitcnt lgkmcnt(10)
  v_mfma_f32_16x16x32_bf16 v[24:27], a[104:107], a[72:75], v[24:27]
  ds_read_b64_tr_b16 a[132:133], v9 offset:30976
  s_add_u32 s36, s36, 4096
  s_add_u32 m0, s68, 61440
  v_mfma_f32_16x16x32_bf16 v[64:67], a[104:107], a[76:79], v[64:67]
  ds_read_b64_tr_b16 a[134:135], v9 offset:36096
  s_barrier
  v_mfma_f32_16x16x32_bf16 v[28:31], a[108:111], a[72:75], v[28:31]
  ds_read_b64_tr_b16 a[96:97], v8 offset:40960
  buffer_load_dwordx4 v200, s[56:59], s69 offen offset:0 lds
  v_mfma_f32_16x16x32_bf16 v[68:71], a[108:111], a[76:79], v[68:71]
  ds_read_b64_tr_b16 a[98:99], v8 offset:46080
  s_waitcnt lgkmcnt(10)
  v_mfma_f32_16x16x32_bf16 v[32:35], a[112:115], a[72:75], v[32:35]
  ds_read_b64_tr_b16 a[100:101], v9 offset:40960
  v_mfma_f32_16x16x32_bf16 v[72:75], a[112:115], a[76:79], v[72:75]
  ds_read_b64_tr_b16 a[102:103], v9 offset:46080
  v_mfma_f32_16x16x32_bf16 v[36:39], a[116:119], a[72:75], v[36:39]
  ds_read_b64_tr_b16 a[104:105], v8 offset:41024
  buffer_load_dwordx4 v201, s[56:59], s69 offen offset:1024 lds
  v_mfma_f32_16x16x32_bf16 v[76:79], a[116:119], a[76:79], v[76:79]
  ds_read_b64_tr_b16 a[106:107], v8 offset:46144
  s_waitcnt lgkmcnt(10)
  v_mfma_f32_16x16x32_bf16 v[40:43], a[120:123], a[72:75], v[40:43]
  ds_read_b64_tr_b16 a[108:109], v9 offset:41024
  v_mfma_f32_16x16x32_bf16 v[80:83], a[120:123], a[76:79], v[80:83]
  ds_read_b64_tr_b16 a[110:111], v9 offset:46144
  v_mfma_f32_16x16x32_bf16 v[44:47], a[124:127], a[72:75], v[44:47]
  ds_read_b64_tr_b16 a[112:113], v8 offset:41088
  buffer_load_dwordx4 v202, s[56:59], s69 offen offset:2048 lds
  v_mfma_f32_16x16x32_bf16 v[84:87], a[124:127], a[76:79], v[84:87]
  ds_read_b64_tr_b16 a[114:115], v8 offset:46208
  s_waitcnt lgkmcnt(10)
  v_mfma_f32_16x16x32_bf16 v[48:51], a[128:131], a[72:75], v[48:51]
  ds_read_b64_tr_b16 a[116:117], v9 offset:41088
  v_mfma_f32_16x16x32_bf16 v[88:91], a[128:131], a[76:79], v[88:91]
  ds_read_b64_tr_b16 a[118:119], v9 offset:46208
  v_mfma_f32_16x16x32_bf16 v[52:55], a[132:135], a[72:75], v[52:55]
  ds_read_b64_tr_b16 a[120:121], v8 offset:41152
  buffer_load_dwordx4 v203, s[56:59], s69 offen offset:3072 lds
  v_mfma_f32_16x16x32_bf16 v[92:95], a[132:135], a[76:79], v[92:95]
  ds_read_b64_tr_b16 a[122:123], v8 offset:46272
  s_waitcnt vmcnt(23)
  s_waitcnt lgkmcnt(10)
  v_mfma_f32_16x16x32_bf16 v[16:19], a[96:99], a[80:83], v[16:19]
  ds_read_b64_tr_b16 a[124:125], v9 offset:41152
  v_mfma_f32_16x16x32_bf16 v[56:59], a[96:99], a[84:87], v[56:59]
  ds_read_b64_tr_b16 a[126:127], v9 offset:46272
  s_add_u32 m0, s68, 65536
  v_mfma_f32_16x16x32_bf16 v[20:23], a[100:103], a[80:83], v[20:23]
  ds_read_b64_tr_b16 a[128:129], v8 offset:41216
  v_mfma_f32_16x16x32_bf16 v[60:63], a[100:103], a[84:87], v[60:63]
  ds_read_b64_tr_b16 a[130:131], v8 offset:46336
  s_waitcnt lgkmcnt(10)
  v_mfma_f32_16x16x32_bf16 v[24:27], a[104:107], a[80:83], v[24:27]
  ds_read_b64_tr_b16 a[132:133], v9 offset:41216
  buffer_load_dwordx4 v204, s[56:59], s69 offen offset:0 lds
  v_mfma_f32_16x16x32_bf16 v[64:67], a[104:107], a[84:87], v[64:67]
  ds_read_b64_tr_b16 a[134:135], v9 offset:46336
  s_add_u32 s69, s69, 81920
  v_mfma_f32_16x16x32_bf16 v[28:31], a[108:111], a[80:83], v[28:31]
  ds_read_b64_tr_b16 a[96:97], v8 offset:51200
  v_mfma_f32_16x16x32_bf16 v[68:71], a[108:111], a[84:87], v[68:71]
  ds_read_b64_tr_b16 a[98:99], v8 offset:56320
  s_waitcnt lgkmcnt(10)
  v_mfma_f32_16x16x32_bf16 v[32:35], a[112:115], a[80:83], v[32:35]
  ds_read_b64_tr_b16 a[100:101], v9 offset:51200
  buffer_load_dwordx4 a[32:35], v198, s[8:11], s36 offen offset:0 sc1
  v_mfma_f32_16x16x32_bf16 v[72:75], a[112:115], a[84:87], v[72:75]
  ds_read_b64_tr_b16 a[102:103], v9 offset:56320
  v_mfma_f32_16x16x32_bf16 v[36:39], a[116:119], a[80:83], v[36:39]
  ds_read_b64_tr_b16 a[104:105], v8 offset:51264
  v_mfma_f32_16x16x32_bf16 v[76:79], a[116:119], a[84:87], v[76:79]
  ds_read_b64_tr_b16 a[106:107], v8 offset:56384
  s_waitcnt lgkmcnt(10)
  v_mfma_f32_16x16x32_bf16 v[40:43], a[120:123], a[80:83], v[40:43]
  ds_read_b64_tr_b16 a[108:109], v9 offset:51264
  buffer_store_dword v5, v207, s[76:79], s49 offen sc1
  v_mfma_f32_16x16x32_bf16 v[80:83], a[120:123], a[84:87], v[80:83]
  ds_read_b64_tr_b16 a[110:111], v9 offset:56384
  buffer_load_dwordx4 a[36:39], v199, s[8:11], s36 offen offset:0 sc1
  v_mfma_f32_16x16x32_bf16 v[44:47], a[124:127], a[80:83], v[44:47]
  ds_read_b64_tr_b16 a[112:113], v8 offset:51328
  v_mfma_f32_16x16x32_bf16 v[84:87], a[124:127], a[84:87], v[84:87]
  ds_read_b64_tr_b16 a[114:115], v8 offset:56448
  s_waitcnt lgkmcnt(10)
  v_mfma_f32_16x16x32_bf16 v[48:51], a[128:131], a[80:83], v[48:51]
  ds_read_b64_tr_b16 a[116:117], v9 offset:51328
  v_mfma_f32_16x16x32_bf16 v[88:91], a[128:131], a[84:87], v[88:91]
  ds_read_b64_tr_b16 a[118:119], v9 offset:56448
  buffer_load_dwordx4 a[40:43], v198, s[8:11], s36 offen offset:2048 sc1
  v_mfma_f32_16x16x32_bf16 v[52:55], a[132:135], a[80:83], v[52:55]
  ds_read_b64_tr_b16 a[120:121], v8 offset:51392
  v_mfma_f32_16x16x32_bf16 v[92:95], a[132:135], a[84:87], v[92:95]
  ds_read_b64_tr_b16 a[122:123], v8 offset:56512
  s_waitcnt lgkmcnt(10)
  v_mfma_f32_16x16x32_bf16 v[16:19], a[96:99], a[88:91], v[16:19]
  ds_read_b64_tr_b16 a[124:125], v9 offset:51392
  v_mfma_f32_16x16x32_bf16 v[56:59], a[96:99], a[92:95], v[56:59]
  ds_read_b64_tr_b16 a[126:127], v9 offset:56512
  v_mfma_f32_16x16x32_bf16 v[20:23], a[100:103], a[88:91], v[20:23]
  ds_read_b64_tr_b16 a[128:129], v8 offset:51456
  buffer_load_dwordx4 a[44:47], v199, s[8:11], s36 offen offset:2048 sc1
  v_mfma_f32_16x16x32_bf16 v[60:63], a[100:103], a[92:95], v[60:63]
  ds_read_b64_tr_b16 a[130:131], v8 offset:56576
  s_waitcnt lgkmcnt(10)
  v_mfma_f32_16x16x32_bf16 v[24:27], a[104:107], a[88:91], v[24:27]
  ds_read_b64_tr_b16 a[132:133], v9 offset:51456
  s_add_u32 s36, s36, 4096
  s_add_u32 m0, s68, 81920
  v_mfma_f32_16x16x32_bf16 v[64:67], a[104:107], a[92:95], v[64:67]
  ds_read_b64_tr_b16 a[134:135], v9 offset:56576
  s_barrier
  v_mfma_f32_16x16x32_bf16 v[28:31], a[108:111], a[88:91], v[28:31]
  ds_read_b64_tr_b16 a[96:97], v6 offset:0
  buffer_load_dwordx4 v200, s[56:59], s69 offen offset:0 lds
  v_mfma_f32_16x16x32_bf16 v[68:71], a[108:111], a[92:95], v[68:71]
  ds_read_b64_tr_b16 a[98:99], v6 offset:5120
  s_waitcnt lgkmcnt(10)
  v_mfma_f32_16x16x32_bf16 v[32:35], a[112:115], a[88:91], v[32:35]
  ds_read_b64_tr_b16 a[100:101], v7 offset:0
  v_mfma_f32_16x16x32_bf16 v[72:75], a[112:115], a[92:95], v[72:75]
  ds_read_b64_tr_b16 a[102:103], v7 offset:5120
  v_mfma_f32_16x16x32_bf16 v[36:39], a[116:119], a[88:91], v[36:39]
  ds_read_b64_tr_b16 a[104:105], v6 offset:64
  buffer_load_dwordx4 v201, s[56:59], s69 offen offset:1024 lds
  v_mfma_f32_16x16x32_bf16 v[76:79], a[116:119], a[92:95], v[76:79]
  ds_read_b64_tr_b16 a[106:107], v6 offset:5184
  s_waitcnt lgkmcnt(10)
  v_mfma_f32_16x16x32_bf16 v[40:43], a[120:123], a[88:91], v[40:43]
  ds_read_b64_tr_b16 a[108:109], v7 offset:64
  s_add_u32 s39, s39, 1
  v_mfma_f32_16x16x32_bf16 v[80:83], a[120:123], a[92:95], v[80:83]
  ds_read_b64_tr_b16 a[110:111], v7 offset:5184
  v_mfma_f32_16x16x32_bf16 v[44:47], a[124:127], a[88:91], v[44:47]
  ds_read_b64_tr_b16 a[112:113], v6 offset:128
  buffer_load_dwordx4 v202, s[56:59], s69 offen offset:2048 lds
  v_mfma_f32_16x16x32_bf16 v[84:87], a[124:127], a[92:95], v[84:87]
  ds_read_b64_tr_b16 a[114:115], v6 offset:5248
  s_waitcnt lgkmcnt(10)
  v_mfma_f32_16x16x32_bf16 v[48:51], a[128:131], a[88:91], v[48:51]
  ds_read_b64_tr_b16 a[116:117], v7 offset:128
  v_mfma_f32_16x16x32_bf16 v[88:91], a[128:131], a[92:95], v[88:91]
  ds_read_b64_tr_b16 a[118:119], v7 offset:5248
  s_cmp_lt_u32 s39, 3
  v_mfma_f32_16x16x32_bf16 v[52:55], a[132:135], a[88:91], v[52:55]
  ds_read_b64_tr_b16 a[120:121], v6 offset:192
  buffer_load_dwordx4 v203, s[56:59], s69 offen offset:3072 lds
  v_mfma_f32_16x16x32_bf16 v[92:95], a[132:135], a[92:95], v[92:95]
  ds_read_b64_tr_b16 a[122:123], v6 offset:5312
  s_waitcnt vmcnt(23)
  s_waitcnt lgkmcnt(10)
  s_cbranch_scc1 re_loop
re_l4:
  v_mfma_f32_16x16x32_bf16 v[16:19], a[96:99], a[0:3], v[16:19]
  ds_read_b64_tr_b16 a[124:125], v7 offset:192
  v_cmp_ne_u32 vcc, s60, v197
  v_mfma_f32_16x16x32_bf16 v[56:59], a[96:99], a[4:7], v[56:59]
  ds_read_b64_tr_b16 a[126:127], v7 offset:5312
  s_add_u32 m0, s68, 86016
  s_cbranch_vccnz re_pfx
  re_pfb:
  v_mfma_f32_16x16x32_bf16 v[20:23], a[100:103], a[0:3], v[20:23]
  ds_read_b64_tr_b16 a[128:129], v6 offset:256
  v_mfma_f32_16x16x32_bf16 v[60:63], a[100:103], a[4:7], v[60:63]
  ds_read_b64_tr_b16 a[130:131], v6 offset:5376
  s_waitcnt lgkmcnt(10)
  v_mfma_f32_16x16x32_bf16 v[24:27], a[104:107], a[0:3], v[24:27]
  ds_read_b64_tr_b16 a[132:133], v7 offset:256
  buffer_load_dwordx4 v204, s[56:59], s69 offen offset:0 lds
  v_mfma_f32_16x16x32_bf16 v[64:67], a[104:107], a[4:7], v[64:67]
  ds_read_b64_tr_b16 a[134:135], v7 offset:5376
  s_add_u32 s69, s69, 81920
  v_mfma_f32_16x16x32_bf16 v[28:31], a[108:111], a[0:3], v[28:31]
  ds_read_b64_tr_b16 a[96:97], v6 offset:10240
  v_mfma_f32_16x16x32_bf16 v[68:71], a[108:111], a[4:7], v[68:71]
  ds_read_b64_tr_b16 a[98:99], v6 offset:15360
  s_waitcnt lgkmcnt(10)
  v_mfma_f32_16x16x32_bf16 v[32:35], a[112:115], a[0:3], v[32:35]
  ds_read_b64_tr_b16 a[100:101], v7 offset:10240
  buffer_load_dwordx4 a[48:51], v198, s[8:11], s36 offen offset:0 sc1
  v_mfma_f32_16x16x32_bf16 v[72:75], a[112:115], a[4:7], v[72:75]
  ds_read_b64_tr_b16 a[102:103], v7 offset:15360
  v_mfma_f32_16x16x32_bf16 v[36:39], a[116:119], a[0:3], v[36:39]
  ds_read_b64_tr_b16 a[104:105], v6 offset:10304
  v_mfma_f32_16x16x32_bf16 v[76:79], a[116:119], a[4:7], v[76:79]
  ds_read_b64_tr_b16 a[106:107], v6 offset:15424
  s_waitcnt lgkmcnt(10)
  v_mfma_f32_16x16x32_bf16 v[40:43], a[120:123], a[0:3], v[40:43]
  ds_read_b64_tr_b16 a[108:109], v7 offset:10304
  v_mfma_f32_16x16x32_bf16 v[80:83], a[120:123], a[4:7], v[80:83]
  ds_read_b64_tr_b16 a[110:111], v7 offset:15424
  buffer_load_dwordx4 a[52:55], v199, s[8:11], s36 offen offset:0 sc1
  v_mfma_f32_16x16x32_bf16 v[44:47], a[124:127], a[0:3], v[44:47]
  ds_read_b64_tr_b16 a[112:113], v6 offset:10368
  v_mfma_f32_16x16x32_bf16 v[84:87], a[124:127], a[4:7], v[84:87]
  ds_read_b64_tr_b16 a[114:115], v6 offset:15488
  s_waitcnt lgkmcnt(10)
  v_mfma_f32_16x16x32_bf16 v[48:51], a[128:131], a[0:3], v[48:51]
  ds_read_b64_tr_b16 a[116:117], v7 offset:10368
  v_mfma_f32_16x16x32_bf16 v[88:91], a[128:131], a[4:7], v[88:91]
  ds_read_b64_tr_b16 a[118:119], v7 offset:15488
  buffer_load_dwordx4 a[56:59], v198, s[8:11], s36 offen offset:2048 sc1
  v_mfma_f32_16x16x32_bf16 v[52:55], a[132:135], a[0:3], v[52:55]
  ds_read_b64_tr_b16 a[120:121], v6 offset:10432
  v_mfma_f32_16x16x32_bf16 v[92:95], a[132:135], a[4:7], v[92:95]
  ds_read_b64_tr_b16 a[122:123], v6 offset:15552
  s_waitcnt lgkmcnt(10)
  v_mfma_f32_16x16x32_bf16 v[16:19], a[96:99], a[8:11], v[16:19]
  ds_read_b64_tr_b16 a[124:125], v7 offset:10432
  v_mfma_f32_16x16x32_bf16 v[56:59], a[96:99], a[12:15], v[56:59]
  ds_read_b64_tr_b16 a[126:127], v7 offset:15552
  v_mfma_f32_16x16x32_bf16 v[20:23], a[100:103], a[8:11], v[20:23]
  ds_read_b64_tr_b16 a[128:129], v6 offset:10496
  buffer_load_dwordx4 a[60:63], v199, s[8:11], s36 offen offset:2048 sc1
  v_mfma_f32_16x16x32_bf16 v[60:63], a[100:103], a[12:15], v[60:63]
  ds_read_b64_tr_b16 a[130:131], v6 offset:15616
  s_waitcnt lgkmcnt(10)
  v_mfma_f32_16x16x32_bf16 v[24:27], a[104:107], a[8:11], v[24:27]
  ds_read_b64_tr_b16 a[132:133], v7 offset:10496
  s_add_u32 s36, s36, 4096
  s_add_u32 m0, s68, 102400
  v_mfma_f32_16x16x32_bf16 v[64:67], a[104:107], a[12:15], v[64:67]
  ds_read_b64_tr_b16 a[134:135], v7 offset:15616
  s_barrier
  v_mfma_f32_16x16x32_bf16 v[28:31], a[108:111], a[8:11], v[28:31]
  ds_read_b64_tr_b16 a[96:97], v6 offset:20480
  buffer_load_dwordx4 v200, s[56:59], s69 offen offset:0 lds
  v_mfma_f32_16x16x32_bf16 v[68:71], a[108:111], a[12:15], v[68:71]
  ds_read_b64_tr_b16 a[98:99], v6 offset:25600
  s_waitcnt lgkmcnt(10)
  v_mfma_f32_16x16x32_bf16 v[32:35], a[112:115], a[8:11], v[32:35]
  ds_read_b64_tr_b16 a[100:101], v7 offset:20480
  v_mfma_f32_16x16x32_bf16 v[72:75], a[112:115], a[12:15], v[72:75]
  ds_read_b64_tr_b16 a[102:103], v7 offset:25600
  v_mfma_f32_16x16x32_bf16 v[36:39], a[116:119], a[8:11], v[36:39]
  ds_read_b64_tr_b16 a[104:105], v6 offset:20544
  buffer_load_dwordx4 v201, s[56:59], s69 offen offset:1024 lds
  v_mfma_f32_16x16x32_bf16 v[76:79], a[116:119], a[12:15], v[76:79]
  ds_read_b64_tr_b16 a[106:107], v6 offset:25664
  s_waitcnt lgkmcnt(10)
  v_mfma_f32_16x16x32_bf16 v[40:43], a[120:123], a[8:11], v[40:43]
  ds_read_b64_tr_b16 a[108:109], v7 offset:20544
  v_mfma_f32_16x16x32_bf16 v[80:83], a[120:123], a[12:15], v[80:83]
  ds_read_b64_tr_b16 a[110:111], v7 offset:25664
  v_mfma_f32_16x16x32_bf16 v[44:47], a[124:127], a[8:11], v[44:47]
  ds_read_b64_tr_b16 a[112:113], v6 offset:20608
  buffer_load_dwordx4 v202, s[56:59], s69 offen offset:2048 lds
  v_mfma_f32_16x16x32_bf16 v[84:87], a[124:127], a[12:15], v[84:87]
  ds_read_b64_tr_b16 a[114:115], v6 offset:25728
  s_waitcnt lgkmcnt(10)
  v_mfma_f32_16x16x32_bf16 v[48:51], a[128:131], a[8:11], v[48:51]
  ds_read_b64_tr_b16 a[116:117], v7 offset:20608
  v_mfma_f32_16x16x32_bf16 v[88:91], a[128:131], a[12:15], v[88:91]
  ds_read_b64_tr_b16 a[118:119], v7 offset:25728
  v_mfma_f32_16x16x32_bf16 v[52:55], a[132:135], a[8:11], v[52:55]
  ds_read_b64_tr_b16 a[120:121], v6 offset:20672
  buffer_load_dwordx4 v203, s[56:59], s69 offen offset:3072 lds
  v_mfma_f32_16x16x32_bf16 v[92:95], a[132:135], a[12:15], v[92:95]
  ds_read_b64_tr_b16 a[122:123], v6 offset:25792
  s_waitcnt vmcnt(23)
  s_waitcnt lgkmcnt(10)
  ds_read_b64_tr_b16 a[124:125], v7 offset:20672
  v_mfma_f32_16x16x32_bf16 v[56:59], a[96:99], a[20:23], v[56:59]
  ds_read_b64_tr_b16 a[126:127], v7 offset:25792
  s_add_u32 m0, s68, 106496
  ds_read_b64_tr_b16 a[128:129], v6 offset:20736
  v_mfma_f32_16x16x32_bf16 v[60:63], a[100:103], a[20:23], v[60:63]
  ds_read_b64_tr_b16 a[130:131], v6 offset:25856
  s_waitcnt lgkmcnt(10)
  ds_read_b64_tr_b16 a[132:133], v7 offset:20736
  buffer_load_dwordx4 v204, s[56:59], s69 offen offset:0 lds
  v_mfma_f32_16x16x32_bf16 v[64:67], a[104:107], a[20:23], v[64:67]
  ds_read_b64_tr_b16 a[134:135], v7 offset:25856
  s_add_u32 s69, s69, 81920
  ds_read_b64_tr_b16 a[96:97], v6 offset:30720
  v_mfma_f32_16x16x32_bf16 v[68:71], a[108:111], a[20:23], v[68:71]
  ds_read_b64_tr_b16 a[98:99], v6 offset:35840
  s_waitcnt lgkmcnt(10)
  ds_read_b64_tr_b16 a[100:101], v7 offset:30720
  buffer_load_dwordx4 a[64:67], v198, s[8:11], s36 offen offset:0 sc1
  v_mfma_f32_16x16x32_bf16 v[72:75], a[112:115], a[20:23], v[72:75]
  ds_read_b64_tr_b16 a[102:103], v7 offset:35840
  v_mfma_f32_16x16x32_bf16 v[36:39], a[116:119], a[16:19], v[36:39]
  ds_read_b64_tr_b16 a[104:105], v6 offset:30784
  v_mfma_f32_16x16x32_bf16 v[76:79], a[116:119], a[20:23], v[76:79]
  ds_read_b64_tr_b16 a[106:107], v6 offset:35904
  s_waitcnt lgkmcnt(10)
  v_mfma_f32_16x16x32_bf16 v[40:43], a[120:123], a[16:19], v[40:43]
  ds_read_b64_tr_b16 a[108:109], v7 offset:30784
  v_mfma_f32_16x16x32_bf16 v[80:83], a[120:123], a[20:23], v[80:83]
  ds_read_b64_tr_b16 a[110:111], v7 offset:35904
  buffer_load_dwordx4 a[68:71], v199, s[8:11], s36 offen offset:0 sc1
  v_mfma_f32_16x16x32_bf16 v[44:47], a[124:127], a[16:19], v[44:47]
  ds_read_b64_tr_b16 a[112:113], v6 offset:30848
  v_mfma_f32_16x16x32_bf16 v[84:87], a[124:127], a[20:23], v[84:87]
  ds_read_b64_tr_b16 a[114:115], v6 offset:35968
  s_waitcnt lgkmcnt(10)
  v_mfma_f32_16x16x32_bf16 v[48:51], a[128:131], a[16:19], v[48:51]
  ds_read_b64_tr_b16 a[116:117], v7 offset:30848
  v_mfma_f32_16x16x32_bf16 v[88:91], a[128:131], a[20:23], v[88:91]
  ds_read_b64_tr_b16 a[118:119], v7 offset:35968
  buffer_load_dwordx4 a[72:75], v198, s[8:11], s36 offen offset:2048 sc1
  v_mfma_f32_16x16x32_bf16 v[52:55], a[132:135], a[16:19], v[52:55]
  ds_read_b64_tr_b16 a[120:121], v6 offset:30912
  v_mfma_f32_16x16x32_bf16 v[92:95], a[132:135], a[20:23], v[92:95]
  ds_read_b64_tr_b16 a[122:123], v6 offset:36032
  s_waitcnt lgkmcnt(10)
  ds_read_b64_tr_b16 a[124:125], v7 offset:30912
  v_mfma_f32_16x16x32_bf16 v[56:59], a[96:99], a[28:31], v[56:59]
  ds_read_b64_tr_b16 a[126:127], v7 offset:36032
  ds_read_b64_tr_b16 a[128:129], v6 offset:30976
  buffer_load_dwordx4 a[76:79], v199, s[8:11], s36 offen offset:2048 sc1
  v_mfma_f32_16x16x32_bf16 v[60:63], a[100:103], a[28:31], v[60:63]
  ds_read_b64_tr_b16 a[130:131], v6 offset:36096
  s_waitcnt lgkmcnt(10)
  ds_read_b64_tr_b16 a[132:133], v7 offset:30976
  s_add_u32 s36, s36, 4096
  v_mfma_f32_16x16x32_bf16 v[64:67], a[104:107], a[28:31], v[64:67]
  ds_read_b64_tr_b16 a[134:135], v7 offset:36096
  s_barrier
  ds_read_b64_tr_b16 a[96:97], v6 offset:40960
  s_mov_b32 s70, 0x42b87e74
  v_mfma_f32_16x16x32_bf16 v[68:71], a[108:111], a[28:31], v[68:71]
  ds_read_b64_tr_b16 a[98:99], v6 offset:46080
  s_waitcnt lgkmcnt(10)
  ds_read_b64_tr_b16 a[100:101], v7 offset:40960
  v_mfma_f32_16x16x32_bf16 v[72:75], a[112:115], a[28:31], v[72:75]
  ds_read_b64_tr_b16 a[102:103], v7 offset:46080
  v_mfma_f32_16x16x32_bf16 v[36:39], a[116:119], a[24:27], v[36:39]
  ds_read_b64_tr_b16 a[104:105], v6 offset:41024
  v_mfma_f32_16x16x32_bf16 v[76:79], a[116:119], a[28:31], v[76:79]
  ds_read_b64_tr_b16 a[106:107], v6 offset:46144
  s_mov_b32 s72, 0xbfb8aa3b
  s_waitcnt lgkmcnt(10)
  v_mfma_f32_16x16x32_bf16 v[40:43], a[120:123], a[24:27], v[40:43]
  ds_read_b64_tr_b16 a[108:109], v7 offset:41024
  v_mfma_f32_16x16x32_bf16 v[80:83], a[120:123], a[28:31], v[80:83]
  ds_read_b64_tr_b16 a[110:111], v7 offset:46144
  v_mfma_f32_16x16x32_bf16 v[44:47], a[124:127], a[24:27], v[44:47]
  ds_read_b64_tr_b16 a[112:113], v6 offset:41088
  v_mfma_f32_16x16x32_bf16 v[84:87], a[124:127], a[28:31], v[84:87]
  ds_read_b64_tr_b16 a[114:115], v6 offset:46208
  s_waitcnt lgkmcnt(10)
  v_mfma_f32_16x16x32_bf16 v[48:51], a[128:131], a[24:27], v[48:51]
  ds_read_b64_tr_b16 a[116:117], v7 offset:41088
  v_mfma_f32_16x16x32_bf16 v[88:91], a[128:131], a[28:31], v[88:91]
  ds_read_b64_tr_b16 a[118:119], v7 offset:46208
  v_mfma_f32_16x16x32_bf16 v[52:55], a[132:135], a[24:27], v[52:55]
  ds_read_b64_tr_b16 a[120:121], v6 offset:41152
  v_mfma_f32_16x16x32_bf16 v[92:95], a[132:135], a[28:31], v[92:95]
  ds_read_b64_tr_b16 a[122:123], v6 offset:46272
  s_waitcnt vmcnt(18)
  s_waitcnt lgkmcnt(10)
  ds_read_b64_tr_b16 a[124:125], v7 offset:41152
  v_mfma_f32_16x16x32_bf16 v[56:59], a[96:99], a[36:39], v[56:59]
  ds_read_b64_tr_b16 a[126:127], v7 offset:46272
  ds_read_b64_tr_b16 a[128:129], v6 offset:41216
  v_mfma_f32_16x16x32_bf16 v[60:63], a[100:103], a[36:39], v[60:63]
  ds_read_b64_tr_b16 a[130:131], v6 offset:46336
  v_lshlrev_b32 v152, 16, v176
  v_and_b32 v153, 0xffff0000, v176
  s_waitcnt lgkmcnt(10)
  ds_read_b64_tr_b16 a[132:133], v7 offset:41216
  v_mfma_f32_16x16x32_bf16 v[64:67], a[104:107], a[36:39], v[64:67]
  ds_read_b64_tr_b16 a[134:135], v7 offset:46336
  ds_read_b64_tr_b16 a[96:97], v6 offset:51200
  v_mfma_f32_16x16x32_bf16 v[68:71], a[108:111], a[36:39], v[68:71]
  ds_read_b64_tr_b16 a[98:99], v6 offset:56320
  s_waitcnt lgkmcnt(10)
  ds_read_b64_tr_b16 a[100:101], v7 offset:51200
  buffer_load_dwordx4 a[80:83], v198, s[8:11], s36 offen offset:0 sc1
  v_mfma_f32_16x16x32_bf16 v[72:75], a[112:115], a[36:39], v[72:75]
  ds_read_b64_tr_b16 a[102:103], v7 offset:56320
  v_lshlrev_b32 v154, 16, v177
  v_and_b32 v155, 0xffff0000, v177
  v_mfma_f32_16x16x32_bf16 v[36:39], a[116:119], a[32:35], v[36:39]
  ds_read_b64_tr_b16 a[104:105], v6 offset:51264
  v_mfma_f32_16x16x32_bf16 v[76:79], a[116:119], a[36:39], v[76:79]
  ds_read_b64_tr_b16 a[106:107], v6 offset:56384
  s_waitcnt lgkmcnt(10)
  v_mfma_f32_16x16x32_bf16 v[40:43], a[120:123], a[32:35], v[40:43]
  ds_read_b64_tr_b16 a[108:109], v7 offset:51264
  v_mfma_f32_16x16x32_bf16 v[80:83], a[120:123], a[36:39], v[80:83]
  ds_read_b64_tr_b16 a[110:111], v7 offset:56384
  buffer_load_dwordx4 a[84:87], v199, s[8:11], s36 offen offset:0 sc1
  v_mfma_f32_16x16x32_bf16 v[44:47], a[124:127], a[32:35], v[44:47]
  ds_read_b64_tr_b16 a[112:113], v6 offset:51328
  v_mfma_f32_16x16x32_bf16 v[84:87], a[124:127], a[36:39], v[84:87]
  ds_read_b64_tr_b16 a[114:115], v6 offset:56448
  v_lshlrev_b32 v156, 16, v178
  v_and_b32 v157, 0xffff0000, v178
  s_waitcnt lgkmcnt(10)
  v_mfma_f32_16x16x32_bf16 v[48:51], a[128:131], a[32:35], v[48:51]
  ds_read_b64_tr_b16 a[116:117], v7 offset:51328
  v_mfma_f32_16x16x32_bf16 v[88:91], a[128:131], a[36:39], v[88:91]
  ds_read_b64_tr_b16 a[118:119], v7 offset:56448
  buffer_load_dwordx4 a[88:91], v198, s[8:11], s36 offen offset:2048 sc1
  v_mfma_f32_16x16x32_bf16 v[52:55], a[132:135], a[32:35], v[52:55]
  ds_read_b64_tr_b16 a[120:121], v6 offset:51392
  v_mfma_f32_16x16x32_bf16 v[92:95], a[132:135], a[36:39], v[92:95]
  ds_read_b64_tr_b16 a[122:123], v6 offset:56512
  s_waitcnt lgkmcnt(10)
  ds_read_b64_tr_b16 a[124:125], v7 offset:51392
  v_lshlrev_b32 v158, 16, v179
  v_and_b32 v159, 0xffff0000, v179
  v_mfma_f32_16x16x32_bf16 v[56:59], a[96:99], a[44:47], v[56:59]
  ds_read_b64_tr_b16 a[126:127], v7 offset:56512
  ds_read_b64_tr_b16 a[128:129], v6 offset:51456
  buffer_load_dwordx4 a[92:95], v199, s[8:11], s36 offen offset:2048 sc1
  v_mfma_f32_16x16x32_bf16 v[60:63], a[100:103], a[44:47], v[60:63]
  ds_read_b64_tr_b16 a[130:131], v6 offset:56576
  s_waitcnt lgkmcnt(10)
  ds_read_b64_tr_b16 a[132:133], v7 offset:51456
  s_add_u32 s36, s36, 4096
  v_mfma_f32_16x16x32_bf16 v[64:67], a[104:107], a[44:47], v[64:67]
  ds_read_b64_tr_b16 a[134:135], v7 offset:56576
  s_barrier
  ds_read_b64_tr_b16 a[96:97], v8 offset:0
  v_lshlrev_b32 v160, 16, v180
  v_and_b32 v161, 0xffff0000, v180
  v_mfma_f32_16x16x32_bf16 v[68:71], a[108:111], a[44:47], v[68:71]
  ds_read_b64_tr_b16 a[98:99], v8 offset:5120
  s_waitcnt lgkmcnt(10)
  ds_read_b64_tr_b16 a[100:101], v9 offset:0
  v_mfma_f32_16x16x32_bf16 v[72:75], a[112:115], a[44:47], v[72:75]
  ds_read_b64_tr_b16 a[102:103], v9 offset:5120
  v_mfma_f32_16x16x32_bf16 v[36:39], a[116:119], a[40:43], v[36:39]
  ds_read_b64_tr_b16 a[104:105], v8 offset:64
  v_mfma_f32_16x16x32_bf16 v[76:79], a[116:119], a[44:47], v[76:79]
  ds_read_b64_tr_b16 a[106:107], v8 offset:5184
  s_waitcnt lgkmcnt(10)
  v_mfma_f32_16x16x32_bf16 v[40:43], a[120:123], a[40:43], v[40:43]
  ds_read_b64_tr_b16 a[108:109], v9 offset:64
  v_lshlrev_b32 v162, 16, v181
  v_and_b32 v163, 0xffff0000, v181
  v_mfma_f32_16x16x32_bf16 v[80:83], a[120:123], a[44:47], v[80:83]
  ds_read_b64_tr_b16 a[110:111], v9 offset:5184
  v_mfma_f32_16x16x32_bf16 v[44:47], a[124:127], a[40:43], v[44:47]
  ds_read_b64_tr_b16 a[112:113], v8 offset:128
  v_mfma_f32_16x16x32_bf16 v[84:87], a[124:127], a[44:47], v[84:87]
  ds_read_b64_tr_b16 a[114:115], v8 offset:5248
  s_waitcnt lgkmcnt(10)
  v_mfma_f32_16x16x32_bf16 v[48:51], a[128:131], a[40:43], v[48:51]
  ds_read_b64_tr_b16 a[116:117], v9 offset:128
  v_mfma_f32_16x16x32_bf16 v[88:91], a[128:131], a[44:47], v[88:91]
  ds_read_b64_tr_b16 a[118:119], v9 offset:5248
  v_mfma_f32_16x16x32_bf16 v[52:55], a[132:135], a[40:43], v[52:55]
  ds_read_b64_tr_b16 a[120:121], v8 offset:192
  v_lshlrev_b32 v164, 16, v182
  v_and_b32 v165, 0xffff0000, v182
  v_mfma_f32_16x16x32_bf16 v[92:95], a[132:135], a[44:47], v[92:95]
  ds_read_b64_tr_b16 a[122:123], v8 offset:5312
  s_waitcnt vmcnt(13)
  s_waitcnt lgkmcnt(10)
  ds_read_b64_tr_b16 a[124:125], v9 offset:192
  v_mfma_f32_16x16x32_bf16 v[56:59], a[96:99], a[52:55], v[56:59]
  ds_read_b64_tr_b16 a[126:127], v9 offset:5312
  ds_read_b64_tr_b16 a[128:129], v8 offset:256
  v_mfma_f32_16x16x32_bf16 v[60:63], a[100:103], a[52:55], v[60:63]
  ds_read_b64_tr_b16 a[130:131], v8 offset:5376
  s_waitcnt lgkmcnt(10)
  ds_read_b64_tr_b16 a[132:133], v9 offset:256
  v_lshlrev_b32 v166, 16, v183
  v_and_b32 v167, 0xffff0000, v183
  v_mfma_f32_16x16x32_bf16 v[64:67], a[104:107], a[52:55], v[64:67]
  ds_read_b64_tr_b16 a[134:135], v9 offset:5376
  ds_read_b64_tr_b16 a[96:97], v8 offset:10240
  v_mfma_f32_16x16x32_bf16 v[68:71], a[108:111], a[52:55], v[68:71]
  ds_read_b64_tr_b16 a[98:99], v8 offset:15360
  s_waitcnt lgkmcnt(10)
  ds_read_b64_tr_b16 a[100:101], v9 offset:10240
  v_mfma_f32_16x16x32_bf16 v[72:75], a[112:115], a[52:55], v[72:75]
  ds_read_b64_tr_b16 a[102:103], v9 offset:15360
  v_mfma_f32_16x16x32_bf16 v[36:39], a[116:119], a[48:51], v[36:39]
  ds_read_b64_tr_b16 a[104:105], v8 offset:10304
  v_lshlrev_b32 v168, 16, v184
  v_and_b32 v169, 0xffff0000, v184
  v_mfma_f32_16x16x32_bf16 v[76:79], a[116:119], a[52:55], v[76:79]
  ds_read_b64_tr_b16 a[106:107], v8 offset:15424
  s_waitcnt lgkmcnt(10)
  v_mfma_f32_16x16x32_bf16 v[40:43], a[120:123], a[48:51], v[40:43]
  ds_read_b64_tr_b16 a[108:109], v9 offset:10304
  v_mfma_f32_16x16x32_bf16 v[80:83], a[120:123], a[52:55], v[80:83]
  ds_read_b64_tr_b16 a[110:111], v9 offset:15424
  v_mfma_f32_16x16x32_bf16 v[44:47], a[124:127], a[48:51], v[44:47]
  ds_read_b64_tr_b16 a[112:113], v8 offset:10368
  v_mfma_f32_16x16x32_bf16 v[84:87], a[124:127], a[52:55], v[84:87]
  ds_read_b64_tr_b16 a[114:115], v8 offset:15488
  v_lshlrev_b32 v170, 16, v185
  v_and_b32 v171, 0xffff0000, v185
  s_waitcnt lgkmcnt(10)
  v_mfma_f32_16x16x32_bf16 v[48:51], a[128:131], a[48:51], v[48:51]
  ds_read_b64_tr_b16 a[116:117], v9 offset:10368
  v_mfma_f32_16x16x32_bf16 v[88:91], a[128:131], a[52:55], v[88:91]
  ds_read_b64_tr_b16 a[118:119], v9 offset:15488
  v_mfma_f32_16x16x32_bf16 v[52:55], a[132:135], a[48:51], v[52:55]
  ds_read_b64_tr_b16 a[120:121], v8 offset:10432
  v_mfma_f32_16x16x32_bf16 v[92:95], a[132:135], a[52:55], v[92:95]
  ds_read_b64_tr_b16 a[122:123], v8 offset:15552
  s_waitcnt lgkmcnt(10)
  ds_read_b64_tr_b16 a[124:125], v9 offset:10432
  v_mfma_f32_16x16x32_bf16 v[56:59], a[96:99], a[60:63], v[56:59]
  ds_read_b64_tr_b16 a[126:127], v9 offset:15552
  v_lshlrev_b32 v208, 16, v186
  v_and_b32 v209, 0xffff0000, v186
  ds_read_b64_tr_b16 a[128:129], v8 offset:10496
  v_mfma_f32_16x16x32_bf16 v[60:63], a[100:103], a[60:63], v[60:63]
  ds_read_b64_tr_b16 a[130:131], v8 offset:15616
  s_waitcnt lgkmcnt(10)
  ds_read_b64_tr_b16 a[132:133], v9 offset:10496
  v_mfma_f32_16x16x32_bf16 v[64:67], a[104:107], a[60:63], v[64:67]
  ds_read_b64_tr_b16 a[134:135], v9 offset:15616
  s_barrier
  ds_read_b64_tr_b16 a[96:97], v8 offset:20480
  v_mfma_f32_16x16x32_bf16 v[68:71], a[108:111], a[60:63], v[68:71]
  ds_read_b64_tr_b16 a[98:99], v8 offset:25600
  buffer_load_dwordx4 v[116:119], v2, s[16:19], s44 offen offset:0 sc1
  v_lshlrev_b32 v210, 16, v187
  v_and_b32 v211, 0xffff0000, v187
  s_waitcnt lgkmcnt(10)
  ds_read_b64_tr_b16 a[100:101], v9 offset:20480
  v_mfma_f32_16x16x32_bf16 v[72:75], a[112:115], a[60:63], v[72:75]
  ds_read_b64_tr_b16 a[102:103], v9 offset:25600
  v_mfma_f32_16x16x32_bf16 v[36:39], a[116:119], a[56:59], v[36:39]
  ds_read_b64_tr_b16 a[104:105], v8 offset:20544
  v_mfma_f32_16x16x32_bf16 v[76:79], a[116:119], a[60:63], v[76:79]
  ds_read_b64_tr_b16 a[106:107], v8 offset:25664
  buffer_load_dwordx4 v[120:123], v2, s[16:19], s44 offen offset:1024 sc1
  s_waitcnt lgkmcnt(10)
  v_mfma_f32_16x16x32_bf16 v[40:43], a[120:123], a[56:59], v[40:43]
  ds_read_b64_tr_b16 a[108:109], v9 offset:20544
  v_mfma_f32_16x16x32_bf16 v[80:83], a[120:123], a[60:63], v[80:83]
  ds_read_b64_tr_b16 a[110:111], v9 offset:25664
  v_lshlrev_b32 v212, 16, v188
  v_and_b32 v213, 0xffff0000, v188
  v_mfma_f32_16x16x32_bf16 v[44:47], a[124:127], a[56:59], v[44:47]
  ds_read_b64_tr_b16 a[112:113], v8 offset:20608
  v_mfma_f32_16x16x32_bf16 v[84:87], a[124:127], a[60:63], v[84:87]
  ds_read_b64_tr_b16 a[114:115], v8 offset:25728
  buffer_load_dwordx2 v[124:125], v4, s[16:19], s44 offen offset:2048 sc1
  s_waitcnt lgkmcnt(10)
  v_mfma_f32_16x16x32_bf16 v[48:51], a[128:131], a[56:59], v[48:51]
  ds_read_b64_tr_b16 a[116:117], v9 offset:20608
  v_mfma_f32_16x16x32_bf16 v[88:91], a[128:131], a[60:63], v[88:91]
  ds_read_b64_tr_b16 a[118:119], v9 offset:25728
  v_mfma_f32_16x16x32_bf16 v[52:55], a[132:135], a[56:59], v[52:55]
  ds_read_b64_tr_b16 a[120:121], v8 offset:20672
  v_mfma_f32_16x16x32_bf16 v[92:95], a[132:135], a[60:63], v[92:95]
  ds_read_b64_tr_b16 a[122:123], v8 offset:25792
  s_waitcnt vmcnt(7)
  buffer_load_dwordx4 v[128:131], v2, s[16:19], s45 offen offset:0 sc1
  v_lshlrev_b32 v214, 16, v189
  v_and_b32 v215, 0xffff0000, v189
  s_waitcnt lgkmcnt(10)
  ds_read_b64_tr_b16 a[124:125], v9 offset:20672
  v_mfma_f32_16x16x32_bf16 v[56:59], a[96:99], a[68:71], v[56:59]
  ds_read_b64_tr_b16 a[126:127], v9 offset:25792
  ds_read_b64_tr_b16 a[128:129], v8 offset:20736
  v_mfma_f32_16x16x32_bf16 v[60:63], a[100:103], a[68:71], v[60:63]
  ds_read_b64_tr_b16 a[130:131], v8 offset:25856
  buffer_load_dwordx4 v[132:135], v2, s[16:19], s45 offen offset:1024 sc1
  s_waitcnt lgkmcnt(10)
  ds_read_b64_tr_b16 a[132:133], v9 offset:20736
  v_mfma_f32_16x16x32_bf16 v[64:67], a[104:107], a[68:71], v[64:67]
  ds_read_b64_tr_b16 a[134:135], v9 offset:25856
  v_lshlrev_b32 v216, 16, v190
  v_and_b32 v217, 0xffff0000, v190
  ds_read_b64_tr_b16 a[96:97], v8 offset:30720
  v_mfma_f32_16x16x32_bf16 v[68:71], a[108:111], a[68:71], v[68:71]
  ds_read_b64_tr_b16 a[98:99], v8 offset:35840
  buffer_load_dwordx2 v[136:137], v4, s[16:19], s45 offen offset:2048 sc1
  s_waitcnt lgkmcnt(10)
  ds_read_b64_tr_b16 a[100:101], v9 offset:30720
  v_mfma_f32_16x16x32_bf16 v[72:75], a[112:115], a[68:71], v[72:75]
  ds_read_b64_tr_b16 a[102:103], v9 offset:35840
  v_mfma_f32_16x16x32_bf16 v[36:39], a[116:119], a[64:67], v[36:39]
  ds_read_b64_tr_b16 a[104:105], v8 offset:30784
  v_lshlrev_b32 v218, 16, v191
  v_and_b32 v219, 0xffff0000, v191
  v_mfma_f32_16x16x32_bf16 v[76:79], a[116:119], a[68:71], v[76:79]
  ds_read_b64_tr_b16 a[106:107], v8 offset:35904
  buffer_load_dwordx4 v[140:143], v2, s[16:19], s46 offen offset:0 sc1
  s_waitcnt lgkmcnt(10)
  v_mfma_f32_16x16x32_bf16 v[40:43], a[120:123], a[64:67], v[40:43]
  ds_read_b64_tr_b16 a[108:109], v9 offset:30784
  v_mfma_f32_16x16x32_bf16 v[80:83], a[120:123], a[68:71], v[80:83]
  ds_read_b64_tr_b16 a[110:111], v9 offset:35904
  v_mfma_f32_16x16x32_bf16 v[44:47], a[124:127], a[64:67], v[44:47]
  ds_read_b64_tr_b16 a[112:113], v8 offset:30848
  v_mfma_f32_16x16x32_bf16 v[84:87], a[124:127], a[68:71], v[84:87]
  ds_read_b64_tr_b16 a[114:115], v8 offset:35968
  buffer_load_dwordx4 v[144:147], v2, s[16:19], s46 offen offset:1024 sc1
  s_waitcnt lgkmcnt(10)
  v_mfma_f32_16x16x32_bf16 v[48:51], a[128:131], a[64:67], v[48:51]
  ds_read_b64_tr_b16 a[116:117], v9 offset:30848
  v_lshlrev_b32 v220, 16, v192
  v_and_b32 v221, 0xffff0000, v192
  v_mfma_f32_16x16x32_bf16 v[88:91], a[128:131], a[68:71], v[88:91]
  ds_read_b64_tr_b16 a[118:119], v9 offset:35968
  v_mfma_f32_16x16x32_bf16 v[52:55], a[132:135], a[64:67], v[52:55]
  ds_read_b64_tr_b16 a[120:121], v8 offset:30912
  v_mfma_f32_16x16x32_bf16 v[92:95], a[132:135], a[68:71], v[92:95]
  ds_read_b64_tr_b16 a[122:123], v8 offset:36032
  buffer_load_dwordx2 v[148:149], v4, s[16:19], s46 offen offset:2048 sc1
  s_waitcnt lgkmcnt(10)
  ds_read_b64_tr_b16 a[124:125], v9 offset:30912
  v_mfma_f32_16x16x32_bf16 v[56:59], a[96:99], a[76:79], v[56:59]
  ds_read_b64_tr_b16 a[126:127], v9 offset:36032
  ds_read_b64_tr_b16 a[128:129], v8 offset:30976
  v_lshlrev_b32 v222, 16, v193
  v_and_b32 v223, 0xffff0000, v193
  v_mfma_f32_16x16x32_bf16 v[60:63], a[100:103], a[76:79], v[60:63]
  ds_read_b64_tr_b16 a[130:131], v8 offset:36096
  s_waitcnt lgkmcnt(10)
  ds_read_b64_tr_b16 a[132:133], v9 offset:30976
  v_mfma_f32_16x16x32_bf16 v[64:67], a[104:107], a[76:79], v[64:67]
  ds_read_b64_tr_b16 a[134:135], v9 offset:36096
  s_barrier
  ds_read_b64_tr_b16 a[96:97], v9 offset:41088
  v_mfma_f32_16x16x32_bf16 v[68:71], a[108:111], a[76:79], v[68:71]
  ds_read_b64_tr_b16 a[98:99], v9 offset:46208
  s_waitcnt lgkmcnt(10)
  ds_read_b64_tr_b16 a[100:101], v8 offset:41152
  v_lshlrev_b32 v224, 16, v194
  v_and_b32 v225, 0xffff0000, v194
  v_mfma_f32_16x16x32_bf16 v[72:75], a[112:115], a[76:79], v[72:75]
  ds_read_b64_tr_b16 a[102:103], v8 offset:46272
  v_mfma_f32_16x16x32_bf16 v[36:39], a[116:119], a[72:75], v[36:39]
  ds_read_b64_tr_b16 a[104:105], v9 offset:41152
  v_mfma_f32_16x16x32_bf16 v[76:79], a[116:119], a[76:79], v[76:79]
  ds_read_b64_tr_b16 a[106:107], v9 offset:46272
  s_waitcnt lgkmcnt(10)
  v_mfma_f32_16x16x32_bf16 v[40:43], a[120:123], a[72:75], v[40:43]
  ds_read_b64_tr_b16 a[108:109], v8 offset:41216
  v_mfma_f32_16x16x32_bf16 v[80:83], a[120:123], a[76:79], v[80:83]
  ds_read_b64_tr_b16 a[110:111], v8 offset:46336
  v_mfma_f32_16x16x32_bf16 v[44:47], a[124:127], a[72:75], v[44:47]
  ds_read_b64_tr_b16 a[112:113], v9 offset:41216
  v_lshlrev_b32 v226, 16, v195
  v_and_b32 v227, 0xffff0000, v195
  v_mfma_f32_16x16x32_bf16 v[84:87], a[124:127], a[76:79], v[84:87]
  ds_read_b64_tr_b16 a[114:115], v9 offset:46336
  s_waitcnt lgkmcnt(10)
  v_mfma_f32_16x16x32_bf16 v[48:51], a[128:131], a[72:75], v[48:51]
  ds_read_b64_tr_b16 a[116:117], v9 offset:51328
  v_mfma_f32_16x16x32_bf16 v[88:91], a[128:131], a[76:79], v[88:91]
  ds_read_b64_tr_b16 a[118:119], v9 offset:56448
  v_mfma_f32_16x16x32_bf16 v[52:55], a[132:135], a[72:75], v[52:55]
  ds_read_b64_tr_b16 a[120:121], v8 offset:51392
  v_mfma_f32_16x16x32_bf16 v[92:95], a[132:135], a[76:79], v[92:95]
  ds_read_b64_tr_b16 a[122:123], v8 offset:56512
  s_waitcnt vmcnt(9)
  s_waitcnt lgkmcnt(10)
  v_mfma_f32_16x16x32_bf16 v[36:39], a[96:99], a[80:83], v[36:39]
  ds_read_b64_tr_b16 a[124:125], v9 offset:51392
  v_mfma_f32_16x16x32_bf16 v[76:79], a[96:99], a[84:87], v[76:79]
  ds_read_b64_tr_b16 a[126:127], v9 offset:56512
  v_mfma_f32_16x16x32_bf16 v[40:43], a[100:103], a[80:83], v[40:43]
  ds_read_b64_tr_b16 a[128:129], v8 offset:51456
  v_mfma_f32_16x16x32_bf16 v[80:83], a[100:103], a[84:87], v[80:83]
  ds_read_b64_tr_b16 a[130:131], v8 offset:56576
  s_waitcnt lgkmcnt(10)
  v_mfma_f32_16x16x32_bf16 v[44:47], a[104:107], a[80:83], v[44:47]
  ds_read_b64_tr_b16 a[132:133], v9 offset:51456
  v_mfma_f32_16x16x32_bf16 v[84:87], a[104:107], a[84:87], v[84:87]
  ds_read_b64_tr_b16 a[134:135], v9 offset:56576
  v_mfma_f32_16x16x32_bf16 v[48:51], a[108:111], a[80:83], v[48:51]
  ds_read_b64_tr_b16 a[96:97], v8 offset:40960
  v_mfma_f32_16x16x32_bf16 v[88:91], a[108:111], a[84:87], v[88:91]
  ds_read_b64_tr_b16 a[98:99], v8 offset:46080
  s_waitcnt lgkmcnt(10)
  v_mfma_f32_16x16x32_bf16 v[52:55], a[112:115], a[80:83], v[52:55]
  ds_read_b64_tr_b16 a[100:101], v9 offset:40960
  v_mfma_f32_16x16x32_bf16 v[92:95], a[112:115], a[84:87], v[92:95]
  ds_read_b64_tr_b16 a[102:103], v9 offset:46080
  v_mfma_f32_16x16x32_bf16 v[36:39], a[116:119], a[88:91], v[36:39]
  ds_read_b64_tr_b16 a[104:105], v8 offset:41024
  v_mfma_f32_16x16x32_bf16 v[76:79], a[116:119], a[92:95], v[76:79]
  ds_read_b64_tr_b16 a[106:107], v8 offset:46144
  s_waitcnt lgkmcnt(10)
  v_mfma_f32_16x16x32_bf16 v[40:43], a[120:123], a[88:91], v[40:43]
  ds_read_b64_tr_b16 a[108:109], v9 offset:41024
  v_mfma_f32_16x16x32_bf16 v[80:83], a[120:123], a[92:95], v[80:83]
  ds_read_b64_tr_b16 a[110:111], v9 offset:46144
  v_mfma_f32_16x16x32_bf16 v[44:47], a[124:127], a[88:91], v[44:47]
  ds_read_b64_tr_b16 a[112:113], v8 offset:41088
  v_mfma_f32_16x16x32_bf16 v[84:87], a[124:127], a[92:95], v[84:87]
  ds_read_b64_tr_b16 a[114:115], v8 offset:46208
  s_waitcnt lgkmcnt(10)
  v_mfma_f32_16x16x32_bf16 v[48:51], a[128:131], a[88:91], v[48:51]
  ds_read_b64_tr_b16 a[116:117], v8 offset:51200
  v_mfma_f32_16x16x32_bf16 v[88:91], a[128:131], a[92:95], v[88:91]
  ds_read_b64_tr_b16 a[118:119], v8 offset:56320
  v_mfma_f32_16x16x32_bf16 v[52:55], a[132:135], a[88:91], v[52:55]
  ds_read_b64_tr_b16 a[120:121], v9 offset:51200
  v_mfma_f32_16x16x32_bf16 v[92:95], a[132:135], a[92:95], v[92:95]
  ds_read_b64_tr_b16 a[122:123], v9 offset:56320
  s_waitcnt lgkmcnt(10)
  ds_read_b64_tr_b16 a[124:125], v8 offset:51264
  v_mfma_f32_16x16x32_bf16 v[56:59], a[96:99], a[84:87], v[56:59]
  ds_read_b64_tr_b16 a[126:127], v8 offset:56384
  v_cvt_pk_bf16_f32 v176, v36, v37
  v_cvt_pk_bf16_f32 v177, v38, v39
  ds_read_b64_tr_b16 a[128:129], v9 offset:51264
  v_cvt_pk_bf16_f32 v178, v40, v41
  v_mfma_f32_16x16x32_bf16 v[60:63], a[100:103], a[84:87], v[60:63]
  ds_read_b64_tr_b16 a[130:131], v9 offset:56384
  v_cvt_pk_bf16_f32 v179, v42, v43
  buffer_store_dwordx4 v[176:179], v0, s[16:19], s41 offen offset:0 sc1
  s_waitcnt lgkmcnt(10)
  ds_read_b64_tr_b16 a[132:133], v8 offset:51328
  v_cvt_pk_bf16_f32 v180, v44, v45
  v_mfma_f32_16x16x32_bf16 v[64:67], a[104:107], a[84:87], v[64:67]
  ds_read_b64_tr_b16 a[134:135], v8 offset:56448
  v_cvt_pk_bf16_f32 v181, v46, v47
  v_cvt_pk_bf16_f32 v182, v48, v49
  v_cvt_pk_bf16_f32 v183, v50, v51
  v_mfma_f32_16x16x32_bf16 v[68:71], a[108:111], a[84:87], v[68:71]
  buffer_store_dwordx4 v[180:183], v0, s[16:19], s41 offen offset:1024 sc1
  v_cvt_pk_bf16_f32 v184, v52, v53
  s_waitcnt lgkmcnt(8)
  v_cvt_pk_bf16_f32 v185, v54, v55
  v_mfma_f32_16x16x32_bf16 v[72:75], a[112:115], a[84:87], v[72:75]
  buffer_store_dwordx2 v[184:185], v3, s[16:19], s41 offen offset:2048 sc1
  v_cvt_pk_bf16_f32 v244, v76, v77
  v_cvt_pk_bf16_f32 v245, v78, v79
  v_mfma_f32_16x16x32_bf16 v[56:59], a[116:119], a[92:95], v[56:59]
  v_cvt_pk_bf16_f32 v246, v80, v81
  s_waitcnt lgkmcnt(4)
  v_cvt_pk_bf16_f32 v247, v82, v83
  buffer_store_dwordx4 v[244:247], v0, s[16:19], s43 offen offset:0 sc1
  v_mfma_f32_16x16x32_bf16 v[60:63], a[120:123], a[92:95], v[60:63]
  v_cvt_pk_bf16_f32 v248, v84, v85
  v_cvt_pk_bf16_f32 v249, v86, v87
  v_cvt_pk_bf16_f32 v250, v88, v89
  v_mfma_f32_16x16x32_bf16 v[64:67], a[124:127], a[92:95], v[64:67]
  v_cvt_pk_bf16_f32 v251, v90, v91
  s_waitcnt lgkmcnt(0)
  buffer_store_dwordx4 v[248:251], v0, s[16:19], s43 offen offset:1024 sc1
  v_cvt_pk_bf16_f32 v252, v92, v93
  v_mfma_f32_16x16x32_bf16 v[68:71], a[128:131], a[92:95], v[68:71]
  v_cvt_pk_bf16_f32 v253, v94, v95
  buffer_store_dwordx2 v[252:253], v3, s[16:19], s43 offen offset:2048 sc1
  v_mfma_f32_16x16x32_bf16 v[72:75], a[132:135], a[92:95], v[72:75]
  s_nop 7
  v_cvt_pk_bf16_f32 v232, v56, v57
  v_cvt_pk_bf16_f32 v233, v58, v59
  v_cvt_pk_bf16_f32 v234, v60, v61
  v_cvt_pk_bf16_f32 v235, v62, v63
  ds_read_b64_tr_b16 a[96:97], v6 offset:20480
  ds_read_b64_tr_b16 a[98:99], v6 offset:25600
  buffer_store_dwordx4 v[232:235], v0, s[16:19], s42 offen offset:0 sc1
  ds_read_b64_tr_b16 a[100:101], v7 offset:20480
  ds_read_b64_tr_b16 a[102:103], v7 offset:25600
  v_cvt_pk_bf16_f32 v236, v64, v65
  ds_read_b64_tr_b16 a[104:105], v6 offset:20544
  ds_read_b64_tr_b16 a[106:107], v6 offset:25664
  v_cvt_pk_bf16_f32 v237, v66, v67
  ds_read_b64_tr_b16 a[108:109], v7 offset:20544
  ds_read_b64_tr_b16 a[110:111], v7 offset:25664
  v_cvt_pk_bf16_f32 v238, v68, v69
  ds_read_b64_tr_b16 a[112:113], v6 offset:20608
  ds_read_b64_tr_b16 a[114:115], v6 offset:25728
  v_cvt_pk_bf16_f32 v239, v70, v71
  ds_read_b64_tr_b16 a[116:117], v6 offset:30720
  ds_read_b64_tr_b16 a[118:119], v6 offset:35840
  buffer_store_dwordx4 v[236:239], v0, s[16:19], s42 offen offset:1024 sc1
  ds_read_b64_tr_b16 a[120:121], v7 offset:30720
  ds_read_b64_tr_b16 a[122:123], v7 offset:35840
  v_cvt_pk_bf16_f32 v240, v72, v73
  v_cvt_pk_bf16_f32 v241, v74, v75
  buffer_store_dwordx2 v[240:241], v3, s[16:19], s42 offen offset:2048 sc1
  s_waitcnt lgkmcnt(12)
  v_mfma_f32_16x16x32_bf16 v[16:19], a[96:99], a[16:19], v[16:19]
  ds_read_b64_tr_b16 a[124:125], v6 offset:30784
  ds_read_b64_tr_b16 a[126:127], v6 offset:35904
  s_waitcnt lgkmcnt(12)
  v_mfma_f32_16x16x32_bf16 v[20:23], a[100:103], a[16:19], v[20:23]
  ds_read_b64_tr_b16 a[128:129], v7 offset:30784
  ds_read_b64_tr_b16 a[130:131], v7 offset:35904
  s_waitcnt lgkmcnt(12)
  v_mfma_f32_16x16x32_bf16 v[24:27], a[104:107], a[16:19], v[24:27]
  ds_read_b64_tr_b16 a[132:133], v6 offset:30848
  ds_read_b64_tr_b16 a[134:135], v6 offset:35968
  s_waitcnt lgkmcnt(12)
  v_mfma_f32_16x16x32_bf16 v[28:31], a[108:111], a[16:19], v[28:31]
  ds_read_b64_tr_b16 a[96:97], v6 offset:40960
  ds_read_b64_tr_b16 a[98:99], v6 offset:46080
  s_waitcnt lgkmcnt(12)
  v_mfma_f32_16x16x32_bf16 v[32:35], a[112:115], a[16:19], v[32:35]
  ds_read_b64_tr_b16 a[100:101], v7 offset:40960
  ds_read_b64_tr_b16 a[102:103], v7 offset:46080
  s_waitcnt lgkmcnt(12)
  v_mfma_f32_16x16x32_bf16 v[16:19], a[116:119], a[24:27], v[16:19]
  ds_read_b64_tr_b16 a[104:105], v6 offset:41024
  ds_read_b64_tr_b16 a[106:107], v6 offset:46144
  s_waitcnt lgkmcnt(12)
  v_mfma_f32_16x16x32_bf16 v[20:23], a[120:123], a[24:27], v[20:23]
  ds_read_b64_tr_b16 a[108:109], v7 offset:41024
  ds_read_b64_tr_b16 a[110:111], v7 offset:46144
  s_waitcnt lgkmcnt(12)
  v_mfma_f32_16x16x32_bf16 v[24:27], a[124:127], a[24:27], v[24:27]
  ds_read_b64_tr_b16 a[112:113], v6 offset:41088
  ds_read_b64_tr_b16 a[114:115], v6 offset:46208
  s_waitcnt lgkmcnt(12)
  v_mfma_f32_16x16x32_bf16 v[28:31], a[128:131], a[24:27], v[28:31]
  ds_read_b64_tr_b16 a[116:117], v6 offset:51200
  ds_read_b64_tr_b16 a[118:119], v6 offset:56320
  s_waitcnt lgkmcnt(12)
  v_mfma_f32_16x16x32_bf16 v[32:35], a[132:135], a[24:27], v[32:35]
  ds_read_b64_tr_b16 a[120:121], v7 offset:51200
  ds_read_b64_tr_b16 a[122:123], v7 offset:56320
  s_waitcnt lgkmcnt(12)
  v_mfma_f32_16x16x32_bf16 v[16:19], a[96:99], a[32:35], v[16:19]
  ds_read_b64_tr_b16 a[124:125], v6 offset:51264
  ds_read_b64_tr_b16 a[126:127], v6 offset:56384
  s_waitcnt lgkmcnt(12)
  v_mfma_f32_16x16x32_bf16 v[20:23], a[100:103], a[32:35], v[20:23]
  ds_read_b64_tr_b16 a[128:129], v7 offset:51264
  ds_read_b64_tr_b16 a[130:131], v7 offset:56384
  s_waitcnt lgkmcnt(12)
  v_mfma_f32_16x16x32_bf16 v[24:27], a[104:107], a[32:35], v[24:27]
  ds_read_b64_tr_b16 a[132:133], v6 offset:51328
  ds_read_b64_tr_b16 a[134:135], v6 offset:56448
  s_waitcnt lgkmcnt(12)
  v_mfma_f32_16x16x32_bf16 v[28:31], a[108:111], a[32:35], v[28:31]
  ds_read_b64_tr_b16 a[96:97], v8 offset:0
  ds_read_b64_tr_b16 a[98:99], v8 offset:5120
  s_waitcnt lgkmcnt(12)
  v_mfma_f32_16x16x32_bf16 v[32:35], a[112:115], a[32:35], v[32:35]
  ds_read_b64_tr_b16 a[100:101], v9 offset:0
  ds_read_b64_tr_b16 a[102:103], v9 offset:5120
  s_waitcnt lgkmcnt(12)
  v_mfma_f32_16x16x32_bf16 v[16:19], a[116:119], a[40:43], v[16:19]
  ds_read_b64_tr_b16 a[104:105], v8 offset:64
  ds_read_b64_tr_b16 a[106:107], v8 offset:5184
  s_waitcnt lgkmcnt(12)
  v_mfma_f32_16x16x32_bf16 v[20:23], a[120:123], a[40:43], v[20:23]
  ds_read_b64_tr_b16 a[108:109], v9 offset:64
  ds_read_b64_tr_b16 a[110:111], v9 offset:5184
  s_waitcnt lgkmcnt(12)
  v_mfma_f32_16x16x32_bf16 v[24:27], a[124:127], a[40:43], v[24:27]
  ds_read_b64_tr_b16 a[112:113], v8 offset:128
  ds_read_b64_tr_b16 a[114:115], v8 offset:5248
  s_waitcnt lgkmcnt(12)
  v_mfma_f32_16x16x32_bf16 v[28:31], a[128:131], a[40:43], v[28:31]
  ds_read_b64_tr_b16 a[116:117], v8 offset:10240
  ds_read_b64_tr_b16 a[118:119], v8 offset:15360
  s_waitcnt lgkmcnt(12)
  v_mfma_f32_16x16x32_bf16 v[32:35], a[132:135], a[40:43], v[32:35]
  ds_read_b64_tr_b16 a[120:121], v9 offset:10240
  ds_read_b64_tr_b16 a[122:123], v9 offset:15360
  s_waitcnt lgkmcnt(12)
  v_mfma_f32_16x16x32_bf16 v[16:19], a[96:99], a[48:51], v[16:19]
  ds_read_b64_tr_b16 a[124:125], v8 offset:10304
  ds_read_b64_tr_b16 a[126:127], v8 offset:15424
  s_waitcnt lgkmcnt(12)
  v_mfma_f32_16x16x32_bf16 v[20:23], a[100:103], a[48:51], v[20:23]
  ds_read_b64_tr_b16 a[128:129], v9 offset:10304
  ds_read_b64_tr_b16 a[130:131], v9 offset:15424
  s_waitcnt lgkmcnt(12)
  v_mfma_f32_16x16x32_bf16 v[24:27], a[104:107], a[48:51], v[24:27]
  ds_read_b64_tr_b16 a[132:133], v8 offset:10368
  ds_read_b64_tr_b16 a[134:135], v8 offset:15488
  s_waitcnt lgkmcnt(12)
  v_mfma_f32_16x16x32_bf16 v[28:31], a[108:111], a[48:51], v[28:31]
  ds_read_b64_tr_b16 a[96:97], v8 offset:20480
  ds_read_b64_tr_b16 a[98:99], v8 offset:25600
  s_waitcnt lgkmcnt(12)
  v_mfma_f32_16x16x32_bf16 v[32:35], a[112:115], a[48:51], v[32:35]
  ds_read_b64_tr_b16 a[100:101], v9 offset:20480
  ds_read_b64_tr_b16 a[102:103], v9 offset:25600
  s_waitcnt lgkmcnt(12)
  v_mfma_f32_16x16x32_bf16 v[16:19], a[116:119], a[56:59], v[16:19]
  ds_read_b64_tr_b16 a[104:105], v8 offset:20544
  ds_read_b64_tr_b16 a[106:107], v8 offset:25664
  s_waitcnt lgkmcnt(12)
  v_mfma_f32_16x16x32_bf16 v[20:23], a[120:123], a[56:59], v[20:23]
  ds_read_b64_tr_b16 a[108:109], v9 offset:20544
  ds_read_b64_tr_b16 a[110:111], v9 offset:25664
  s_waitcnt lgkmcnt(12)
  v_mfma_f32_16x16x32_bf16 v[24:27], a[124:127], a[56:59], v[24:27]
  ds_read_b64_tr_b16 a[112:113], v8 offset:20608
  ds_read_b64_tr_b16 a[114:115], v8 offset:25728
  s_waitcnt lgkmcnt(12)
  v_mfma_f32_16x16x32_bf16 v[28:31], a[128:131], a[56:59], v[28:31]
  ds_read_b64_tr_b16 a[116:117], v8 offset:30720
  ds_read_b64_tr_b16 a[118:119], v8 offset:35840
  s_waitcnt lgkmcnt(12)
  v_mfma_f32_16x16x32_bf16 v[32:35], a[132:135], a[56:59], v[32:35]
  ds_read_b64_tr_b16 a[120:121], v9 offset:30720
  ds_read_b64_tr_b16 a[122:123], v9 offset:35840
  s_waitcnt lgkmcnt(12)
  v_mfma_f32_16x16x32_bf16 v[16:19], a[96:99], a[64:67], v[16:19]
  ds_read_b64_tr_b16 a[124:125], v8 offset:30784
  ds_read_b64_tr_b16 a[126:127], v8 offset:35904
  s_waitcnt lgkmcnt(12)
  v_mfma_f32_16x16x32_bf16 v[20:23], a[100:103], a[64:67], v[20:23]
  ds_read_b64_tr_b16 a[128:129], v9 offset:30784
  ds_read_b64_tr_b16 a[130:131], v9 offset:35904
  s_waitcnt lgkmcnt(12)
  v_mfma_f32_16x16x32_bf16 v[24:27], a[104:107], a[64:67], v[24:27]
  ds_read_b64_tr_b16 a[132:133], v8 offset:30848
  ds_read_b64_tr_b16 a[134:135], v8 offset:35968
  s_waitcnt lgkmcnt(12)
  v_mfma_f32_16x16x32_bf16 v[28:31], a[108:111], a[64:67], v[28:31]
  ds_read_b64_tr_b16 a[96:97], v8 offset:40960
  ds_read_b64_tr_b16 a[98:99], v8 offset:46080
  s_waitcnt lgkmcnt(12)
  v_mfma_f32_16x16x32_bf16 v[32:35], a[112:115], a[64:67], v[32:35]
  ds_read_b64_tr_b16 a[100:101], v9 offset:40960
  ds_read_b64_tr_b16 a[102:103], v9 offset:46080
  s_waitcnt lgkmcnt(12)
  v_mfma_f32_16x16x32_bf16 v[16:19], a[116:119], a[72:75], v[16:19]
  ds_read_b64_tr_b16 a[104:105], v8 offset:41024
  ds_read_b64_tr_b16 a[106:107], v8 offset:46144
  s_waitcnt lgkmcnt(12)
  v_mfma_f32_16x16x32_bf16 v[20:23], a[120:123], a[72:75], v[20:23]
  ds_read_b64_tr_b16 a[108:109], v9 offset:41024
  ds_read_b64_tr_b16 a[110:111], v9 offset:46144
  s_waitcnt lgkmcnt(12)
  v_mfma_f32_16x16x32_bf16 v[24:27], a[124:127], a[72:75], v[24:27]
  ds_read_b64_tr_b16 a[112:113], v8 offset:41088
  ds_read_b64_tr_b16 a[114:115], v8 offset:46208
  s_waitcnt lgkmcnt(12)
  v_mfma_f32_16x16x32_bf16 v[28:31], a[128:131], a[72:75], v[28:31]
  ds_read_b64_tr_b16 a[116:117], v8 offset:51200
  ds_read_b64_tr_b16 a[118:119], v8 offset:56320
  s_waitcnt lgkmcnt(12)
  v_mfma_f32_16x16x32_bf16 v[32:35], a[132:135], a[72:75], v[32:35]
  ds_read_b64_tr_b16 a[120:121], v9 offset:51200
  ds_read_b64_tr_b16 a[122:123], v9 offset:56320
  s_waitcnt lgkmcnt(12)
  v_mfma_f32_16x16x32_bf16 v[16:19], a[96:99], a[80:83], v[16:19]
  ds_read_b64_tr_b16 a[124:125], v8 offset:51264
  ds_read_b64_tr_b16 a[126:127], v8 offset:56384
  s_waitcnt lgkmcnt(12)
  v_mfma_f32_16x16x32_bf16 v[20:23], a[100:103], a[80:83], v[20:23]
  ds_read_b64_tr_b16 a[128:129], v9 offset:51264
  ds_read_b64_tr_b16 a[130:131], v9 offset:56384
  s_waitcnt lgkmcnt(12)
  v_mfma_f32_16x16x32_bf16 v[24:27], a[104:107], a[80:83], v[24:27]
  ds_read_b64_tr_b16 a[132:133], v8 offset:51328
  ds_read_b64_tr_b16 a[134:135], v8 offset:56448
  s_waitcnt lgkmcnt(12)
  v_mfma_f32_16x16x32_bf16 v[28:31], a[108:111], a[80:83], v[28:31]
  s_waitcnt lgkmcnt(10)
  v_mfma_f32_16x16x32_bf16 v[32:35], a[112:115], a[80:83], v[32:35]
  s_waitcnt lgkmcnt(8)
  v_mfma_f32_16x16x32_bf16 v[16:19], a[116:119], a[88:91], v[16:19]
  s_waitcnt lgkmcnt(6)
  v_mfma_f32_16x16x32_bf16 v[20:23], a[120:123], a[88:91], v[20:23]
  s_waitcnt lgkmcnt(4)
  v_mfma_f32_16x16x32_bf16 v[24:27], a[124:127], a[88:91], v[24:27]
  s_waitcnt lgkmcnt(2)
  v_mfma_f32_16x16x32_bf16 v[28:31], a[128:131], a[88:91], v[28:31]
  s_waitcnt lgkmcnt(0)
  v_mfma_f32_16x16x32_bf16 v[32:35], a[132:135], a[88:91], v[32:35]
  s_sub_u32 s49, s49, -16
  s_sub_u32 s48, s48, -16
  s_mov_b32 s70, 0x3f80
  s_mov_b32 s72, 0x3f800000
  s_waitcnt vmcnt(0) lgkmcnt(0)
  buffer_store_dword v5, v207, s[76:79], s49 offen sc1
  v_dot2c_f32_bf16 v96, s70, v116
  v_dot2c_f32_bf16 v97, s72, v116
  v_dot2c_f32_bf16 v98, s70, v117
  v_dot2c_f32_bf16 v99, s72, v117
  v_dot2c_f32_bf16 v100, s70, v118
  v_dot2c_f32_bf16 v101, s72, v118
  v_dot2c_f32_bf16 v102, s70, v119
  v_dot2c_f32_bf16 v103, s72, v119
  v_dot2c_f32_bf16 v104, s70, v120
  v_dot2c_f32_bf16 v105, s72, v120
  v_dot2c_f32_bf16 v106, s70, v121
  v_dot2c_f32_bf16 v107, s72, v121
  v_dot2c_f32_bf16 v108, s70, v122
  v_dot2c_f32_bf16 v109, s72, v122
  v_dot2c_f32_bf16 v110, s70, v123
  v_dot2c_f32_bf16 v111, s72, v123
  v_dot2c_f32_bf16 v112, s70, v124
  v_dot2c_f32_bf16 v113, s72, v124
  v_dot2c_f32_bf16 v114, s70, v125
  v_dot2c_f32_bf16 v115, s72, v125
  v_dot2c_f32_bf16 v96, s70, v128
  v_dot2c_f32_bf16 v97, s72, v128
  v_dot2c_f32_bf16 v98, s70, v129
  v_dot2c_f32_bf16 v99, s72, v129
  v_dot2c_f32_bf16 v100, s70, v130
  v_dot2c_f32_bf16 v101, s72, v130
  v_dot2c_f32_bf16 v102, s70, v131
  v_dot2c_f32_bf16 v103, s72, v131
  v_dot2c_f32_bf16 v104, s70, v132
  v_dot2c_f32_bf16 v105, s72, v132
  v_dot2c_f32_bf16 v106, s70, v133
  v_dot2c_f32_bf16 v107, s72, v133
  v_dot2c_f32_bf16 v108, s70, v134
  v_dot2c_f32_bf16 v109, s72, v134
  v_dot2c_f32_bf16 v110, s70, v135
  v_dot2c_f32_bf16 v111, s72, v135
  v_dot2c_f32_bf16 v112, s70, v136
  v_dot2c_f32_bf16 v113, s72, v136
  v_dot2c_f32_bf16 v114, s70, v137
  v_dot2c_f32_bf16 v115, s72, v137
  v_dot2c_f32_bf16 v96, s70, v140
  v_dot2c_f32_bf16 v97, s72, v140
  v_dot2c_f32_bf16 v98, s70, v141
  v_dot2c_f32_bf16 v99, s72, v141
  v_dot2c_f32_bf16 v100, s70, v142
  v_dot2c_f32_bf16 v101, s72, v142
  v_dot2c_f32_bf16 v102, s70, v143
  v_dot2c_f32_bf16 v103, s72, v143
  v_dot2c_f32_bf16 v104, s70, v144
  v_dot2c_f32_bf16 v105, s72, v144
  v_dot2c_f32_bf16 v106, s70, v145
  v_dot2c_f32_bf16 v107, s72, v145
  v_dot2c_f32_bf16 v108, s70, v146
  v_dot2c_f32_bf16 v109, s72, v146
  v_dot2c_f32_bf16 v110, s70, v147
  v_dot2c_f32_bf16 v111, s72, v147
  v_dot2c_f32_bf16 v112, s70, v148
  v_dot2c_f32_bf16 v113, s72, v148
  v_dot2c_f32_bf16 v114, s70, v149
  v_dot2c_f32_bf16 v115, s72, v149
  s_mov_b32 s70, 0x42b87e74
  s_mov_b32 s72, 0xbfb8aa3b
  v_pk_fma_f32 v[208:209], v[96:97], s[70:71], v[208:209] op_sel_hi:[1,0,1]
  v_pk_fma_f32 v[210:211], v[98:99], s[70:71], v[210:211] op_sel_hi:[1,0,1]
  v_pk_fma_f32 v[212:213], v[100:101], s[70:71], v[212:213] op_sel_hi:[1,0,1]
  v_pk_fma_f32 v[214:215], v[102:103], s[70:71], v[214:215] op_sel_hi:[1,0,1]
  v_pk_fma_f32 v[216:217], v[104:105], s[70:71], v[216:217] op_sel_hi:[1,0,1]
  v_pk_fma_f32 v[218:219], v[106:107], s[70:71], v[218:219] op_sel_hi:[1,0,1]
  v_pk_fma_f32 v[220:221], v[108:109], s[70:71], v[220:221] op_sel_hi:[1,0,1]
  v_pk_fma_f32 v[222:223], v[110:111], s[70:71], v[222:223] op_sel_hi:[1,0,1]
  v_pk_fma_f32 v[224:225], v[112:113], s[70:71], v[224:225] op_sel_hi:[1,0,1]
  v_pk_fma_f32 v[226:227], v[114:115], s[70:71], v[226:227] op_sel_hi:[1,0,1]
  v_pk_mul_f32 v[96:97], v[208:209], s[72:73] op_sel_hi:[1,0]
  v_pk_mul_f32 v[98:99], v[210:211], s[72:73] op_sel_hi:[1,0]
  v_pk_mul_f32 v[100:101], v[212:213], s[72:73] op_sel_hi:[1,0]
  v_pk_mul_f32 v[102:103], v[214:215], s[72:73] op_sel_hi:[1,0]
  v_pk_mul_f32 v[104:105], v[216:217], s[72:73] op_sel_hi:[1,0]
  v_pk_mul_f32 v[106:107], v[218:219], s[72:73] op_sel_hi:[1,0]
  v_pk_mul_f32 v[108:109], v[220:221], s[72:73] op_sel_hi:[1,0]
  v_pk_mul_f32 v[110:111], v[222:223], s[72:73] op_sel_hi:[1,0]
  v_pk_mul_f32 v[112:113], v[224:225], s[72:73] op_sel_hi:[1,0]
  v_pk_mul_f32 v[114:115], v[226:227], s[72:73] op_sel_hi:[1,0]
  s_mov_b32 s70, 0x3f80
  s_mov_b32 s72, 0x3f800000
  buffer_load_dword v15, v1, s[76:79], s48 offen sc1
  v_exp_f32 v96, v96
  v_exp_f32 v97, v97
  v_exp_f32 v98, v98
  v_exp_f32 v99, v99
  v_exp_f32 v100, v100
  v_exp_f32 v101, v101
  v_exp_f32 v102, v102
  v_exp_f32 v103, v103
  v_exp_f32 v104, v104
  v_exp_f32 v105, v105
  v_exp_f32 v106, v106
  v_exp_f32 v107, v107
  v_exp_f32 v108, v108
  v_exp_f32 v109, v109
  v_exp_f32 v110, v110
  v_exp_f32 v111, v111
  v_exp_f32 v112, v112
  v_exp_f32 v113, v113
  v_exp_f32 v114, v114
  v_exp_f32 v115, v115
  v_pk_add_f32 v[96:97], v[96:97], 1.0 op_sel_hi:[1,0]
  v_pk_add_f32 v[98:99], v[98:99], 1.0 op_sel_hi:[1,0]
  v_pk_add_f32 v[100:101], v[100:101], 1.0 op_sel_hi:[1,0]
  v_pk_add_f32 v[102:103], v[102:103], 1.0 op_sel_hi:[1,0]
  v_pk_add_f32 v[104:105], v[104:105], 1.0 op_sel_hi:[1,0]
  v_pk_add_f32 v[106:107], v[106:107], 1.0 op_sel_hi:[1,0]
  v_pk_add_f32 v[108:109], v[108:109], 1.0 op_sel_hi:[1,0]
  v_pk_add_f32 v[110:111], v[110:111], 1.0 op_sel_hi:[1,0]
  v_pk_add_f32 v[112:113], v[112:113], 1.0 op_sel_hi:[1,0]
  v_pk_add_f32 v[114:115], v[114:115], 1.0 op_sel_hi:[1,0]
  v_rcp_f32 v96, v96
  v_rcp_f32 v97, v97
  v_rcp_f32 v98, v98
  v_rcp_f32 v99, v99
  v_rcp_f32 v100, v100
  v_rcp_f32 v101, v101
  v_rcp_f32 v102, v102
  v_rcp_f32 v103, v103
  v_rcp_f32 v104, v104
  v_rcp_f32 v105, v105
  v_rcp_f32 v106, v106
  v_rcp_f32 v107, v107
  v_rcp_f32 v108, v108
  v_rcp_f32 v109, v109
  v_rcp_f32 v110, v110
  v_rcp_f32 v111, v111
  v_rcp_f32 v112, v112
  v_rcp_f32 v113, v113
  v_rcp_f32 v114, v114
  v_rcp_f32 v115, v115
  v_pk_mul_f32 v[96:97], v[96:97], v[208:209]
  v_pk_mul_f32 v[98:99], v[98:99], v[210:211]
  v_pk_mul_f32 v[100:101], v[100:101], v[212:213]
  v_pk_mul_f32 v[102:103], v[102:103], v[214:215]
  v_pk_mul_f32 v[104:105], v[104:105], v[216:217]
  v_pk_mul_f32 v[106:107], v[106:107], v[218:219]
  v_pk_mul_f32 v[108:109], v[108:109], v[220:221]
  v_pk_mul_f32 v[110:111], v[110:111], v[222:223]
  v_pk_mul_f32 v[112:113], v[112:113], v[224:225]
  v_pk_mul_f32 v[114:115], v[114:115], v[226:227]
  s_waitcnt vmcnt(0)
  v_cmp_ne_u32 vcc, s60, v15
  s_cbranch_vccnz re_pex
  re_peb:
  buffer_load_dwordx4 v[116:119], v0, s[16:19], s44 offen offset:0 sc1
  buffer_load_dwordx4 v[120:123], v0, s[16:19], s44 offen offset:1024 sc1
  buffer_load_dwordx2 v[124:125], v3, s[16:19], s44 offen offset:2048 sc1
  buffer_load_dwordx4 v[128:131], v0, s[16:19], s45 offen offset:0 sc1
  buffer_load_dwordx4 v[132:135], v0, s[16:19], s45 offen offset:1024 sc1
  buffer_load_dwordx2 v[136:137], v3, s[16:19], s45 offen offset:2048 sc1
  buffer_load_dwordx4 v[140:143], v0, s[16:19], s46 offen offset:0 sc1
  buffer_load_dwordx4 v[144:147], v0, s[16:19], s46 offen offset:1024 sc1
  buffer_load_dwordx2 v[148:149], v3, s[16:19], s46 offen offset:2048 sc1
  s_waitcnt vmcnt(6)
  v_dot2c_f32_bf16 v16, s70, v116
  v_dot2c_f32_bf16 v17, s72, v116
  v_dot2c_f32_bf16 v18, s70, v117
  v_dot2c_f32_bf16 v19, s72, v117
  v_dot2c_f32_bf16 v20, s70, v118
  v_dot2c_f32_bf16 v21, s72, v118
  v_dot2c_f32_bf16 v22, s70, v119
  v_dot2c_f32_bf16 v23, s72, v119
  v_dot2c_f32_bf16 v24, s70, v120
  v_dot2c_f32_bf16 v25, s72, v120
  v_dot2c_f32_bf16 v26, s70, v121
  v_dot2c_f32_bf16 v27, s72, v121
  v_dot2c_f32_bf16 v28, s70, v122
  v_dot2c_f32_bf16 v29, s72, v122
  v_dot2c_f32_bf16 v30, s70, v123
  v_dot2c_f32_bf16 v31, s72, v123
  v_dot2c_f32_bf16 v32, s70, v124
  v_dot2c_f32_bf16 v33, s72, v124
  v_dot2c_f32_bf16 v34, s70, v125
  v_dot2c_f32_bf16 v35, s72, v125
  s_waitcnt vmcnt(3)
  v_dot2c_f32_bf16 v16, s70, v128
  v_dot2c_f32_bf16 v17, s72, v128
  v_dot2c_f32_bf16 v18, s70, v129
  v_dot2c_f32_bf16 v19, s72, v129
  v_dot2c_f32_bf16 v20, s70, v130
  v_dot2c_f32_bf16 v21, s72, v130
  v_dot2c_f32_bf16 v22, s70, v131
  v_dot2c_f32_bf16 v23, s72, v131
  v_dot2c_f32_bf16 v24, s70, v132
  v_dot2c_f32_bf16 v25, s72, v132
  v_dot2c_f32_bf16 v26, s70, v133
  v_dot2c_f32_bf16 v27, s72, v133
  v_dot2c_f32_bf16 v28, s70, v134
  v_dot2c_f32_bf16 v29, s72, v134
  v_dot2c_f32_bf16 v30, s70, v135
  v_dot2c_f32_bf16 v31, s72, v135
  v_dot2c_f32_bf16 v32, s70, v136
  v_dot2c_f32_bf16 v33, s72, v136
  v_dot2c_f32_bf16 v34, s70, v137
  v_dot2c_f32_bf16 v35, s72, v137
  s_waitcnt vmcnt(0)
  v_dot2c_f32_bf16 v16, s70, v140
  v_dot2c_f32_bf16 v17, s72, v140
  v_dot2c_f32_bf16 v18, s70, v141
  v_dot2c_f32_bf16 v19, s72, v141
  v_dot2c_f32_bf16 v20, s70, v142
  v_dot2c_f32_bf16 v21, s72, v142
  v_dot2c_f32_bf16 v22, s70, v143
  v_dot2c_f32_bf16 v23, s72, v143
  v_dot2c_f32_bf16 v24, s70, v144
  v_dot2c_f32_bf16 v25, s72, v144
  v_dot2c_f32_bf16 v26, s70, v145
  v_dot2c_f32_bf16 v27, s72, v145
  v_dot2c_f32_bf16 v28, s70, v146
  v_dot2c_f32_bf16 v29, s72, v146
  v_dot2c_f32_bf16 v30, s70, v147
  v_dot2c_f32_bf16 v31, s72, v147
  v_dot2c_f32_bf16 v32, s70, v148
  v_dot2c_f32_bf16 v33, s72, v148
  v_dot2c_f32_bf16 v34, s70, v149
  v_dot2c_f32_bf16 v35, s72, v149
  v_pk_fma_f32 v[16:17], v[16:17], v[96:97], v[152:153]
  v_cvt_pk_bf16_f32 v208, v16, v17
  v_pk_fma_f32 v[18:19], v[18:19], v[98:99], v[154:155]
  v_cvt_pk_bf16_f32 v209, v18, v19
  buffer_store_dwordx2 v[208:209], v12, s[24:27], 0 offen offset:0
  v_pk_fma_f32 v[20:21], v[20:21], v[100:101], v[156:157]
  v_cvt_pk_bf16_f32 v210, v20, v21
  v_pk_fma_f32 v[22:23], v[22:23], v[102:103], v[158:159]
  v_cvt_pk_bf16_f32 v211, v22, v23
  buffer_store_dwordx2 v[210:211], v12, s[24:27], 0 offen offset:32
  v_pk_fma_f32 v[24:25], v[24:25], v[104:105], v[160:161]
  v_cvt_pk_bf16_f32 v212, v24, v25
  v_pk_fma_f32 v[26:27], v[26:27], v[106:107], v[162:163]
  v_cvt_pk_bf16_f32 v213, v26, v27
  buffer_store_dwordx2 v[212:213], v12, s[24:27], 0 offen offset:64
  v_pk_fma_f32 v[28:29], v[28:29], v[108:109], v[164:165]
  v_cvt_pk_bf16_f32 v214, v28, v29
  v_pk_fma_f32 v[30:31], v[30:31], v[110:111], v[166:167]
  v_cvt_pk_bf16_f32 v215, v30, v31
  buffer_store_dwordx2 v[214:215], v12, s[24:27], 0 offen offset:96
  v_pk_fma_f32 v[32:33], v[32:33], v[112:113], v[168:169]
  v_cvt_pk_bf16_f32 v216, v32, v33
  v_pk_fma_f32 v[34:35], v[34:35], v[114:115], v[170:171]
  v_cvt_pk_bf16_f32 v217, v34, v35
  buffer_store_dwordx2 v[216:217], v12, s[24:27], 0 offen offset:128
  s_cmp_lg_u32 s4, 24
  s_cbranch_scc1 re_last
  s_barrier
  s_lshl_b32 s70, s3, 7
  s_add_u32 s70, s70, 3145728
  buffer_store_dword v5, v207, s[76:79], s70 offen sc1
re_last:
re_end:
  s_endpgm
  re_phx:
  s_mov_b32 s73, 0
  re_phl:
  buffer_load_dword v197, v196, s[76:79], s54 offen sc1
  s_waitcnt vmcnt(0)
  v_cmp_ne_u32 vcc, s60, v197
  s_add_u32 s73, s73, 1
  s_bitcmp1_b32 s73, 20
  s_cbranch_scc1 re_phb
  s_cbranch_vccnz re_phl
  s_branch re_phb
  re_pox:
  s_mov_b32 s73, 0
  re_pol:
  buffer_load_dword v197, v196, s[76:79], s54 offen sc1
  s_waitcnt vmcnt(0)
  v_cmp_ne_u32 vcc, s60, v197
  s_add_u32 s73, s73, 1
  s_bitcmp1_b32 s73, 20
  s_cbranch_scc1 re_pob
  s_cbranch_vccnz re_pol
  s_branch re_pob
  re_pfx:
  s_mov_b32 s73, 0
  re_pfl:
  buffer_load_dword v197, v1, s[76:79], s48 offen sc1
  s_waitcnt vmcnt(0)
  v_cmp_ne_u32 vcc, s60, v197
  s_add_u32 s73, s73, 1
  s_bitcmp1_b32 s73, 20
  s_cbranch_scc1 re_pfb
  s_cbranch_vccnz re_pfl
  s_branch re_pfb
  re_pex:
  s_mov_b32 s73, 0
  re_pel:
  buffer_load_dword v15, v1, s[76:79], s48 offen sc1
  s_waitcnt vmcnt(0)
  v_cmp_ne_u32 vcc, s60, v15
  s_add_u32 s73, s73, 1
  s_bitcmp1_b32 s73, 20
  s_cbranch_scc1 re_peb
  s_cbranch_vccnz re_pel
  s_branch re_peb
re_p1w0x:
  s_waitcnt vmcnt(17)
  s_branch re_p1w0b
re_p1w1x:
  s_waitcnt vmcnt(21)
  s_branch re_p1w1b
re_p1w2x:
  s_waitcnt vmcnt(28)
  s_mov_b64 vcc, 0
  s_branch re_p1w2b
re_p3w0x:
  s_waitcnt vmcnt(30)
  s_mov_b64 vcc, 0
  s_branch re_p3w0b
re_fb:
  s_waitcnt vmcnt(0) lgkmcnt(0)
  s_barrier
  s_mov_b32 s40, 1
  s_mov_b32 s37, 0
  s_mov_b32 s69, 0
  s_mov_b32 s72, s68
  v_mov_b32 v196, 0xff800000
  v_mov_b32 v197, 0xff800000
  v_mov_b32 v198, 0xff800000
  v_mov_b32 v199, 0xff800000
re_fbl:
  s_add_u32 m0, s33, 65536
  s_nop 0
  buffer_load_dwordx4 v8, s[20:23], s37 offen offset:0 lds
  buffer_load_dwordx4 v9, s[20:23], s37 offen offset:1024 lds
  buffer_load_dwordx4 v10, s[20:23], s37 offen offset:2048 lds
  s_add_u32 s37, s37, 12288
  s_waitcnt vmcnt(0) lgkmcnt(0)
  s_barrier
  ds_read_b128 a[192:195], v14 offset:0
  ds_read_b128 a[196:199], v15 offset:0
  ds_read_b128 a[200:203], v14 offset:128
  ds_read_b128 a[204:207], v15 offset:128
  ds_read_b128 a[208:211], v14 offset:256
  ds_read_b128 a[212:215], v15 offset:256
  ds_read_b128 a[216:219], v14 offset:6144
  ds_read_b128 a[220:223], v15 offset:6144
  ds_read_b128 a[224:227], v14 offset:6272
  ds_read_b128 a[228:231], v15 offset:6272
  ds_read_b128 a[232:235], v14 offset:6400
  ds_read_b128 a[236:239], v15 offset:6400
  s_waitcnt vmcnt(0) lgkmcnt(0)
  s_barrier
  v_mfma_f32_16x16x32_bf16 v[32:35], a[192:195], v[16:19], 0
  v_mfma_f32_16x16x32_bf16 v[36:39], a[192:195], v[20:23], 0
  v_mfma_f32_16x16x32_bf16 v[40:43], a[192:195], v[24:27], 0
  v_mfma_f32_16x16x32_bf16 v[44:47], a[192:195], v[28:31], 0
  v_mfma_f32_16x16x32_bf16 v[32:35], a[196:199], v[48:51], v[32:35]
  v_mfma_f32_16x16x32_bf16 v[36:39], a[196:199], v[52:55], v[36:39]
  v_mfma_f32_16x16x32_bf16 v[40:43], a[196:199], v[56:59], v[40:43]
  v_mfma_f32_16x16x32_bf16 v[44:47], a[196:199], v[60:63], v[44:47]
  v_mfma_f32_16x16x32_bf16 v[32:35], a[200:203], v[80:83], v[32:35]
  v_mfma_f32_16x16x32_bf16 v[36:39], a[200:203], v[84:87], v[36:39]
  v_mfma_f32_16x16x32_bf16 v[40:43], a[200:203], v[88:91], v[40:43]
  v_mfma_f32_16x16x32_bf16 v[44:47], a[200:203], v[92:95], v[44:47]
  v_mfma_f32_16x16x32_bf16 v[32:35], a[204:207], v[112:115], v[32:35]
  v_mfma_f32_16x16x32_bf16 v[36:39], a[204:207], v[116:119], v[36:39]
  v_mfma_f32_16x16x32_bf16 v[40:43], a[204:207], v[120:123], v[40:43]
  v_mfma_f32_16x16x32_bf16 v[44:47], a[204:207], v[124:127], v[44:47]
  v_mfma_f32_16x16x32_bf16 v[32:35], a[208:211], v[144:147], v[32:35]
  v_mfma_f32_16x16x32_bf16 v[36:39], a[208:211], v[148:151], v[36:39]
  v_mfma_f32_16x16x32_bf16 v[40:43], a[208:211], v[152:155], v[40:43]
  v_mfma_f32_16x16x32_bf16 v[44:47], a[208:211], v[156:159], v[44:47]
  v_mfma_f32_16x16x32_bf16 v[32:35], a[212:215], v[176:179], v[32:35]
  v_mfma_f32_16x16x32_bf16 v[36:39], a[212:215], v[180:183], v[36:39]
  v_mfma_f32_16x16x32_bf16 v[40:43], a[212:215], v[184:187], v[40:43]
  v_mfma_f32_16x16x32_bf16 v[44:47], a[212:215], v[188:191], v[44:47]
  v_mfma_f32_16x16x32_bf16 v[64:67], a[216:219], v[16:19], 0
  v_mfma_f32_16x16x32_bf16 v[68:71], a[216:219], v[20:23], 0
  v_mfma_f32_16x16x32_bf16 v[72:75], a[216:219], v[24:27], 0
  v_mfma_f32_16x16x32_bf16 v[76:79], a[216:219], v[28:31], 0
  v_mfma_f32_16x16x32_bf16 v[64:67], a[220:223], v[48:51], v[64:67]
  v_mfma_f32_16x16x32_bf16 v[68:71], a[220:223], v[52:55], v[68:71]
  v_mfma_f32_16x16x32_bf16 v[72:75], a[220:223], v[56:59], v[72:75]
  v_mfma_f32_16x16x32_bf16 v[76:79], a[220:223], v[60:63], v[76:79]
  v_mfma_f32_16x16x32_bf16 v[64:67], a[224:227], v[80:83], v[64:67]
  v_mfma_f32_16x16x32_bf16 v[68:71], a[224:227], v[84:87], v[68:71]
  v_mfma_f32_16x16x32_bf16 v[72:75], a[224:227], v[88:91], v[72:75]
  v_mfma_f32_16x16x32_bf16 v[76:79], a[224:227], v[92:95], v[76:79]
  v_mfma_f32_16x16x32_bf16 v[64:67], a[228:231], v[112:115], v[64:67]
  v_mfma_f32_16x16x32_bf16 v[68:71], a[228:231], v[116:119], v[68:71]
  v_mfma_f32_16x16x32_bf16 v[72:75], a[228:231], v[120:123], v[72:75]
  v_mfma_f32_16x16x32_bf16 v[76:79], a[228:231], v[124:127], v[76:79]
  v_mfma_f32_16x16x32_bf16 v[64:67], a[232:235], v[144:147], v[64:67]
  v_mfma_f32_16x16x32_bf16 v[68:71], a[232:235], v[148:151], v[68:71]
  v_mfma_f32_16x16x32_bf16 v[72:75], a[232:235], v[152:155], v[72:75]
  v_mfma_f32_16x16x32_bf16 v[76:79], a[232:235], v[156:159], v[76:79]
  v_mfma_f32_16x16x32_bf16 v[64:67], a[236:239], v[176:179], v[64:67]
  v_mfma_f32_16x16x32_bf16 v[68:71], a[236:239], v[180:183], v[68:71]
  v_mfma_f32_16x16x32_bf16 v[72:75], a[236:239], v[184:187], v[72:75]
  v_mfma_f32_16x16x32_bf16 v[76:79], a[236:239], v[188:191], v[76:79]
  s_nop 7
  s_nop 7
  v_max3_f32 v196, v196, v32, v33
  v_max3_f32 v196, v196, v34, v35
  v_max3_f32 v197, v197, v36, v37
  v_max3_f32 v197, v197, v38, v39
  v_max3_f32 v198, v198, v40, v41
  v_max3_f32 v198, v198, v42, v43
  v_max3_f32 v199, v199, v44, v45
  v_max3_f32 v199, v199, v46, v47
  v_max3_f32 v196, v196, v64, v65
  v_max3_f32 v196, v196, v66, v67
  v_max3_f32 v197, v197, v68, v69
  v_max3_f32 v197, v197, v70, v71
  v_max3_f32 v198, v198, v72, v73
  v_max3_f32 v198, v198, v74, v75
  v_max3_f32 v199, v199, v76, v77
  v_max3_f32 v199, v199, v78, v79
  s_cmp_lt_u32 s37, 196608
  s_cbranch_scc1 re_fbl
re_fb2:
  s_nop 1
  v_permlane32_swap_b32 v196, v197
  v_permlane32_swap_b32 v198, v199
  s_nop 1
  v_max_f32 v196, v196, v197
  v_max_f32 v198, v198, v199
  s_nop 1
  v_permlane16_swap_b32 v196, v198
  s_nop 1
  v_max_f32 v196, v196, v198
  v_sub_f32 v196, 0, v196
  v_mov_b32 v198, v196
  s_nop 1
  v_permlane16_swap_b32 v196, v198
  s_nop 1
  v_mov_b32 v197, v196
  v_mov_b32 v199, v198
  s_nop 1
  v_permlane32_swap_b32 v196, v197
  v_permlane32_swap_b32 v198, v199
  s_nop 1
  v_mov_b32 v160, v196
  v_mov_b32 v161, v196
  v_mov_b32 v162, v196
  v_mov_b32 v163, v196
  v_mov_b32 v164, v197
  v_mov_b32 v165, v197
  v_mov_b32 v166, v197
  v_mov_b32 v167, v197
  v_mov_b32 v168, v198
  v_mov_b32 v169, v198
  v_mov_b32 v170, v198
  v_mov_b32 v171, v198
  v_mov_b32 v172, v199
  v_mov_b32 v173, v199
  v_mov_b32 v174, v199
  v_mov_b32 v175, v199
  s_mov_b32 s37, 0
  s_mov_b32 s38, 0
  s_add_u32 m0, s33, 65536
  s_nop 0
  buffer_load_dwordx4 v8, s[20:23], s37 offen offset:0 lds
  buffer_load_dwordx4 v9, s[20:23], s37 offen offset:1024 lds
  buffer_load_dwordx4 v10, s[20:23], s37 offen offset:2048 lds
  s_add_u32 s37, s37, 12288
  s_add_u32 m0, s33, 114688
  s_nop 0
  buffer_load_dwordx4 v11, s[24:27], s38 offen offset:0 lds
  buffer_load_dwordx4 v12, s[24:27], s38 offen offset:1024 lds
  buffer_load_dwordx4 v13, s[24:27], s38 offen offset:2048 lds
  s_add_u32 s38, s38, 12288
  s_add_u32 m0, s33, 77824
  s_nop 0
  buffer_load_dwordx4 v8, s[20:23], s37 offen offset:0 lds
  buffer_load_dwordx4 v9, s[20:23], s37 offen offset:1024 lds
  buffer_load_dwordx4 v10, s[20:23], s37 offen offset:2048 lds
  s_add_u32 s37, s37, 12288
  s_add_u32 m0, s33, 126976
  s_nop 0
  buffer_load_dwordx4 v11, s[24:27], s38 offen offset:0 lds
  buffer_load_dwordx4 v12, s[24:27], s38 offen offset:1024 lds
  buffer_load_dwordx4 v13, s[24:27], s38 offen offset:2048 lds
  s_add_u32 s38, s38, 12288
  s_add_u32 m0, s33, 90112
  s_nop 0
  buffer_load_dwordx4 v8, s[20:23], s37 offen offset:0 lds
  buffer_load_dwordx4 v9, s[20:23], s37 offen offset:1024 lds
  buffer_load_dwordx4 v10, s[20:23], s37 offen offset:2048 lds
  s_add_u32 s37, s37, 12288
  s_add_u32 m0, s33, 102400
  s_nop 0
  buffer_load_dwordx4 v8, s[20:23], s37 offen offset:0 lds
  buffer_load_dwordx4 v9, s[20:23], s37 offen offset:1024 lds
  buffer_load_dwordx4 v10, s[20:23], s37 offen offset:2048 lds
  s_add_u32 s37, s37, 12288
  v_accvgpr_write_b32 a0, 0
  v_accvgpr_write_b32 a1, 0
  v_accvgpr_write_b32 a2, 0
  v_accvgpr_write_b32 a3, 0
  v_accvgpr_write_b32 a4, 0
  v_accvgpr_write_b32 a5, 0
  v_accvgpr_write_b32 a6, 0
  v_accvgpr_write_b32 a7, 0
  v_accvgpr_write_b32 a8, 0
  v_accvgpr_write_b32 a9, 0
  v_accvgpr_write_b32 a10, 0
  v_accvgpr_write_b32 a11, 0
  v_accvgpr_write_b32 a12, 0
  v_accvgpr_write_b32 a13, 0
  v_accvgpr_write_b32 a14, 0
  v_accvgpr_write_b32 a15, 0
  v_accvgpr_write_b32 a16, 0
  v_accvgpr_write_b32 a17, 0
  v_accvgpr_write_b32 a18, 0
  v_accvgpr_write_b32 a19, 0
  v_accvgpr_write_b32 a20, 0
  v_accvgpr_write_b32 a21, 0
  v_accvgpr_write_b32 a22, 0
  v_accvgpr_write_b32 a23, 0
  v_accvgpr_write_b32 a24, 0
  v_accvgpr_write_b32 a25, 0
  v_accvgpr_write_b32 a26, 0
  v_accvgpr_write_b32 a27, 0
  v_accvgpr_write_b32 a28, 0
  v_accvgpr_write_b32 a29, 0
  v_accvgpr_write_b32 a30, 0
  v_accvgpr_write_b32 a31, 0
  v_accvgpr_write_b32 a32, 0
  v_accvgpr_write_b32 a33, 0
  v_accvgpr_write_b32 a34, 0
  v_accvgpr_write_b32 a35, 0
  v_accvgpr_write_b32 a36, 0
  v_accvgpr_write_b32 a37, 0
  v_accvgpr_write_b32 a38, 0
  v_accvgpr_write_b32 a39, 0
  v_accvgpr_write_b32 a40, 0
  v_accvgpr_write_b32 a41, 0
  v_accvgpr_write_b32 a42, 0
  v_accvgpr_write_b32 a43, 0
  v_accvgpr_write_b32 a44, 0
  v_accvgpr_write_b32 a45, 0
  v_accvgpr_write_b32 a46, 0
  v_accvgpr_write_b32 a47, 0
  v_accvgpr_write_b32 a48, 0
  v_accvgpr_write_b32 a49, 0
  v_accvgpr_write_b32 a50, 0
  v_accvgpr_write_b32 a51, 0
  v_accvgpr_write_b32 a52, 0
  v_accvgpr_write_b32 a53, 0
  v_accvgpr_write_b32 a54, 0
  v_accvgpr_write_b32 a55, 0
  v_accvgpr_write_b32 a56, 0
  v_accvgpr_write_b32 a57, 0
  v_accvgpr_write_b32 a58, 0
  v_accvgpr_write_b32 a59, 0
  v_accvgpr_write_b32 a60, 0
  v_accvgpr_write_b32 a61, 0
  v_accvgpr_write_b32 a62, 0
  v_accvgpr_write_b32 a63, 0
  v_accvgpr_write_b32 a64, 0
  v_accvgpr_write_b32 a65, 0
  v_accvgpr_write_b32 a66, 0
  v_accvgpr_write_b32 a67, 0
  v_accvgpr_write_b32 a68, 0
  v_accvgpr_write_b32 a69, 0
  v_accvgpr_write_b32 a70, 0
  v_accvgpr_write_b32 a71, 0
  v_accvgpr_write_b32 a72, 0
  v_accvgpr_write_b32 a73, 0
  v_accvgpr_write_b32 a74, 0
  v_accvgpr_write_b32 a75, 0
  v_accvgpr_write_b32 a76, 0
  v_accvgpr_write_b32 a77, 0
  v_accvgpr_write_b32 a78, 0
  v_accvgpr_write_b32 a79, 0
  v_accvgpr_write_b32 a80, 0
  v_accvgpr_write_b32 a81, 0
  v_accvgpr_write_b32 a82, 0
  v_accvgpr_write_b32 a83, 0
  v_accvgpr_write_b32 a84, 0
  v_accvgpr_write_b32 a85, 0
  v_accvgpr_write_b32 a86, 0
  v_accvgpr_write_b32 a87, 0
  v_accvgpr_write_b32 a88, 0
  v_accvgpr_write_b32 a89, 0
  v_accvgpr_write_b32 a90, 0
  v_accvgpr_write_b32 a91, 0
  v_accvgpr_write_b32 a92, 0
  v_accvgpr_write_b32 a93, 0
  v_accvgpr_write_b32 a94, 0
  v_accvgpr_write_b32 a95, 0
  v_accvgpr_write_b32 a96, 0
  v_accvgpr_write_b32 a97, 0
  v_accvgpr_write_b32 a98, 0
  v_accvgpr_write_b32 a99, 0
  v_accvgpr_write_b32 a100, 0
  v_accvgpr_write_b32 a101, 0
  v_accvgpr_write_b32 a102, 0
  v_accvgpr_write_b32 a103, 0
  v_accvgpr_write_b32 a104, 0
  v_accvgpr_write_b32 a105, 0
  v_accvgpr_write_b32 a106, 0
  v_accvgpr_write_b32 a107, 0
  v_accvgpr_write_b32 a108, 0
  v_accvgpr_write_b32 a109, 0
  v_accvgpr_write_b32 a110, 0
  v_accvgpr_write_b32 a111, 0
  v_accvgpr_write_b32 a112, 0
  v_accvgpr_write_b32 a113, 0
  v_accvgpr_write_b32 a114, 0
  v_accvgpr_write_b32 a115, 0
  v_accvgpr_write_b32 a116, 0
  v_accvgpr_write_b32 a117, 0
  v_accvgpr_write_b32 a118, 0
  v_accvgpr_write_b32 a119, 0
  v_accvgpr_write_b32 a120, 0
  v_accvgpr_write_b32 a121, 0
  v_accvgpr_write_b32 a122, 0
  v_accvgpr_write_b32 a123, 0
  v_accvgpr_write_b32 a124, 0
  v_accvgpr_write_b32 a125, 0
  v_accvgpr_write_b32 a126, 0
  v_accvgpr_write_b32 a127, 0
  v_accvgpr_write_b32 a128, 0
  v_accvgpr_write_b32 a129, 0
  v_accvgpr_write_b32 a130, 0
  v_accvgpr_write_b32 a131, 0
  v_accvgpr_write_b32 a132, 0
  v_accvgpr_write_b32 a133, 0
  v_accvgpr_write_b32 a134, 0
  v_accvgpr_write_b32 a135, 0
  v_accvgpr_write_b32 a136, 0
  v_accvgpr_write_b32 a137, 0
  v_accvgpr_write_b32 a138, 0
  v_accvgpr_write_b32 a139, 0
  v_accvgpr_write_b32 a140, 0
  v_accvgpr_write_b32 a141, 0
  v_accvgpr_write_b32 a142, 0
  v_accvgpr_write_b32 a143, 0
  v_accvgpr_write_b32 a144, 0
  v_accvgpr_write_b32 a145, 0
  v_accvgpr_write_b32 a146, 0
  v_accvgpr_write_b32 a147, 0
  v_accvgpr_write_b32 a148, 0
  v_accvgpr_write_b32 a149, 0
  v_accvgpr_write_b32 a150, 0
  v_accvgpr_write_b32 a151, 0
  v_accvgpr_write_b32 a152, 0
  v_accvgpr_write_b32 a153, 0
  v_accvgpr_write_b32 a154, 0
  v_accvgpr_write_b32 a155, 0
  v_accvgpr_write_b32 a156, 0
  v_accvgpr_write_b32 a157, 0
  v_accvgpr_write_b32 a158, 0
  v_accvgpr_write_b32 a159, 0
  v_accvgpr_write_b32 a160, 0
  v_accvgpr_write_b32 a161, 0
  v_accvgpr_write_b32 a162, 0
  v_accvgpr_write_b32 a163, 0
  v_accvgpr_write_b32 a164, 0
  v_accvgpr_write_b32 a165, 0
  v_accvgpr_write_b32 a166, 0
  v_accvgpr_write_b32 a167, 0
  v_accvgpr_write_b32 a168, 0
  v_accvgpr_write_b32 a169, 0
  v_accvgpr_write_b32 a170, 0
  v_accvgpr_write_b32 a171, 0
  v_accvgpr_write_b32 a172, 0
  v_accvgpr_write_b32 a173, 0
  v_accvgpr_write_b32 a174, 0
  v_accvgpr_write_b32 a175, 0
  v_accvgpr_write_b32 a176, 0
  v_accvgpr_write_b32 a177, 0
  v_accvgpr_write_b32 a178, 0
  v_accvgpr_write_b32 a179, 0
  v_accvgpr_write_b32 a180, 0
  v_accvgpr_write_b32 a181, 0
  v_accvgpr_write_b32 a182, 0
  v_accvgpr_write_b32 a183, 0
  v_accvgpr_write_b32 a184, 0
  v_accvgpr_write_b32 a185, 0
  v_accvgpr_write_b32 a186, 0
  v_accvgpr_write_b32 a187, 0
  v_accvgpr_write_b32 a188, 0
  v_accvgpr_write_b32 a189, 0
  v_accvgpr_write_b32 a190, 0
  v_accvgpr_write_b32 a191, 0
  s_waitcnt vmcnt(0) lgkmcnt(0)
  s_barrier
  ds_read_b128 a[224:227], v14 offset:0
  ds_read_b128 a[228:231], v15 offset:0
  ds_read_b128 a[232:235], v14 offset:128
  ds_read_b128 a[236:239], v15 offset:128
  ds_read_b128 a[240:243], v14 offset:256
  ds_read_b128 a[244:247], v15 offset:256
  ds_read_b128 a[248:251], v14 offset:6144
  ds_read_b128 a[252:255], v15 offset:6144
  s_waitcnt lgkmcnt(7)
  v_mfma_f32_16x16x32_bf16 v[32:35], a[224:227], v[16:19], 0
  v_mfma_f32_16x16x32_bf16 v[36:39], a[224:227], v[20:23], 0
  v_mfma_f32_16x16x32_bf16 v[40:43], a[224:227], v[24:27], 0
  v_mfma_f32_16x16x32_bf16 v[44:47], a[224:227], v[28:31], 0
  s_waitcnt lgkmcnt(6)
  v_mfma_f32_16x16x32_bf16 v[32:35], a[228:231], v[48:51], v[32:35]
  ds_read_b128 a[224:227], v14 offset:6272
  v_mfma_f32_16x16x32_bf16 v[36:39], a[228:231], v[52:55], v[36:39]
  v_mfma_f32_16x16x32_bf16 v[40:43], a[228:231], v[56:59], v[40:43]
  v_mfma_f32_16x16x32_bf16 v[44:47], a[228:231], v[60:63], v[44:47]
  s_waitcnt lgkmcnt(6)
  v_mfma_f32_16x16x32_bf16 v[32:35], a[232:235], v[80:83], v[32:35]
  ds_read_b128 a[228:231], v15 offset:6272
  v_mfma_f32_16x16x32_bf16 v[36:39], a[232:235], v[84:87], v[36:39]
  v_mfma_f32_16x16x32_bf16 v[40:43], a[232:235], v[88:91], v[40:43]
  v_mfma_f32_16x16x32_bf16 v[44:47], a[232:235], v[92:95], v[44:47]
  s_waitcnt lgkmcnt(6)
  v_mfma_f32_16x16x32_bf16 v[32:35], a[236:239], v[112:115], v[32:35]
  ds_read_b128 a[232:235], v14 offset:6400
  v_mfma_f32_16x16x32_bf16 v[36:39], a[236:239], v[116:119], v[36:39]
  v_mfma_f32_16x16x32_bf16 v[40:43], a[236:239], v[120:123], v[40:43]
  v_mfma_f32_16x16x32_bf16 v[44:47], a[236:239], v[124:127], v[44:47]
  s_waitcnt lgkmcnt(6)
  v_mfma_f32_16x16x32_bf16 v[32:35], a[240:243], v[144:147], v[32:35]
  ds_read_b128 a[236:239], v15 offset:6400
  v_mfma_f32_16x16x32_bf16 v[36:39], a[240:243], v[148:151], v[36:39]
  v_mfma_f32_16x16x32_bf16 v[40:43], a[240:243], v[152:155], v[40:43]
  v_mfma_f32_16x16x32_bf16 v[44:47], a[240:243], v[156:159], v[44:47]
  s_waitcnt lgkmcnt(6)
  v_mfma_f32_16x16x32_bf16 v[32:35], a[244:247], v[176:179], v[32:35]
  v_mfma_f32_16x16x32_bf16 v[36:39], a[244:247], v[180:183], v[36:39]
  v_mfma_f32_16x16x32_bf16 v[40:43], a[244:247], v[184:187], v[40:43]
  v_mfma_f32_16x16x32_bf16 v[44:47], a[244:247], v[188:191], v[44:47]
  s_waitcnt lgkmcnt(5)
  s_nop 7
  v_mov_b32 v192, 0
  v_mov_b32 v193, 0
  v_mov_b32 v194, 0
  v_mov_b32 v195, 0
  s_mov_b32 s37, 49152
  s_mov_b32 s38, 24576
  v_mfma_f32_16x16x32_bf16 v[64:67], a[248:251], v[16:19], v[160:163]
  ds_read_b128 a[192:195], v14 offset:12288
  v_add_f32 v32, v32, v160
  v_add_f32 v33, v33, v160
  v_add_f32 v34, v34, v160
  v_mfma_f32_16x16x32_bf16 v[68:71], a[248:251], v[20:23], v[164:167]
  v_add_f32 v35, v35, v160
  v_exp_f32 v32, v32
  v_mfma_f32_16x16x32_bf16 v[72:75], a[248:251], v[24:27], v[168:171]
  v_exp_f32 v33, v33
  v_add_f32 v192, v192, v32
  v_mfma_f32_16x16x32_bf16 v[76:79], a[248:251], v[28:31], v[172:175]
  v_exp_f32 v34, v34
  v_add_f32 v192, v192, v33
  v_exp_f32 v35, v35
  s_waitcnt lgkmcnt(5)
  v_mfma_f32_16x16x32_bf16 v[64:67], a[252:255], v[48:51], v[64:67]
  ds_read_b128 a[196:199], v15 offset:12288
  v_cvt_pk_bf16_f32 v96, v32, v33
  v_add_f32 v192, v192, v34
  v_mfma_f32_16x16x32_bf16 v[68:71], a[252:255], v[52:55], v[68:71]
  v_add_f32 v192, v192, v35
  v_cvt_pk_bf16_f32 v97, v34, v35
  v_mfma_f32_16x16x32_bf16 v[72:75], a[252:255], v[56:59], v[72:75]
  v_add_f32 v36, v36, v164
  v_add_f32 v37, v37, v164
  v_add_f32 v38, v38, v164
  v_mfma_f32_16x16x32_bf16 v[76:79], a[252:255], v[60:63], v[76:79]
  v_add_f32 v39, v39, v164
  v_exp_f32 v36, v36
  s_waitcnt lgkmcnt(5)
  v_mfma_f32_16x16x32_bf16 v[64:67], a[224:227], v[80:83], v[64:67]
  ds_read_b128 a[200:203], v14 offset:12416
  v_exp_f32 v37, v37
  v_add_f32 v193, v193, v36
  v_mfma_f32_16x16x32_bf16 v[68:71], a[224:227], v[84:87], v[68:71]
  v_exp_f32 v38, v38
  v_add_f32 v193, v193, v37
  v_exp_f32 v39, v39
  v_mfma_f32_16x16x32_bf16 v[72:75], a[224:227], v[88:91], v[72:75]
  v_cvt_pk_bf16_f32 v100, v36, v37
  v_add_f32 v193, v193, v38
  v_mfma_f32_16x16x32_bf16 v[76:79], a[224:227], v[92:95], v[76:79]
  v_add_f32 v193, v193, v39
  v_cvt_pk_bf16_f32 v101, v38, v39
  s_waitcnt lgkmcnt(5)
  v_mfma_f32_16x16x32_bf16 v[64:67], a[228:231], v[112:115], v[64:67]
  ds_read_b128 a[204:207], v15 offset:12416
  v_add_f32 v40, v40, v168
  v_add_f32 v41, v41, v168
  v_add_f32 v42, v42, v168
  v_mfma_f32_16x16x32_bf16 v[68:71], a[228:231], v[116:119], v[68:71]
  v_add_f32 v43, v43, v168
  v_exp_f32 v40, v40
  v_mfma_f32_16x16x32_bf16 v[72:75], a[228:231], v[120:123], v[72:75]
  v_exp_f32 v41, v41
  v_add_f32 v194, v194, v40
  v_mfma_f32_16x16x32_bf16 v[76:79], a[228:231], v[124:127], v[76:79]
  v_exp_f32 v42, v42
  v_add_f32 v194, v194, v41
  v_exp_f32 v43, v43
  s_waitcnt lgkmcnt(5)
  v_mfma_f32_16x16x32_bf16 v[64:67], a[232:235], v[144:147], v[64:67]
  ds_read_b128 a[208:211], v14 offset:12544
  v_cvt_pk_bf16_f32 v104, v40, v41
  v_add_f32 v194, v194, v42
  v_mfma_f32_16x16x32_bf16 v[68:71], a[232:235], v[148:151], v[68:71]
  v_add_f32 v194, v194, v43
  v_cvt_pk_bf16_f32 v105, v42, v43
  v_mfma_f32_16x16x32_bf16 v[72:75], a[232:235], v[152:155], v[72:75]
  v_add_f32 v44, v44, v172
  v_add_f32 v45, v45, v172
  v_add_f32 v46, v46, v172
  v_mfma_f32_16x16x32_bf16 v[76:79], a[232:235], v[156:159], v[76:79]
  v_add_f32 v47, v47, v172
  v_exp_f32 v44, v44
  s_waitcnt lgkmcnt(5)
  s_barrier
  v_mfma_f32_16x16x32_bf16 v[64:67], a[236:239], v[176:179], v[64:67]
  v_exp_f32 v45, v45
  v_add_f32 v195, v195, v44
  v_mfma_f32_16x16x32_bf16 v[68:71], a[236:239], v[180:183], v[68:71]
  v_exp_f32 v46, v46
  v_add_f32 v195, v195, v45
  v_exp_f32 v47, v47
  v_mfma_f32_16x16x32_bf16 v[72:75], a[236:239], v[184:187], v[72:75]
  v_cvt_pk_bf16_f32 v108, v44, v45
  v_add_f32 v195, v195, v46
  v_mfma_f32_16x16x32_bf16 v[76:79], a[236:239], v[188:191], v[76:79]
  v_add_f32 v195, v195, v47
  v_cvt_pk_bf16_f32 v109, v46, v47
  s_add_u32 m0, s33, 139264
  s_nop 0
  buffer_load_dwordx4 v11, s[24:27], s38 offen offset:0 lds
  buffer_load_dwordx4 v12, s[24:27], s38 offen offset:1024 lds
  buffer_load_dwordx4 v13, s[24:27], s38 offen offset:2048 lds
  s_add_u32 s38, s38, 12288
  s_nop 7
  v_bfe_u32 v196, v0, 4, 3
  v_lshlrev_b32 v196, 2, v196
  s_lshr_b32 s73, s61, 1
  s_lshl_b32 s73, s73, 10
  v_add_u32 v198, s73, v0
  v_xor_b32 v199, 1024, v198
  v_exp_f32 v64, v64
  v_exp_f32 v68, v68
  v_exp_f32 v65, v65
  v_exp_f32 v69, v69
  v_add_f32 v192, v192, v64
  v_add_f32 v193, v193, v68
  v_exp_f32 v66, v66
  v_exp_f32 v70, v70
  v_add_f32 v192, v192, v65
  v_add_f32 v193, v193, v69
  v_exp_f32 v67, v67
  v_exp_f32 v71, v71
  v_cvt_pk_bf16_f32 v98, v64, v65
  v_cvt_pk_bf16_f32 v102, v68, v69
  v_add_f32 v192, v192, v66
  v_add_f32 v193, v193, v70
  v_add_f32 v192, v192, v67
  v_add_f32 v193, v193, v71
  v_cvt_pk_bf16_f32 v99, v66, v67
  v_cvt_pk_bf16_f32 v103, v70, v71
  s_waitcnt lgkmcnt(4)
  s_branch re_p21
re_zend:
.section .rodata,"a"
.p2align 6
.amdhsa_kernel recurrent_scan__sliding_block_cached__dense_activation_squared_relu__prompt_kernel
  .amdhsa_next_free_vgpr 512
  .amdhsa_next_free_sgpr 102
  .amdhsa_accum_offset 256
  .amdhsa_group_segment_fixed_size 0
  .amdhsa_kernarg_size 104
  .amdhsa_user_sgpr_count 2
  .amdhsa_user_sgpr_kernarg_segment_ptr 1
  .amdhsa_system_sgpr_workgroup_id_x 1
.end_amdhsa_kernel
```
